```python
import torch

def _softmax(x, axis=-1):
    return torch.softmax(x, dim=axis)
def _gelu(x):
    return torch.nn.functional.gelu(x, approximate="tanh")
def _silu(x):
    return torch.nn.functional.silu(x)
def _sigmoid(x):
    return torch.sigmoid(x)
def _layernorm(x, axis=-1, eps=1e-5):
    m = x.mean(dim=axis, keepdim=True)
    v = x.var(dim=axis, keepdim=True, unbiased=False)
    return (x - m) / torch.sqrt(v + eps)
def _scatter_add(tgt, idx, src, axis=0):
    return tgt.clone().index_add_(axis, idx, src)
def _segment_sum(src, seg, n):
    out = torch.zeros((n,) + src.shape[1:], dtype=src.dtype)
    return out.index_add_(0, seg, src)
def _pad(x, pw):
    flat = tuple(v for pair in reversed(pw) for v in pair)
    return torch.nn.functional.pad(x, flat)

kernel_name = 'standalone__gqa_block_cached__near_ridge'

def setup_inputs():

    _w = (lambda a: (lambda t: t.to(torch.bfloat16) if t.is_floating_point() else t)(torch.as_tensor(a)))
    B, Sq, D = 8, 192, 640
    Hq, Hkv, Sk, Dh = 32, 32, 1024, 192
    assert Hq % Hkv == 0, (Hq, Hkv)
    return {
        "x": _w((lambda *s: torch.randn(*s, dtype=torch.bfloat16) * 0.8)(B, Sq, D)),
        "k_cache": _w((lambda *s: torch.randn(*s, dtype=torch.bfloat16) * 0.8)(B, Hkv, Sk, Dh)),
        "v_cache": _w((lambda *s: torch.randn(*s, dtype=torch.bfloat16) * 0.05)(B, Hkv, Sk, Dh)),
        "wq": _w((lambda *s: torch.randn(*s, dtype=torch.bfloat16) * 0.8)(D, Hq * Dh) * (D ** -0.5)),
        "wo": _w((lambda *s: torch.randn(*s, dtype=torch.bfloat16) * 0.05)(Hq * Dh, D) * ((Hq * Dh) ** -0.5)),
    }

def reference(x, k_cache, v_cache, wq, wo):
    B, Sq, D = x.shape
    Hq, Dh = 32, 192
    Hkv = k_cache.shape[1]
    rep = Hq // Hkv
    q = (lambda x, *d: x.permute(*d))((x @ wq).reshape(B, Sq, Hq, Dh), 0, 2, 1, 3)
    k = (lambda x, n, axis: torch.repeat_interleave(x, n, dim=axis))(k_cache, rep, axis=1)
    v = (lambda x, n, axis: torch.repeat_interleave(x, n, dim=axis))(v_cache, rep, axis=1)
    scores = torch.einsum("bhqd,bhkd->bhqk", q, k) * (Dh ** -0.5)
    p = _softmax(scores, axis=-1)
    o = torch.einsum("bhqk,bhkd->bhqd", p, v)
    return (lambda x, *d: x.permute(*d))(o, 0, 2, 1, 3).reshape(B, Sq, Hq * Dh) @ wo
```

```asm
; @launch grid=(256,1,1) block=(256,1,1) lds=163840
.amdgcn_target "amdgcn-amd-amdhsa--gfx950"
.text
.globl standalone__gqa_block_cached__near_ridge_kernel
.p2align 8
.type standalone__gqa_block_cached__near_ridge_kernel,@function
standalone__gqa_block_cached__near_ridge_kernel:
s_cmp_ge_u32 s2, 256
s_cbranch_scc1 L_end
s_load_dwordx8 s[76:83], s[0:1], 0
s_load_dwordx8 s[84:91], s[0:1], 32
v_lshrrev_b32 v1, 6, v0
v_and_b32 v0, 63, v0
v_readfirstlane_b32 s32, v1
s_getpc_b64 s[98:99]
s_lshr_b32 s47, s2, 3
s_mul_i32 s47, s47, 1664
v_mul_u32_u24 v252, 3, v1
v_add_lshl_u32 v252, v252, v0, 7
v_add_u32 v252, s47, v252
v_mov_b32 v253, s99
v_add_co_u32 v252, vcc, s98, v252
s_nop 1
v_addc_co_u32 v253, vcc, 0, v253, vcc
s_mov_b64 exec, 15
global_load_dword v248, v[252:253], off
s_mov_b64 exec, -1
s_and_b32 s35, s2, 7
s_lshr_b32 s33, s2, 5
s_bfe_u32 s36, s2, 0x20003
s_mul_i32 s37, s32, 3072
s_add_u32 s47, s33, s36
s_lshl_b32 s47, s47, 2
s_mov_b32 s96, 812844848
s_mov_b32 s97, 775
s_lshr_b64 s[96:97], s[96:97], s47
s_and_b32 s47, s96, 15
s_and_b32 s96, s35, 7
s_add_u32 s47, s47, s96
s_cmp_ge_u32 s47, 10
s_cselect_b32 s96, 10, 0
s_sub_u32 s47, s47, s96
s_lshl_b32 s44, s47, 7
s_mul_i32 s43, s47, 786432
s_mul_i32 s42, s2, 11
s_add_u32 s42, s42, s33
s_and_b32 s42, s42, 31
s_mul_i32 s42, s42, 12288
s_mov_b32 s38, s42
v_lshrrev_b32 v240, 3, v0
v_and_b32 v241, 7, v0
s_lshl_b32 s46, s32, 3
s_lshl_b32 s47, s33, 2
s_add_u32 s47, s47, s32
s_mul_i32 s50, s47, 61440
s_lshl_b32 s48, s35, 2
s_add_u32 s51, s48, s36
s_mul_i32 s48, s51, 384
v_lshrrev_b32 v242, 1, v240
v_add_u32 v242, 0, v242
v_xor_b32 v242, v242, v241
v_lshlrev_b32 v242, 4, v242
v_add_u32 v243, 0, v240
v_mul_u32_u24 v243, 1280, v243
v_add3_u32 v11, v242, v243, s50
v_add_u32 v13, 19456, v11
v_add_u32 v15, 38912, v11
v_lshrrev_b32 v242, 1, v240
v_add_u32 v242, 4, v242
v_xor_b32 v242, v242, v241
v_lshlrev_b32 v242, 4, v242
v_add_u32 v243, 8, v240
v_mul_u32_u24 v243, 1280, v243
v_add3_u32 v12, v242, v243, s50
v_add_u32 v14, 19456, v12
v_add_u32 v16, 38912, v12
s_waitcnt lgkmcnt(0)
s_mov_b32 s16, s76
s_and_b32 s17, s77, 0xffff
s_mov_b32 s18, 1966080
s_mov_b32 s19, 0x00020000
s_add_u32 m0, s37, 73728
s_nop 0
buffer_load_dwordx4 v11, s[16:19], s44 offen offset:0 lds
buffer_load_dwordx4 v13, s[16:19], s44 offen offset:1024 lds
buffer_load_dwordx4 v15, s[16:19], s44 offen offset:2048 lds
s_add_u32 m0, s37, 86016
s_nop 0
buffer_load_dwordx4 v12, s[16:19], s44 offen offset:0 lds
buffer_load_dwordx4 v14, s[16:19], s44 offen offset:1024 lds
buffer_load_dwordx4 v16, s[16:19], s44 offen offset:2048 lds
s_add_u32 s44, s44, 128
s_cmp_ge_u32 s44, 1280
s_cselect_b32 s44, 0, s44
v_add_u32 v242, 0, v240
v_mul_u32_u24 v243, 11, v242
v_lshrrev_b32 v243, 5, v243
v_mul_u32_u24 v244, 3, v243
v_sub_u32 v244, v242, v244
v_add_u32 v243, s46, v243
v_and_b32 v245, 6, v243
v_xor_b32 v245, v245, v241
v_lshlrev_b32 v245, 4, v245
v_bfe_u32 v246, v243, 2, 2
v_lshlrev_b32 v246, 3, v246
v_lshrrev_b32 v247, 4, v243
v_lshl_add_u32 v246, v247, 2, v246
v_and_b32 v247, 3, v243
v_add_u32 v246, v246, v247
v_mul_u32_u24 v246, 12288, v246
v_lshl_add_u32 v246, v244, 7, v246
v_add3_u32 v246, v246, v245, s48
v_subrev_u32 v8, 0, v246
v_add_u32 v242, 8, v240
v_mul_u32_u24 v243, 11, v242
v_lshrrev_b32 v243, 5, v243
v_mul_u32_u24 v244, 3, v243
v_sub_u32 v244, v242, v244
v_add_u32 v243, s46, v243
v_and_b32 v245, 6, v243
v_xor_b32 v245, v245, v241
v_lshlrev_b32 v245, 4, v245
v_bfe_u32 v246, v243, 2, 2
v_lshlrev_b32 v246, 3, v246
v_lshrrev_b32 v247, 4, v243
v_lshl_add_u32 v246, v247, 2, v246
v_and_b32 v247, 3, v243
v_add_u32 v246, v246, v247
v_mul_u32_u24 v246, 12288, v246
v_lshl_add_u32 v246, v244, 7, v246
v_add3_u32 v246, v246, v245, s48
v_subrev_u32 v9, 1024, v246
v_add_u32 v242, 16, v240
v_mul_u32_u24 v243, 11, v242
v_lshrrev_b32 v243, 5, v243
v_mul_u32_u24 v244, 3, v243
v_sub_u32 v244, v242, v244
v_add_u32 v243, s46, v243
v_and_b32 v245, 6, v243
v_xor_b32 v245, v245, v241
v_lshlrev_b32 v245, 4, v245
v_bfe_u32 v246, v243, 2, 2
v_lshlrev_b32 v246, 3, v246
v_lshrrev_b32 v247, 4, v243
v_lshl_add_u32 v246, v247, 2, v246
v_and_b32 v247, 3, v243
v_add_u32 v246, v246, v247
v_mul_u32_u24 v246, 12288, v246
v_lshl_add_u32 v246, v244, 7, v246
v_add3_u32 v246, v246, v245, s48
v_subrev_u32 v10, 2048, v246
s_mov_b32 s12, s82
s_and_b32 s13, s83, 0xffff
s_mov_b32 s14, 7864320
s_mov_b32 s15, 0x00020000
s_add_u32 m0, s37, 12288
s_nop 0
buffer_load_dwordx4 v8, s[12:15], s43 offen offset:0  lds
buffer_load_dwordx4 v9, s[12:15], s43 offen offset:1024  lds
buffer_load_dwordx4 v10, s[12:15], s43 offen offset:2048  lds
s_add_u32 s43, s43, 393216
s_cmp_ge_u32 s43, 7864320
s_cselect_b32 s43, 0, s43
s_add_u32 m0, s37, 98304
s_nop 0
buffer_load_dwordx4 v8, s[12:15], s43 offen offset:0  lds
buffer_load_dwordx4 v9, s[12:15], s43 offen offset:1024  lds
buffer_load_dwordx4 v10, s[12:15], s43 offen offset:2048  lds
s_add_u32 s43, s43, 393216
s_cmp_ge_u32 s43, 7864320
s_cselect_b32 s43, 0, s43
s_add_u32 m0, s37, 110592
s_nop 0
buffer_load_dwordx4 v8, s[12:15], s43 offen offset:0  lds
buffer_load_dwordx4 v9, s[12:15], s43 offen offset:1024  lds
buffer_load_dwordx4 v10, s[12:15], s43 offen offset:2048  lds
s_add_u32 s43, s43, 393216
s_cmp_ge_u32 s43, 7864320
s_cselect_b32 s43, 0, s43
s_lshl_b32 s47, s33, 3
s_add_u32 s47, s47, s35
s_lshl_b32 s96, s47, 2
s_add_u32 s47, s96, s32
s_lshl_b32 s47, s47, 8
s_add_u32 s47, s47, 41943040
s_lshl_b32 s48, s33, 2
s_add_u32 s48, s48, s36
s_lshl_b32 s48, s48, 2
s_add_u32 s97, s48, s32
s_lshl_b32 s48, s97, 8
s_add_u32 s48, s48, 42008576
v_and_b32 v242, 3, v0
v_lshl_add_u32 v250, v242, 3, s47
v_and_b32 v242, 15, v0
v_lshl_add_u32 v251, v242, 3, s48
s_add_u32 s47, s47, 96
s_add_u32 s48, s48, 192
s_mul_i32 s33, s97, 3
s_add_u32 s33, s33, s35
s_and_b32 s33, s33, 7
s_load_dwordx2 s[92:93], s[90:91], s47
s_load_dwordx2 s[94:95], s[90:91], s48
v_and_b32 v232, 15, v0
v_lshrrev_b32 v233, 4, v0
v_lshrrev_b32 v234, 1, v232
v_xor_b32 v234, v234, v233
v_lshlrev_b32 v237, 4, v234
v_and_b32 v235, 7, v232
v_lshl_add_u32 v237, v235, 7, v237
v_lshrrev_b32 v235, 3, v232
v_mul_u32_u24 v235, 12288, v235
v_add3_u32 v237, v237, v235, s37
v_add_u32 v29, 49152, v237
v_xor_b32 v30, 64, v29
v_bfe_u32 v235, v234, 1, 1
v_and_b32 v236, 1, v234
v_lshl_add_u32 v235, v236, 1, v235
v_and_b32 v236, 4, v234
v_or_b32 v235, v235, v236
v_lshlrev_b32 v235, 4, v235
v_mul_u32_u24 v236, 384, v232
v_add_u32 v17, v235, v236
v_xor_b32 v18, 64, v17
v_mov_b32 v23, v17
v_mov_b32 v24, v18
v_lshrrev_b32 v234, 2, v0
v_mul_u32_u24 v235, 384, v234
v_bfe_u32 v236, v234, 1, 2
v_lshl_add_u32 v235, v236, 5, v235
v_and_b32 v236, 3, v0
v_lshl_add_u32 v19, v236, 3, v235
v_xor_b32 v20, 32, v19
v_xor_b32 v21, 64, v19
v_xor_b32 v22, 96, v19
v_add_u32 v25, 12288, v19
v_add_u32 v26, 12288, v20
v_add_u32 v27, 12288, v21
v_add_u32 v28, 12288, v22
s_waitcnt vmcnt(9)
ds_read_b128 a[0:3], v29 offset:24576
ds_read_b128 a[4:7], v29 offset:25600
ds_read_b128 a[8:11], v29 offset:26624
ds_read_b128 a[12:15], v30 offset:24576
ds_read_b128 a[16:19], v30 offset:25600
ds_read_b128 a[20:23], v30 offset:26624
s_add_u32 m0, s37, 49152
s_nop 0
buffer_load_dwordx4 v11, s[16:19], s44 offen offset:0 lds
buffer_load_dwordx4 v13, s[16:19], s44 offen offset:1024 lds
buffer_load_dwordx4 v15, s[16:19], s44 offen offset:2048 lds
s_add_u32 m0, s37, 61440
s_nop 0
buffer_load_dwordx4 v12, s[16:19], s44 offen offset:0 lds
buffer_load_dwordx4 v14, s[16:19], s44 offen offset:1024 lds
buffer_load_dwordx4 v16, s[16:19], s44 offen offset:2048 lds
s_add_u32 s44, s44, 128
s_cmp_ge_u32 s44, 1280
s_cselect_b32 s44, 0, s44
s_waitcnt lgkmcnt(0)
s_add_u32 s92, s92, 2654435769
s_addc_u32 s93, s93, 2135587861
s_add_u32 s94, s94, 2654435769
s_addc_u32 s95, s95, 2135587861
s_waitcnt vmcnt(12)
s_waitcnt lgkmcnt(0)
s_barrier
ds_read_b64_tr_b16 a[144:145], v25 offset:0
ds_read_b64_tr_b16 a[146:147], v25 offset:6144
ds_read_b64_tr_b16 a[148:149], v26 offset:0
ds_read_b64_tr_b16 a[150:151], v26 offset:6144
ds_read_b64_tr_b16 a[152:153], v27 offset:0
ds_read_b64_tr_b16 a[154:155], v27 offset:6144
ds_read_b64_tr_b16 a[156:157], v28 offset:0
ds_read_b64_tr_b16 a[158:159], v28 offset:6144
s_waitcnt lgkmcnt(6)
v_mfma_f32_16x16x32_bf16 v[32:35], a[144:147], a[0:3], 0
s_add_u32 m0, s37, 122880
ds_read_b64_tr_b16 a[160:161], v25 offset:128
ds_read_b64_tr_b16 a[162:163], v25 offset:6272
v_mfma_f32_16x16x32_bf16 v[36:39], a[144:147], a[4:7], 0
s_add_u32 s47, s96, s36
v_mfma_f32_16x16x32_bf16 v[40:43], a[144:147], a[8:11], 0
s_waitcnt lgkmcnt(6)
ds_read_b64_tr_b16 a[164:165], v26 offset:128
ds_read_b64_tr_b16 a[166:167], v26 offset:6272
v_mfma_f32_16x16x32_bf16 v[52:55], a[148:151], a[8:11], 0
s_mul_i32 s47, s47, 393216
buffer_load_dwordx4 v8, s[12:15], s43 offen offset:0  lds
v_mfma_f32_16x16x32_bf16 v[48:51], a[148:151], a[4:7], 0
ds_read_b64_tr_b16 a[168:169], v27 offset:128
ds_read_b64_tr_b16 a[170:171], v27 offset:6272
v_mfma_f32_16x16x32_bf16 v[44:47], a[148:151], a[0:3], 0
s_waitcnt lgkmcnt(8)
buffer_load_dwordx4 v9, s[12:15], s43 offen offset:1024  lds
v_mfma_f32_16x16x32_bf16 v[56:59], a[152:155], a[0:3], 0
s_add_u32 s78, s78, s47
s_addc_u32 s79, s79, 0
v_add_u32 v252, 98304, v19
v_mfma_f32_16x16x32_bf16 v[60:63], a[152:155], a[4:7], 0
ds_read_b64_tr_b16 a[172:173], v28 offset:128
ds_read_b64_tr_b16 a[174:175], v28 offset:6272
v_mfma_f32_16x16x32_bf16 v[64:67], a[152:155], a[8:11], 0
s_waitcnt lgkmcnt(8)
buffer_load_dwordx4 v10, s[12:15], s43 offen offset:2048  lds
v_mfma_f32_16x16x32_bf16 v[76:79], a[156:159], a[8:11], 0
s_add_u32 s43, s43, 393216
ds_read_b64_tr_b16 a[176:177], v25 offset:256
ds_read_b64_tr_b16 a[178:179], v25 offset:6400
v_mfma_f32_16x16x32_bf16 v[72:75], a[156:159], a[4:7], 0
s_cmp_ge_u32 s43, 7864320
s_cselect_b32 s43, 0, s43
v_add_u32 v253, 98304, v20
v_mfma_f32_16x16x32_bf16 v[68:71], a[156:159], a[0:3], 0
s_waitcnt lgkmcnt(8)
ds_read_b64_tr_b16 a[180:181], v26 offset:256
ds_read_b64_tr_b16 a[182:183], v26 offset:6400
v_mfma_f32_16x16x32_bf16 v[80:83], a[160:163], a[0:3], 0
s_add_u32 s80, s80, s47
s_addc_u32 s81, s81, 0
s_mov_b32 s4, s78
v_mfma_f32_16x16x32_bf16 v[84:87], a[160:163], a[4:7], 0
s_and_b32 s5, s79, 0xffff
v_add_u32 v254, 98304, v21
v_mfma_f32_16x16x32_bf16 v[88:91], a[160:163], a[8:11], 0
s_waitcnt lgkmcnt(8)
ds_read_b64_tr_b16 a[184:185], v27 offset:256
ds_read_b64_tr_b16 a[186:187], v27 offset:6400
v_mfma_f32_16x16x32_bf16 v[100:103], a[164:167], a[8:11], 0
s_mov_b32 s6, 393216
v_add_u32 v255, 98304, v22
v_mfma_f32_16x16x32_bf16 v[96:99], a[164:167], a[4:7], 0
s_mov_b32 s7, 0x00020000
ds_read_b64_tr_b16 a[188:189], v28 offset:256
ds_read_b64_tr_b16 a[190:191], v28 offset:6400
v_mfma_f32_16x16x32_bf16 v[92:95], a[164:167], a[0:3], 0
s_waitcnt lgkmcnt(10)
v_mfma_f32_16x16x32_bf16 v[104:107], a[168:171], a[0:3], 0
s_mov_b32 s8, s80
v_mfma_f32_16x16x32_bf16 v[108:111], a[168:171], a[4:7], 0
s_and_b32 s9, s81, 0xffff
v_mfma_f32_16x16x32_bf16 v[112:115], a[168:171], a[8:11], 0
s_waitcnt lgkmcnt(8)
v_mfma_f32_16x16x32_bf16 v[124:127], a[172:175], a[8:11], 0
s_mov_b32 s10, 393216
v_mfma_f32_16x16x32_bf16 v[120:123], a[172:175], a[4:7], 0
s_mov_b32 s11, 0x00020000
v_mfma_f32_16x16x32_bf16 v[116:119], a[172:175], a[0:3], 0
s_waitcnt lgkmcnt(6)
v_mfma_f32_16x16x32_bf16 v[128:131], a[176:179], a[0:3], 0
s_waitcnt vmcnt(12)
s_waitcnt lgkmcnt(0)
s_mov_b32 s20, s90
v_mfma_f32_16x16x32_bf16 v[132:135], a[176:179], a[4:7], 0
s_barrier
s_and_b32 s21, s91, 0xffff
v_mfma_f32_16x16x32_bf16 v[136:139], a[176:179], a[8:11], 0
ds_read_b64_tr_b16 a[144:145], v252 offset:0
ds_read_b64_tr_b16 a[146:147], v252 offset:6144
v_mfma_f32_16x16x32_bf16 v[148:151], a[180:183], a[8:11], 0
s_add_u32 m0, s37, 135168
ds_read_b64_tr_b16 a[148:149], v253 offset:0
ds_read_b64_tr_b16 a[150:151], v253 offset:6144
v_mfma_f32_16x16x32_bf16 v[144:147], a[180:183], a[4:7], 0
s_mov_b32 s22, 42991616
buffer_load_dwordx4 v8, s[12:15], s43 offen offset:0  lds
v_mfma_f32_16x16x32_bf16 v[140:143], a[180:183], a[0:3], 0
v_mfma_f32_16x16x32_bf16 v[152:155], a[184:187], a[0:3], 0
s_mov_b32 s23, 0x00020000
ds_read_b64_tr_b16 a[152:153], v254 offset:0
ds_read_b64_tr_b16 a[154:155], v254 offset:6144
v_mfma_f32_16x16x32_bf16 v[156:159], a[184:187], a[4:7], 0
s_mov_b32 s24, s84
buffer_load_dwordx4 v9, s[12:15], s43 offen offset:1024  lds
v_mfma_f32_16x16x32_bf16 v[160:163], a[184:187], a[8:11], 0
ds_read_b64_tr_b16 a[156:157], v255 offset:0
ds_read_b64_tr_b16 a[158:159], v255 offset:6144
v_mfma_f32_16x16x32_bf16 v[172:175], a[188:191], a[8:11], 0
s_and_b32 s25, s85, 0xffff
buffer_load_dwordx4 v10, s[12:15], s43 offen offset:2048  lds
v_mfma_f32_16x16x32_bf16 v[168:171], a[188:191], a[4:7], 0
s_add_u32 s43, s43, 393216
s_cmp_ge_u32 s43, 7864320
s_cselect_b32 s43, 0, s43
v_mfma_f32_16x16x32_bf16 v[164:167], a[188:191], a[0:3], 0
s_waitcnt lgkmcnt(6)
ds_read_b64_tr_b16 a[160:161], v252 offset:128
ds_read_b64_tr_b16 a[162:163], v252 offset:6272
v_mfma_f32_16x16x32_bf16 v[32:35], a[144:147], a[12:15], v[32:35]
s_add_u32 m0, s37, 147456
s_mov_b32 s26, 7864320
s_mov_b32 s27, 0x00020000
v_mfma_f32_16x16x32_bf16 v[36:39], a[144:147], a[16:19], v[36:39]
s_mov_b32 s28, s86
ds_read_b64_tr_b16 a[164:165], v253 offset:128
ds_read_b64_tr_b16 a[166:167], v253 offset:6272
v_mfma_f32_16x16x32_bf16 v[40:43], a[144:147], a[20:23], v[40:43]
s_waitcnt lgkmcnt(8)
buffer_load_dwordx4 v8, s[12:15], s43 offen offset:0  lds
v_mfma_f32_16x16x32_bf16 v[52:55], a[148:151], a[20:23], v[52:55]
s_and_b32 s29, s87, 0xffff
v_add_u32 v25, 110592, v19
v_add_u32 v26, 110592, v20
v_add_u32 v27, 110592, v21
v_mfma_f32_16x16x32_bf16 v[48:51], a[148:151], a[16:19], v[48:51]
s_mov_b32 s30, 1966080
buffer_load_dwordx4 v9, s[12:15], s43 offen offset:1024  lds
v_add_u32 v28, 110592, v22
v_mfma_f32_16x16x32_bf16 v[44:47], a[148:151], a[12:15], v[44:47]
s_waitcnt lgkmcnt(6)
ds_read_b64_tr_b16 a[168:169], v254 offset:128
ds_read_b64_tr_b16 a[170:171], v254 offset:6272
v_mfma_f32_16x16x32_bf16 v[56:59], a[152:155], a[12:15], v[56:59]
s_mov_b32 s31, 0x00020000
buffer_load_dwordx4 v10, s[12:15], s43 offen offset:2048  lds
v_mfma_f32_16x16x32_bf16 v[60:63], a[152:155], a[16:19], v[60:63]
s_add_u32 s43, s43, 393216
s_cmp_ge_u32 s43, 7864320
s_cselect_b32 s43, 0, s43
v_mfma_f32_16x16x32_bf16 v[64:67], a[152:155], a[20:23], v[64:67]
s_waitcnt lgkmcnt(6)
ds_read_b64_tr_b16 a[172:173], v255 offset:128
ds_read_b64_tr_b16 a[174:175], v255 offset:6272
v_mfma_f32_16x16x32_bf16 v[76:79], a[156:159], a[20:23], v[76:79]
s_waitcnt vmcnt(9)
ds_read_b64_tr_b16 a[176:177], v252 offset:256
ds_read_b64_tr_b16 a[178:179], v252 offset:6400
v_mfma_f32_16x16x32_bf16 v[72:75], a[156:159], a[16:19], v[72:75]
ds_read_b128 a[24:27], v29 offset:0
ds_read_b128 a[28:31], v29 offset:1024
v_mfma_f32_16x16x32_bf16 v[68:71], a[156:159], a[12:15], v[68:71]
s_waitcnt lgkmcnt(10)
ds_read_b128 a[32:35], v29 offset:2048
ds_read_b128 a[36:39], v30 offset:0
v_mfma_f32_16x16x32_bf16 v[80:83], a[160:163], a[12:15], v[80:83]
ds_read_b128 a[40:43], v30 offset:1024
ds_read_b128 a[44:47], v30 offset:2048
v_mfma_f32_16x16x32_bf16 v[84:87], a[160:163], a[16:19], v[84:87]
ds_read_b64_tr_b16 a[180:181], v253 offset:256
ds_read_b64_tr_b16 a[182:183], v253 offset:6400
v_mfma_f32_16x16x32_bf16 v[88:91], a[160:163], a[20:23], v[88:91]
s_waitcnt lgkmcnt(14)
ds_read_b64_tr_b16 a[184:185], v254 offset:256
ds_read_b64_tr_b16 a[186:187], v254 offset:6400
v_mfma_f32_16x16x32_bf16 v[100:103], a[164:167], a[20:23], v[100:103]
v_add_u32 v242, 0, v240
v_mul_u32_u24 v243, 11, v242
v_mfma_f32_16x16x32_bf16 v[96:99], a[164:167], a[16:19], v[96:99]
ds_read_b64_tr_b16 a[188:189], v255 offset:256
ds_read_b64_tr_b16 a[190:191], v255 offset:6400
v_mfma_f32_16x16x32_bf16 v[92:95], a[164:167], a[12:15], v[92:95]
s_waitcnt lgkmcnt(6)
v_accvgpr_read_b32 v31, a44
v_lshrrev_b32 v243, 5, v243
v_mfma_f32_16x16x32_bf16 v[104:107], a[168:171], a[12:15], v[104:107]
s_add_u32 m0, s37, 73728
v_mul_u32_u24 v244, 3, v243
v_sub_u32 v244, v242, v244
v_mfma_f32_16x16x32_bf16 v[108:111], a[168:171], a[16:19], v[108:111]
buffer_load_dwordx4 v11, s[16:19], s44 offen offset:0 lds
v_mfma_f32_16x16x32_bf16 v[112:115], a[168:171], a[20:23], v[112:115]
v_add_u32 v243, s46, v243
v_and_b32 v245, 6, v243
v_mfma_f32_16x16x32_bf16 v[124:127], a[172:175], a[20:23], v[124:127]
buffer_load_dwordx4 v13, s[16:19], s44 offen offset:1024 lds
v_mfma_f32_16x16x32_bf16 v[120:123], a[172:175], a[16:19], v[120:123]
v_xor_b32 v245, v245, v241
v_lshlrev_b32 v245, 4, v245
v_mfma_f32_16x16x32_bf16 v[116:119], a[172:175], a[12:15], v[116:119]
buffer_load_dwordx4 v15, s[16:19], s44 offen offset:2048 lds
v_mfma_f32_16x16x32_bf16 v[128:131], a[176:179], a[12:15], v[128:131]
s_waitcnt lgkmcnt(0)
s_add_u32 m0, s37, 86016
v_mfma_f32_16x16x32_bf16 v[132:135], a[176:179], a[16:19], v[132:135]
s_barrier
v_lshrrev_b32 v247, 5, v243
v_mfma_f32_16x16x32_bf16 v[136:139], a[176:179], a[20:23], v[136:139]
ds_read_b64_tr_b16 a[144:145], v25 offset:0
ds_read_b64_tr_b16 a[146:147], v25 offset:6144
v_mfma_f32_16x16x32_bf16 v[148:151], a[180:183], a[20:23], v[148:151]
ds_read_b64_tr_b16 a[148:149], v26 offset:0
ds_read_b64_tr_b16 a[150:151], v26 offset:6144
v_mfma_f32_16x16x32_bf16 v[144:147], a[180:183], a[16:19], v[144:147]
buffer_load_dwordx4 v12, s[16:19], s44 offen offset:0 lds
v_mfma_f32_16x16x32_bf16 v[140:143], a[180:183], a[12:15], v[140:143]
v_lshlrev_b32 v247, 10, v247
v_and_b32 v246, 31, v243
v_mfma_f32_16x16x32_bf16 v[152:155], a[184:187], a[12:15], v[152:155]
ds_read_b64_tr_b16 a[152:153], v27 offset:0
ds_read_b64_tr_b16 a[154:155], v27 offset:6144
v_mfma_f32_16x16x32_bf16 v[156:159], a[184:187], a[16:19], v[156:159]
buffer_load_dwordx4 v14, s[16:19], s44 offen offset:1024 lds
v_mfma_f32_16x16x32_bf16 v[160:163], a[184:187], a[20:23], v[160:163]
ds_read_b64_tr_b16 a[156:157], v28 offset:0
ds_read_b64_tr_b16 a[158:159], v28 offset:6144
v_add_u32 v252, 122880, v19
v_mfma_f32_16x16x32_bf16 v[172:175], a[188:191], a[20:23], v[172:175]
buffer_load_dwordx4 v16, s[16:19], s44 offen offset:2048 lds
v_add_u32 v253, 122880, v20
v_mfma_f32_16x16x32_bf16 v[168:171], a[188:191], a[16:19], v[168:171]
s_add_u32 s44, s44, 128
s_cmp_ge_u32 s44, 1280
s_cselect_b32 s44, 0, s44
v_add_u32 v254, 122880, v21
v_mfma_f32_16x16x32_bf16 v[164:167], a[188:191], a[12:15], v[164:167]
s_waitcnt lgkmcnt(6)
ds_read_b64_tr_b16 a[160:161], v25 offset:128
ds_read_b64_tr_b16 a[162:163], v25 offset:6272
v_add_u32 v255, 122880, v22
v_mfma_f32_16x16x32_bf16 v[32:35], a[144:147], a[24:27], v[32:35]
s_add_u32 m0, s37, 12288
v_add_u32 v247, v247, v246
v_mul_u32_u24 v247, 384, v247
v_mfma_f32_16x16x32_bf16 v[36:39], a[144:147], a[28:31], v[36:39]
ds_read_b64_tr_b16 a[164:165], v26 offset:128
ds_read_b64_tr_b16 a[166:167], v26 offset:6272
v_mfma_f32_16x16x32_bf16 v[40:43], a[144:147], a[32:35], v[40:43]
s_waitcnt lgkmcnt(8)
buffer_load_dwordx4 v8, s[12:15], s43 offen offset:0  lds
v_mfma_f32_16x16x32_bf16 v[52:55], a[148:151], a[32:35], v[52:55]
v_lshl_add_u32 v247, v244, 7, v247
v_subrev_u32 v247, 0, v247
v_mfma_f32_16x16x32_bf16 v[48:51], a[148:151], a[28:31], v[48:51]
ds_read_b64_tr_b16 a[168:169], v27 offset:128
ds_read_b64_tr_b16 a[170:171], v27 offset:6272
v_mfma_f32_16x16x32_bf16 v[44:47], a[148:151], a[24:27], v[44:47]
s_waitcnt lgkmcnt(8)
buffer_load_dwordx4 v9, s[12:15], s43 offen offset:1024  lds
v_mfma_f32_16x16x32_bf16 v[56:59], a[152:155], a[24:27], v[56:59]
ds_read_b64_tr_b16 a[172:173], v28 offset:128
ds_read_b64_tr_b16 a[174:175], v28 offset:6272
v_mfma_f32_16x16x32_bf16 v[60:63], a[152:155], a[28:31], v[60:63]
buffer_load_dwordx4 v10, s[12:15], s43 offen offset:2048  lds
v_mfma_f32_16x16x32_bf16 v[64:67], a[152:155], a[32:35], v[64:67]
s_waitcnt lgkmcnt(8)
v_add_u32 v5, v247, v245
v_bfe_u32 v245, v243, 2, 1
v_mfma_f32_16x16x32_bf16 v[76:79], a[156:159], a[32:35], v[76:79]
s_add_u32 s43, s43, 393216
ds_read_b64_tr_b16 a[176:177], v25 offset:256
ds_read_b64_tr_b16 a[178:179], v25 offset:6400
v_mfma_f32_16x16x32_bf16 v[72:75], a[156:159], a[28:31], v[72:75]
s_cmp_ge_u32 s43, 7864320
s_cselect_b32 s43, 0, s43
v_and_b32 v246, 2, v243
v_mfma_f32_16x16x32_bf16 v[68:71], a[156:159], a[24:27], v[68:71]
s_waitcnt lgkmcnt(8)
ds_read_b64_tr_b16 a[180:181], v26 offset:256
ds_read_b64_tr_b16 a[182:183], v26 offset:6400
v_mfma_f32_16x16x32_bf16 v[80:83], a[160:163], a[24:27], v[80:83]
s_add_u32 m0, s37, 49152
v_or_b32 v245, v245, v246
v_lshrrev_b32 v246, 1, v243
v_mfma_f32_16x16x32_bf16 v[84:87], a[160:163], a[28:31], v[84:87]
buffer_load_dwordx4 v11, s[16:19], s44 offen offset:0 lds
v_mfma_f32_16x16x32_bf16 v[88:91], a[160:163], a[32:35], v[88:91]
s_waitcnt lgkmcnt(8)
ds_read_b64_tr_b16 a[184:185], v27 offset:256
ds_read_b64_tr_b16 a[186:187], v27 offset:6400
v_mfma_f32_16x16x32_bf16 v[100:103], a[164:167], a[32:35], v[100:103]
buffer_load_dwordx4 v13, s[16:19], s44 offen offset:1024 lds
v_mfma_f32_16x16x32_bf16 v[96:99], a[164:167], a[28:31], v[96:99]
ds_read_b64_tr_b16 a[188:189], v28 offset:256
ds_read_b64_tr_b16 a[190:191], v28 offset:6400
v_mfma_f32_16x16x32_bf16 v[92:95], a[164:167], a[24:27], v[92:95]
s_waitcnt lgkmcnt(10)
buffer_load_dwordx4 v15, s[16:19], s44 offen offset:2048 lds
v_mfma_f32_16x16x32_bf16 v[104:107], a[168:171], a[24:27], v[104:107]
s_add_u32 m0, s37, 61440
v_and_b32 v246, 4, v246
v_or_b32 v245, v245, v246
v_mfma_f32_16x16x32_bf16 v[108:111], a[168:171], a[28:31], v[108:111]
buffer_load_dwordx4 v12, s[16:19], s44 offen offset:0 lds
v_mfma_f32_16x16x32_bf16 v[112:115], a[168:171], a[32:35], v[112:115]
s_waitcnt lgkmcnt(8)
v_xor_b32 v245, v245, v241
v_lshl_add_u32 v2, v245, 4, v247
v_mfma_f32_16x16x32_bf16 v[124:127], a[172:175], a[32:35], v[124:127]
buffer_load_dwordx4 v14, s[16:19], s44 offen offset:1024 lds
v_mfma_f32_16x16x32_bf16 v[120:123], a[172:175], a[28:31], v[120:123]
v_add_u32 v242, 8, v240
v_mul_u32_u24 v243, 11, v242
v_mfma_f32_16x16x32_bf16 v[116:119], a[172:175], a[24:27], v[116:119]
s_waitcnt lgkmcnt(6)
buffer_load_dwordx4 v16, s[16:19], s44 offen offset:2048 lds
v_mfma_f32_16x16x32_bf16 v[128:131], a[176:179], a[24:27], v[128:131]
s_waitcnt vmcnt(21)
s_waitcnt lgkmcnt(0)
s_add_u32 s44, s44, 128
v_mfma_f32_16x16x32_bf16 v[132:135], a[176:179], a[28:31], v[132:135]
s_barrier
v_lshrrev_b32 v243, 5, v243
v_mfma_f32_16x16x32_bf16 v[136:139], a[176:179], a[32:35], v[136:139]
ds_read_b64_tr_b16 a[144:145], v252 offset:0
ds_read_b64_tr_b16 a[146:147], v252 offset:6144
v_mfma_f32_16x16x32_bf16 v[148:151], a[180:183], a[32:35], v[148:151]
ds_read_b64_tr_b16 a[148:149], v253 offset:0
ds_read_b64_tr_b16 a[150:151], v253 offset:6144
v_mfma_f32_16x16x32_bf16 v[144:147], a[180:183], a[28:31], v[144:147]
s_cmp_ge_u32 s44, 1280
s_cselect_b32 s44, 0, s44
v_mul_u32_u24 v244, 3, v243
v_mfma_f32_16x16x32_bf16 v[140:143], a[180:183], a[24:27], v[140:143]
v_sub_u32 v244, v242, v244
v_add_u32 v243, s46, v243
v_mfma_f32_16x16x32_bf16 v[152:155], a[184:187], a[24:27], v[152:155]
s_add_u32 m0, s37, 98304
ds_read_b64_tr_b16 a[152:153], v254 offset:0
ds_read_b64_tr_b16 a[154:155], v254 offset:6144
v_mfma_f32_16x16x32_bf16 v[156:159], a[184:187], a[28:31], v[156:159]
buffer_load_dwordx4 v8, s[12:15], s43 offen offset:0  lds
v_mfma_f32_16x16x32_bf16 v[160:163], a[184:187], a[32:35], v[160:163]
ds_read_b64_tr_b16 a[156:157], v255 offset:0
ds_read_b64_tr_b16 a[158:159], v255 offset:6144
v_add_u32 v25, 135168, v19
v_mfma_f32_16x16x32_bf16 v[172:175], a[188:191], a[32:35], v[172:175]
buffer_load_dwordx4 v9, s[12:15], s43 offen offset:1024  lds
v_add_u32 v26, 135168, v20
v_mfma_f32_16x16x32_bf16 v[168:171], a[188:191], a[28:31], v[168:171]
v_and_b32 v245, 6, v243
v_xor_b32 v245, v245, v241
v_add_u32 v27, 135168, v21
v_mfma_f32_16x16x32_bf16 v[164:167], a[188:191], a[24:27], v[164:167]
s_waitcnt lgkmcnt(6)
ds_read_b64_tr_b16 a[160:161], v252 offset:128
ds_read_b64_tr_b16 a[162:163], v252 offset:6272
v_add_u32 v28, 135168, v22
v_mfma_f32_16x16x32_bf16 v[32:35], a[144:147], a[36:39], v[32:35]
buffer_load_dwordx4 v10, s[12:15], s43 offen offset:2048  lds
v_mfma_f32_16x16x32_bf16 v[36:39], a[144:147], a[40:43], v[36:39]
s_add_u32 s43, s43, 393216
ds_read_b64_tr_b16 a[164:165], v253 offset:128
ds_read_b64_tr_b16 a[166:167], v253 offset:6272
v_mfma_f32_16x16x32_bf16 v[40:43], a[144:147], a[44:47], v[40:43]
s_waitcnt lgkmcnt(8)
s_cmp_ge_u32 s43, 7864320
s_cselect_b32 s43, 0, s43
v_mfma_f32_16x16x32_bf16 v[52:55], a[148:151], a[44:47], v[52:55]
s_waitcnt vmcnt(12)
v_lshlrev_b32 v245, 4, v245
v_lshrrev_b32 v247, 5, v243
v_mfma_f32_16x16x32_bf16 v[48:51], a[148:151], a[40:43], v[48:51]
ds_read_b128 a[48:51], v29 offset:24576
ds_read_b64_tr_b16 a[168:169], v254 offset:128
v_mfma_f32_16x16x32_bf16 v[44:47], a[148:151], a[36:39], v[44:47]
s_waitcnt lgkmcnt(8)
ds_read_b64_tr_b16 a[170:171], v254 offset:6272
ds_read_b128 a[52:55], v29 offset:25600
v_mfma_f32_16x16x32_bf16 v[56:59], a[152:155], a[36:39], v[56:59]
ds_read_b128 a[56:59], v29 offset:26624
ds_read_b64_tr_b16 a[172:173], v255 offset:128
v_mfma_f32_16x16x32_bf16 v[60:63], a[152:155], a[40:43], v[60:63]
ds_read_b64_tr_b16 a[174:175], v255 offset:6272
ds_read_b128 a[60:63], v30 offset:24576
v_mfma_f32_16x16x32_bf16 v[64:67], a[152:155], a[44:47], v[64:67]
s_waitcnt lgkmcnt(12)
ds_read_b128 a[64:67], v30 offset:25600
v_lshlrev_b32 v247, 10, v247
v_mfma_f32_16x16x32_bf16 v[76:79], a[156:159], a[44:47], v[76:79]
ds_read_b64_tr_b16 a[176:177], v252 offset:256
ds_read_b64_tr_b16 a[178:179], v252 offset:6400
v_mfma_f32_16x16x32_bf16 v[72:75], a[156:159], a[40:43], v[72:75]
ds_read_b128 a[68:71], v30 offset:26624
v_and_b32 v246, 31, v243
v_mfma_f32_16x16x32_bf16 v[68:71], a[156:159], a[36:39], v[68:71]
s_waitcnt lgkmcnt(14)
ds_read_b64_tr_b16 a[180:181], v253 offset:256
ds_read_b64_tr_b16 a[182:183], v253 offset:6400
v_mfma_f32_16x16x32_bf16 v[80:83], a[160:163], a[36:39], v[80:83]
v_add_u32 v247, v247, v246
v_mul_u32_u24 v247, 384, v247
v_mfma_f32_16x16x32_bf16 v[84:87], a[160:163], a[40:43], v[84:87]
v_lshl_add_u32 v247, v244, 7, v247
v_subrev_u32 v247, 1024, v247
v_mfma_f32_16x16x32_bf16 v[88:91], a[160:163], a[44:47], v[88:91]
s_waitcnt lgkmcnt(14)
ds_read_b64_tr_b16 a[184:185], v254 offset:256
ds_read_b64_tr_b16 a[186:187], v254 offset:6400
v_mfma_f32_16x16x32_bf16 v[100:103], a[164:167], a[44:47], v[100:103]
s_waitcnt lgkmcnt(4)
v_accvgpr_read_b32 v31, a68
v_add_u32 v6, v247, v245
v_mfma_f32_16x16x32_bf16 v[96:99], a[164:167], a[40:43], v[96:99]
s_add_u32 m0, s37, 73728
ds_read_b64_tr_b16 a[188:189], v255 offset:256
ds_read_b64_tr_b16 a[190:191], v255 offset:6400
v_mfma_f32_16x16x32_bf16 v[92:95], a[164:167], a[36:39], v[92:95]
buffer_load_dwordx4 v11, s[16:19], s44 offen offset:0 lds
v_mfma_f32_16x16x32_bf16 v[104:107], a[168:171], a[36:39], v[104:107]
v_bfe_u32 v245, v243, 2, 1
v_and_b32 v246, 2, v243
v_mfma_f32_16x16x32_bf16 v[108:111], a[168:171], a[40:43], v[108:111]
buffer_load_dwordx4 v13, s[16:19], s44 offen offset:1024 lds
v_mfma_f32_16x16x32_bf16 v[112:115], a[168:171], a[44:47], v[112:115]
v_or_b32 v245, v245, v246
v_lshrrev_b32 v246, 1, v243
v_mfma_f32_16x16x32_bf16 v[124:127], a[172:175], a[44:47], v[124:127]
buffer_load_dwordx4 v15, s[16:19], s44 offen offset:2048 lds
v_mfma_f32_16x16x32_bf16 v[120:123], a[172:175], a[40:43], v[120:123]
s_add_u32 m0, s37, 86016
v_and_b32 v246, 4, v246
v_or_b32 v245, v245, v246
v_mfma_f32_16x16x32_bf16 v[116:119], a[172:175], a[36:39], v[116:119]
buffer_load_dwordx4 v12, s[16:19], s44 offen offset:0 lds
v_mfma_f32_16x16x32_bf16 v[128:131], a[176:179], a[36:39], v[128:131]
s_waitcnt lgkmcnt(0)
v_xor_b32 v245, v245, v241
v_mfma_f32_16x16x32_bf16 v[132:135], a[176:179], a[40:43], v[132:135]
s_barrier
v_lshl_add_u32 v3, v245, 4, v247
v_mfma_f32_16x16x32_bf16 v[136:139], a[176:179], a[44:47], v[136:139]
ds_read_b64_tr_b16 a[144:145], v25 offset:0
ds_read_b64_tr_b16 a[146:147], v25 offset:6144
v_mfma_f32_16x16x32_bf16 v[148:151], a[180:183], a[44:47], v[148:151]
ds_read_b64_tr_b16 a[148:149], v26 offset:0
ds_read_b64_tr_b16 a[150:151], v26 offset:6144
v_mfma_f32_16x16x32_bf16 v[144:147], a[180:183], a[40:43], v[144:147]
buffer_load_dwordx4 v14, s[16:19], s44 offen offset:1024 lds
v_mfma_f32_16x16x32_bf16 v[140:143], a[180:183], a[36:39], v[140:143]
v_add_u32 v242, 16, v240
v_mul_u32_u24 v243, 11, v242
v_mfma_f32_16x16x32_bf16 v[152:155], a[184:187], a[36:39], v[152:155]
ds_read_b64_tr_b16 a[152:153], v27 offset:0
ds_read_b64_tr_b16 a[154:155], v27 offset:6144
v_mfma_f32_16x16x32_bf16 v[156:159], a[184:187], a[40:43], v[156:159]
buffer_load_dwordx4 v16, s[16:19], s44 offen offset:2048 lds
v_mfma_f32_16x16x32_bf16 v[160:163], a[184:187], a[44:47], v[160:163]
ds_read_b64_tr_b16 a[156:157], v28 offset:0
ds_read_b64_tr_b16 a[158:159], v28 offset:6144
v_add_u32 v252, 147456, v19
v_mfma_f32_16x16x32_bf16 v[172:175], a[188:191], a[44:47], v[172:175]
s_add_u32 s44, s44, 128
s_cmp_ge_u32 s44, 1280
s_cselect_b32 s44, 0, s44
v_add_u32 v253, 147456, v20
v_mfma_f32_16x16x32_bf16 v[168:171], a[188:191], a[40:43], v[168:171]
s_add_u32 m0, s37, 110592
v_lshrrev_b32 v243, 5, v243
v_mul_u32_u24 v244, 3, v243
v_add_u32 v254, 147456, v21
v_mfma_f32_16x16x32_bf16 v[164:167], a[188:191], a[36:39], v[164:167]
s_waitcnt lgkmcnt(6)
ds_read_b64_tr_b16 a[160:161], v25 offset:128
ds_read_b64_tr_b16 a[162:163], v25 offset:6272
v_add_u32 v255, 147456, v22
v_mfma_f32_16x16x32_bf16 v[32:35], a[144:147], a[48:51], v[32:35]
buffer_load_dwordx4 v8, s[12:15], s43 offen offset:0  lds
v_mfma_f32_16x16x32_bf16 v[36:39], a[144:147], a[52:55], v[36:39]
ds_read_b64_tr_b16 a[164:165], v26 offset:128
ds_read_b64_tr_b16 a[166:167], v26 offset:6272
v_mfma_f32_16x16x32_bf16 v[40:43], a[144:147], a[56:59], v[40:43]
s_waitcnt lgkmcnt(8)
buffer_load_dwordx4 v9, s[12:15], s43 offen offset:1024  lds
v_mfma_f32_16x16x32_bf16 v[52:55], a[148:151], a[56:59], v[52:55]
v_sub_u32 v244, v242, v244
v_add_u32 v243, s46, v243
v_mfma_f32_16x16x32_bf16 v[48:51], a[148:151], a[52:55], v[48:51]
buffer_load_dwordx4 v10, s[12:15], s43 offen offset:2048  lds
v_mfma_f32_16x16x32_bf16 v[44:47], a[148:151], a[48:51], v[44:47]
s_waitcnt lgkmcnt(6)
ds_read_b64_tr_b16 a[168:169], v27 offset:128
ds_read_b64_tr_b16 a[170:171], v27 offset:6272
v_mfma_f32_16x16x32_bf16 v[56:59], a[152:155], a[48:51], v[56:59]
s_add_u32 s43, s43, 393216
s_cmp_ge_u32 s43, 7864320
s_cselect_b32 s43, 0, s43
v_mfma_f32_16x16x32_bf16 v[60:63], a[152:155], a[52:55], v[60:63]
s_waitcnt vmcnt(12)
ds_read_b64_tr_b16 a[172:173], v28 offset:128
ds_read_b64_tr_b16 a[174:175], v28 offset:6272
v_mfma_f32_16x16x32_bf16 v[64:67], a[152:155], a[56:59], v[64:67]
s_waitcnt lgkmcnt(8)
ds_read_b128 a[72:75], v29 offset:0
ds_read_b128 a[76:79], v29 offset:1024
v_mfma_f32_16x16x32_bf16 v[76:79], a[156:159], a[56:59], v[76:79]
ds_read_b128 a[80:83], v29 offset:2048
ds_read_b128 a[84:87], v30 offset:0
v_mfma_f32_16x16x32_bf16 v[72:75], a[156:159], a[52:55], v[72:75]
ds_read_b128 a[88:91], v30 offset:1024
ds_read_b64_tr_b16 a[176:177], v25 offset:256
v_mfma_f32_16x16x32_bf16 v[68:71], a[156:159], a[48:51], v[68:71]
s_waitcnt lgkmcnt(12)
ds_read_b64_tr_b16 a[178:179], v25 offset:6400
ds_read_b128 a[92:95], v30 offset:2048
v_mfma_f32_16x16x32_bf16 v[80:83], a[160:163], a[48:51], v[80:83]
ds_read_b64_tr_b16 a[180:181], v26 offset:256
ds_read_b64_tr_b16 a[182:183], v26 offset:6400
v_mfma_f32_16x16x32_bf16 v[84:87], a[160:163], a[52:55], v[84:87]
v_and_b32 v245, 6, v243
v_xor_b32 v245, v245, v241
v_mfma_f32_16x16x32_bf16 v[88:91], a[160:163], a[56:59], v[88:91]
s_waitcnt lgkmcnt(14)
ds_read_b64_tr_b16 a[184:185], v27 offset:256
ds_read_b64_tr_b16 a[186:187], v27 offset:6400
v_mfma_f32_16x16x32_bf16 v[100:103], a[164:167], a[56:59], v[100:103]
s_waitcnt lgkmcnt(4)
v_accvgpr_read_b32 v31, a92
v_lshlrev_b32 v245, 4, v245
v_mfma_f32_16x16x32_bf16 v[96:99], a[164:167], a[52:55], v[96:99]
s_add_u32 m0, s37, 49152
ds_read_b64_tr_b16 a[188:189], v28 offset:256
ds_read_b64_tr_b16 a[190:191], v28 offset:6400
v_mfma_f32_16x16x32_bf16 v[92:95], a[164:167], a[48:51], v[92:95]
buffer_load_dwordx4 v11, s[16:19], s44 offen offset:0 lds
v_mfma_f32_16x16x32_bf16 v[104:107], a[168:171], a[48:51], v[104:107]
v_lshrrev_b32 v247, 5, v243
v_lshlrev_b32 v247, 10, v247
v_mfma_f32_16x16x32_bf16 v[108:111], a[168:171], a[52:55], v[108:111]
buffer_load_dwordx4 v13, s[16:19], s44 offen offset:1024 lds
v_mfma_f32_16x16x32_bf16 v[112:115], a[168:171], a[56:59], v[112:115]
v_and_b32 v246, 31, v243
v_add_u32 v247, v247, v246
v_mfma_f32_16x16x32_bf16 v[124:127], a[172:175], a[56:59], v[124:127]
buffer_load_dwordx4 v15, s[16:19], s44 offen offset:2048 lds
v_mfma_f32_16x16x32_bf16 v[120:123], a[172:175], a[52:55], v[120:123]
s_add_u32 m0, s37, 61440
v_mul_u32_u24 v247, 384, v247
v_lshl_add_u32 v247, v244, 7, v247
v_mfma_f32_16x16x32_bf16 v[116:119], a[172:175], a[48:51], v[116:119]
buffer_load_dwordx4 v12, s[16:19], s44 offen offset:0 lds
v_mfma_f32_16x16x32_bf16 v[128:131], a[176:179], a[48:51], v[128:131]
s_waitcnt lgkmcnt(0)
v_subrev_u32 v247, 2048, v247
v_mfma_f32_16x16x32_bf16 v[132:135], a[176:179], a[52:55], v[132:135]
s_barrier
v_add_u32 v7, v247, v245
v_mfma_f32_16x16x32_bf16 v[136:139], a[176:179], a[56:59], v[136:139]
ds_read_b64_tr_b16 a[144:145], v252 offset:0
ds_read_b64_tr_b16 a[146:147], v252 offset:6144
v_mfma_f32_16x16x32_bf16 v[148:151], a[180:183], a[56:59], v[148:151]
ds_read_b64_tr_b16 a[148:149], v253 offset:0
ds_read_b64_tr_b16 a[150:151], v253 offset:6144
v_mfma_f32_16x16x32_bf16 v[144:147], a[180:183], a[52:55], v[144:147]
buffer_load_dwordx4 v14, s[16:19], s44 offen offset:1024 lds
v_mfma_f32_16x16x32_bf16 v[140:143], a[180:183], a[48:51], v[140:143]
v_bfe_u32 v245, v243, 2, 1
v_and_b32 v246, 2, v243
v_mfma_f32_16x16x32_bf16 v[152:155], a[184:187], a[48:51], v[152:155]
ds_read_b64_tr_b16 a[152:153], v254 offset:0
ds_read_b64_tr_b16 a[154:155], v254 offset:6144
v_mfma_f32_16x16x32_bf16 v[156:159], a[184:187], a[52:55], v[156:159]
buffer_load_dwordx4 v16, s[16:19], s44 offen offset:2048 lds
v_mfma_f32_16x16x32_bf16 v[160:163], a[184:187], a[56:59], v[160:163]
ds_read_b64_tr_b16 a[156:157], v255 offset:0
ds_read_b64_tr_b16 a[158:159], v255 offset:6144
v_mfma_f32_16x16x32_bf16 v[172:175], a[188:191], a[56:59], v[172:175]
s_add_u32 s44, s44, 128
s_cmp_ge_u32 s44, 1280
s_cselect_b32 s44, 0, s44
v_mfma_f32_16x16x32_bf16 v[168:171], a[188:191], a[52:55], v[168:171]
s_add_u32 m0, s37, 122880
v_or_b32 v245, v245, v246
v_lshrrev_b32 v246, 1, v243
v_mfma_f32_16x16x32_bf16 v[164:167], a[188:191], a[48:51], v[164:167]
s_waitcnt lgkmcnt(6)
ds_read_b64_tr_b16 a[160:161], v252 offset:128
ds_read_b64_tr_b16 a[162:163], v252 offset:6272
v_mfma_f32_16x16x32_bf16 v[32:35], a[144:147], a[60:63], v[32:35]
buffer_load_dwordx4 v8, s[12:15], s43 offen offset:0  lds
v_mfma_f32_16x16x32_bf16 v[36:39], a[144:147], a[64:67], v[36:39]
ds_read_b64_tr_b16 a[164:165], v253 offset:128
ds_read_b64_tr_b16 a[166:167], v253 offset:6272
v_mfma_f32_16x16x32_bf16 v[40:43], a[144:147], a[68:71], v[40:43]
s_waitcnt lgkmcnt(8)
buffer_load_dwordx4 v9, s[12:15], s43 offen offset:1024  lds
v_mfma_f32_16x16x32_bf16 v[52:55], a[148:151], a[68:71], v[52:55]
v_and_b32 v246, 4, v246
v_or_b32 v245, v245, v246
v_mfma_f32_16x16x32_bf16 v[48:51], a[148:151], a[64:67], v[48:51]
buffer_load_dwordx4 v10, s[12:15], s43 offen offset:2048  lds
v_mfma_f32_16x16x32_bf16 v[44:47], a[148:151], a[60:63], v[44:47]
s_waitcnt lgkmcnt(6)
ds_read_b64_tr_b16 a[168:169], v254 offset:128
ds_read_b64_tr_b16 a[170:171], v254 offset:6272
v_mfma_f32_16x16x32_bf16 v[56:59], a[152:155], a[60:63], v[56:59]
s_add_u32 s43, s43, 393216
s_cmp_ge_u32 s43, 7864320
s_cselect_b32 s43, 0, s43
v_mfma_f32_16x16x32_bf16 v[60:63], a[152:155], a[64:67], v[60:63]
s_waitcnt vmcnt(12)
ds_read_b64_tr_b16 a[172:173], v255 offset:128
ds_read_b64_tr_b16 a[174:175], v255 offset:6272
v_mfma_f32_16x16x32_bf16 v[64:67], a[152:155], a[68:71], v[64:67]
s_waitcnt lgkmcnt(8)
ds_read_b128 a[96:99], v29 offset:24576
ds_read_b128 a[100:103], v29 offset:25600
v_mfma_f32_16x16x32_bf16 v[76:79], a[156:159], a[68:71], v[76:79]
ds_read_b128 a[104:107], v29 offset:26624
ds_read_b128 a[108:111], v30 offset:24576
v_mfma_f32_16x16x32_bf16 v[72:75], a[156:159], a[64:67], v[72:75]
ds_read_b128 a[112:115], v30 offset:25600
ds_read_b64_tr_b16 a[176:177], v252 offset:256
v_mfma_f32_16x16x32_bf16 v[68:71], a[156:159], a[60:63], v[68:71]
s_waitcnt lgkmcnt(12)
ds_read_b64_tr_b16 a[178:179], v252 offset:6400
ds_read_b128 a[116:119], v30 offset:26624
v_mfma_f32_16x16x32_bf16 v[80:83], a[160:163], a[60:63], v[80:83]
ds_read_b64_tr_b16 a[180:181], v253 offset:256
ds_read_b64_tr_b16 a[182:183], v253 offset:6400
v_mfma_f32_16x16x32_bf16 v[84:87], a[160:163], a[64:67], v[84:87]
v_xor_b32 v245, v245, v241
v_lshl_add_u32 v4, v245, 4, v247
v_mfma_f32_16x16x32_bf16 v[88:91], a[160:163], a[68:71], v[88:91]
s_waitcnt lgkmcnt(14)
ds_read_b64_tr_b16 a[184:185], v254 offset:256
ds_read_b64_tr_b16 a[186:187], v254 offset:6400
v_mfma_f32_16x16x32_bf16 v[100:103], a[164:167], a[68:71], v[100:103]
s_mul_i32 s47, s35, 983040
s_mul_i32 s48, s36, 320
s_waitcnt lgkmcnt(4)
v_accvgpr_read_b32 v31, a116
v_mfma_f32_16x16x32_bf16 v[96:99], a[164:167], a[64:67], v[96:99]
s_add_u32 m0, s37, 73728
ds_read_b64_tr_b16 a[188:189], v255 offset:256
ds_read_b64_tr_b16 a[190:191], v255 offset:6400
v_mfma_f32_16x16x32_bf16 v[92:95], a[164:167], a[60:63], v[92:95]
buffer_load_dwordx4 v11, s[16:19], s44 offen offset:0 lds
v_mfma_f32_16x16x32_bf16 v[104:107], a[168:171], a[60:63], v[104:107]
s_mul_i32 s49, s32, 20480
v_add_u32 v25, 12288, v19
v_add_u32 v26, 12288, v20
v_add_u32 v27, 12288, v21
v_add_u32 v28, 12288, v22
v_mfma_f32_16x16x32_bf16 v[108:111], a[168:171], a[64:67], v[108:111]
s_add_u32 s49, s49, s47
buffer_load_dwordx4 v13, s[16:19], s44 offen offset:1024 lds
v_mfma_f32_16x16x32_bf16 v[112:115], a[168:171], a[68:71], v[112:115]
v_mfma_f32_16x16x32_bf16 v[124:127], a[172:175], a[68:71], v[124:127]
s_add_u32 s49, s49, s48
buffer_load_dwordx4 v15, s[16:19], s44 offen offset:2048 lds
v_mfma_f32_16x16x32_bf16 v[120:123], a[172:175], a[64:67], v[120:123]
s_add_u32 m0, s37, 86016
v_add_u32 v224, 0, v0
v_mul_u32_u24 v225, 205, v224
v_mfma_f32_16x16x32_bf16 v[116:119], a[172:175], a[60:63], v[116:119]
buffer_load_dwordx4 v12, s[16:19], s44 offen offset:0 lds
v_mfma_f32_16x16x32_bf16 v[128:131], a[176:179], a[60:63], v[128:131]
s_waitcnt lgkmcnt(0)
v_lshrrev_b32 v225, 12, v225
v_mfma_f32_16x16x32_bf16 v[132:135], a[176:179], a[64:67], v[132:135]
s_barrier
v_mul_u32_u24 v226, 20, v225
v_mfma_f32_16x16x32_bf16 v[136:139], a[176:179], a[68:71], v[136:139]
ds_read_b64_tr_b16 a[144:145], v25 offset:0
ds_read_b64_tr_b16 a[146:147], v25 offset:6144
v_mfma_f32_16x16x32_bf16 v[148:151], a[180:183], a[68:71], v[148:151]
ds_read_b64_tr_b16 a[148:149], v26 offset:0
ds_read_b64_tr_b16 a[150:151], v26 offset:6144
v_mfma_f32_16x16x32_bf16 v[144:147], a[180:183], a[64:67], v[144:147]
buffer_load_dwordx4 v14, s[16:19], s44 offen offset:1024 lds
v_mfma_f32_16x16x32_bf16 v[140:143], a[180:183], a[60:63], v[140:143]
v_sub_u32 v226, v224, v226
v_lshrrev_b32 v227, 1, v225
v_mfma_f32_16x16x32_bf16 v[152:155], a[184:187], a[60:63], v[152:155]
ds_read_b64_tr_b16 a[152:153], v27 offset:0
ds_read_b64_tr_b16 a[154:155], v27 offset:6144
v_mfma_f32_16x16x32_bf16 v[156:159], a[184:187], a[64:67], v[156:159]
buffer_load_dwordx4 v16, s[16:19], s44 offen offset:2048 lds
v_mfma_f32_16x16x32_bf16 v[160:163], a[184:187], a[68:71], v[160:163]
ds_read_b64_tr_b16 a[156:157], v28 offset:0
ds_read_b64_tr_b16 a[158:159], v28 offset:6144
v_add_u32 v252, 98304, v19
v_mfma_f32_16x16x32_bf16 v[172:175], a[188:191], a[68:71], v[172:175]
s_add_u32 s44, s44, 128
s_cmp_ge_u32 s44, 1280
s_cselect_b32 s44, 0, s44
v_add_u32 v253, 98304, v20
v_mfma_f32_16x16x32_bf16 v[168:171], a[188:191], a[64:67], v[168:171]
s_add_u32 m0, s37, 135168
v_and_b32 v227, 2, v227
v_xor_b32 v226, v226, v227
v_add_u32 v254, 98304, v21
v_mfma_f32_16x16x32_bf16 v[164:167], a[188:191], a[60:63], v[164:167]
s_waitcnt lgkmcnt(6)
ds_read_b64_tr_b16 a[160:161], v25 offset:128
ds_read_b64_tr_b16 a[162:163], v25 offset:6272
v_add_u32 v255, 98304, v22
v_mfma_f32_16x16x32_bf16 v[32:35], a[144:147], a[72:75], v[32:35]
buffer_load_dwordx4 v8, s[12:15], s43 offen offset:0  lds
v_mfma_f32_16x16x32_bf16 v[36:39], a[144:147], a[76:79], v[36:39]
ds_read_b64_tr_b16 a[164:165], v26 offset:128
ds_read_b64_tr_b16 a[166:167], v26 offset:6272
v_mfma_f32_16x16x32_bf16 v[40:43], a[144:147], a[80:83], v[40:43]
s_waitcnt lgkmcnt(8)
buffer_load_dwordx4 v9, s[12:15], s43 offen offset:1024  lds
v_mfma_f32_16x16x32_bf16 v[52:55], a[148:151], a[80:83], v[52:55]
v_mul_u32_u24 v225, 1280, v225
v_lshl_add_u32 v225, v226, 4, v225
v_mfma_f32_16x16x32_bf16 v[48:51], a[148:151], a[76:79], v[48:51]
buffer_load_dwordx4 v10, s[12:15], s43 offen offset:2048  lds
v_mfma_f32_16x16x32_bf16 v[44:47], a[148:151], a[72:75], v[44:47]
s_waitcnt lgkmcnt(6)
ds_read_b64_tr_b16 a[168:169], v27 offset:128
ds_read_b64_tr_b16 a[170:171], v27 offset:6272
v_mfma_f32_16x16x32_bf16 v[56:59], a[152:155], a[72:75], v[56:59]
s_add_u32 s43, s43, 393216
s_cmp_ge_u32 s43, 7864320
s_cselect_b32 s43, 0, s43
v_mfma_f32_16x16x32_bf16 v[60:63], a[152:155], a[76:79], v[60:63]
s_waitcnt vmcnt(12)
ds_read_b64_tr_b16 a[172:173], v28 offset:128
ds_read_b64_tr_b16 a[174:175], v28 offset:6272
v_mfma_f32_16x16x32_bf16 v[64:67], a[152:155], a[80:83], v[64:67]
s_waitcnt lgkmcnt(8)
ds_read_b128 a[120:123], v29 offset:0
ds_read_b128 a[124:127], v29 offset:1024
v_mfma_f32_16x16x32_bf16 v[76:79], a[156:159], a[80:83], v[76:79]
ds_read_b128 a[128:131], v29 offset:2048
ds_read_b128 a[132:135], v30 offset:0
v_mfma_f32_16x16x32_bf16 v[72:75], a[156:159], a[76:79], v[72:75]
ds_read_b128 a[136:139], v30 offset:1024
ds_read_b64_tr_b16 a[176:177], v25 offset:256
v_mfma_f32_16x16x32_bf16 v[68:71], a[156:159], a[72:75], v[68:71]
s_waitcnt lgkmcnt(12)
ds_read_b64_tr_b16 a[178:179], v25 offset:6400
ds_read_b128 a[140:143], v30 offset:2048
v_mfma_f32_16x16x32_bf16 v[80:83], a[160:163], a[72:75], v[80:83]
ds_read_b64_tr_b16 a[180:181], v26 offset:256
ds_read_b64_tr_b16 a[182:183], v26 offset:6400
v_mfma_f32_16x16x32_bf16 v[84:87], a[160:163], a[76:79], v[84:87]
v_add_u32 v225, s49, v225
v_subrev_u32 v225, 0, v225
v_mfma_f32_16x16x32_bf16 v[88:91], a[160:163], a[80:83], v[88:91]
s_waitcnt lgkmcnt(14)
ds_read_b64_tr_b16 a[184:185], v27 offset:256
ds_read_b64_tr_b16 a[186:187], v27 offset:6400
v_mfma_f32_16x16x32_bf16 v[100:103], a[164:167], a[80:83], v[100:103]
s_waitcnt lgkmcnt(4)
v_accvgpr_read_b32 v31, a140
v_accvgpr_write_b32 a244, v225
v_mfma_f32_16x16x32_bf16 v[96:99], a[164:167], a[76:79], v[96:99]
s_add_u32 m0, s37, 49152
ds_read_b64_tr_b16 a[188:189], v28 offset:256
ds_read_b64_tr_b16 a[190:191], v28 offset:6400
v_mfma_f32_16x16x32_bf16 v[92:95], a[164:167], a[72:75], v[92:95]
buffer_load_dwordx4 v11, s[16:19], s44 offen offset:0 lds
v_mfma_f32_16x16x32_bf16 v[104:107], a[168:171], a[72:75], v[104:107]
v_add_u32 v224, 64, v0
v_mul_u32_u24 v225, 205, v224
v_mfma_f32_16x16x32_bf16 v[108:111], a[168:171], a[76:79], v[108:111]
buffer_load_dwordx4 v13, s[16:19], s44 offen offset:1024 lds
v_mfma_f32_16x16x32_bf16 v[112:115], a[168:171], a[80:83], v[112:115]
v_lshrrev_b32 v225, 12, v225
v_mul_u32_u24 v226, 20, v225
v_mfma_f32_16x16x32_bf16 v[124:127], a[172:175], a[80:83], v[124:127]
buffer_load_dwordx4 v15, s[16:19], s44 offen offset:2048 lds
v_mfma_f32_16x16x32_bf16 v[120:123], a[172:175], a[76:79], v[120:123]
s_add_u32 m0, s37, 61440
v_sub_u32 v226, v224, v226
v_lshrrev_b32 v227, 1, v225
v_mfma_f32_16x16x32_bf16 v[116:119], a[172:175], a[72:75], v[116:119]
buffer_load_dwordx4 v12, s[16:19], s44 offen offset:0 lds
v_mfma_f32_16x16x32_bf16 v[128:131], a[176:179], a[72:75], v[128:131]
s_waitcnt lgkmcnt(0)
v_and_b32 v227, 2, v227
v_mfma_f32_16x16x32_bf16 v[132:135], a[176:179], a[76:79], v[132:135]
s_barrier
v_xor_b32 v226, v226, v227
v_mfma_f32_16x16x32_bf16 v[136:139], a[176:179], a[80:83], v[136:139]
ds_read_b64_tr_b16 a[144:145], v252 offset:0
ds_read_b64_tr_b16 a[146:147], v252 offset:6144
v_mfma_f32_16x16x32_bf16 v[148:151], a[180:183], a[80:83], v[148:151]
ds_read_b64_tr_b16 a[148:149], v253 offset:0
ds_read_b64_tr_b16 a[150:151], v253 offset:6144
v_mfma_f32_16x16x32_bf16 v[144:147], a[180:183], a[76:79], v[144:147]
buffer_load_dwordx4 v14, s[16:19], s44 offen offset:1024 lds
v_mfma_f32_16x16x32_bf16 v[140:143], a[180:183], a[72:75], v[140:143]
v_mul_u32_u24 v225, 1280, v225
v_lshl_add_u32 v225, v226, 4, v225
v_mfma_f32_16x16x32_bf16 v[152:155], a[184:187], a[72:75], v[152:155]
ds_read_b64_tr_b16 a[152:153], v254 offset:0
ds_read_b64_tr_b16 a[154:155], v254 offset:6144
v_mfma_f32_16x16x32_bf16 v[156:159], a[184:187], a[76:79], v[156:159]
buffer_load_dwordx4 v16, s[16:19], s44 offen offset:2048 lds
v_mfma_f32_16x16x32_bf16 v[160:163], a[184:187], a[80:83], v[160:163]
ds_read_b64_tr_b16 a[156:157], v255 offset:0
ds_read_b64_tr_b16 a[158:159], v255 offset:6144
v_add_u32 v25, 110592, v19
v_mfma_f32_16x16x32_bf16 v[172:175], a[188:191], a[80:83], v[172:175]
s_add_u32 s44, s44, 128
s_cmp_ge_u32 s44, 1280
s_cselect_b32 s44, 0, s44
v_add_u32 v26, 110592, v20
v_mfma_f32_16x16x32_bf16 v[168:171], a[188:191], a[76:79], v[168:171]
s_add_u32 m0, s37, 147456
v_add_u32 v225, s49, v225
v_subrev_u32 v225, 1024, v225
v_add_u32 v27, 110592, v21
v_mfma_f32_16x16x32_bf16 v[164:167], a[188:191], a[72:75], v[164:167]
s_waitcnt lgkmcnt(6)
ds_read_b64_tr_b16 a[160:161], v252 offset:128
ds_read_b64_tr_b16 a[162:163], v252 offset:6272
v_add_u32 v28, 110592, v22
v_mfma_f32_16x16x32_bf16 v[32:35], a[144:147], a[84:87], v[32:35]
buffer_load_dwordx4 v8, s[12:15], s43 offen offset:0  lds
v_mfma_f32_16x16x32_bf16 v[36:39], a[144:147], a[88:91], v[36:39]
ds_read_b64_tr_b16 a[164:165], v253 offset:128
ds_read_b64_tr_b16 a[166:167], v253 offset:6272
v_mfma_f32_16x16x32_bf16 v[40:43], a[144:147], a[92:95], v[40:43]
s_waitcnt lgkmcnt(8)
buffer_load_dwordx4 v9, s[12:15], s43 offen offset:1024  lds
v_mfma_f32_16x16x32_bf16 v[52:55], a[148:151], a[92:95], v[52:55]
v_accvgpr_write_b32 a245, v225
v_add_u32 v224, 128, v0
v_mfma_f32_16x16x32_bf16 v[48:51], a[148:151], a[88:91], v[48:51]
buffer_load_dwordx4 v10, s[12:15], s43 offen offset:2048  lds
v_mfma_f32_16x16x32_bf16 v[44:47], a[148:151], a[84:87], v[44:47]
s_waitcnt lgkmcnt(6)
ds_read_b64_tr_b16 a[168:169], v254 offset:128
ds_read_b64_tr_b16 a[170:171], v254 offset:6272
v_mfma_f32_16x16x32_bf16 v[56:59], a[152:155], a[84:87], v[56:59]
s_add_u32 s43, s43, 393216
s_cmp_ge_u32 s43, 7864320
s_cselect_b32 s43, 0, s43
v_mfma_f32_16x16x32_bf16 v[60:63], a[152:155], a[88:91], v[60:63]
s_waitcnt vmcnt(12)
ds_read_b64_tr_b16 a[172:173], v255 offset:128
ds_read_b64_tr_b16 a[174:175], v255 offset:6272
v_mfma_f32_16x16x32_bf16 v[64:67], a[152:155], a[92:95], v[64:67]
s_waitcnt lgkmcnt(8)
ds_read_b128 a[0:3], v29 offset:24576
ds_read_b128 a[4:7], v29 offset:25600
v_mfma_f32_16x16x32_bf16 v[76:79], a[156:159], a[92:95], v[76:79]
ds_read_b128 a[8:11], v29 offset:26624
ds_read_b128 a[12:15], v30 offset:24576
v_mfma_f32_16x16x32_bf16 v[72:75], a[156:159], a[88:91], v[72:75]
ds_read_b128 a[16:19], v30 offset:25600
ds_read_b64_tr_b16 a[176:177], v252 offset:256
v_mfma_f32_16x16x32_bf16 v[68:71], a[156:159], a[84:87], v[68:71]
s_waitcnt lgkmcnt(12)
ds_read_b64_tr_b16 a[178:179], v252 offset:6400
ds_read_b128 a[20:23], v30 offset:26624
v_mfma_f32_16x16x32_bf16 v[80:83], a[160:163], a[84:87], v[80:83]
ds_read_b64_tr_b16 a[180:181], v253 offset:256
ds_read_b64_tr_b16 a[182:183], v253 offset:6400
v_mfma_f32_16x16x32_bf16 v[84:87], a[160:163], a[88:91], v[84:87]
v_mul_u32_u24 v225, 205, v224
v_lshrrev_b32 v225, 12, v225
v_mfma_f32_16x16x32_bf16 v[88:91], a[160:163], a[92:95], v[88:91]
s_waitcnt lgkmcnt(14)
ds_read_b64_tr_b16 a[184:185], v254 offset:256
ds_read_b64_tr_b16 a[186:187], v254 offset:6400
v_mfma_f32_16x16x32_bf16 v[100:103], a[164:167], a[92:95], v[100:103]
s_waitcnt lgkmcnt(4)
v_accvgpr_read_b32 v31, a20
v_mul_u32_u24 v226, 20, v225
v_mfma_f32_16x16x32_bf16 v[96:99], a[164:167], a[88:91], v[96:99]
s_add_u32 m0, s37, 73728
ds_read_b64_tr_b16 a[188:189], v255 offset:256
ds_read_b64_tr_b16 a[190:191], v255 offset:6400
v_mfma_f32_16x16x32_bf16 v[92:95], a[164:167], a[84:87], v[92:95]
buffer_load_dwordx4 v11, s[16:19], s44 offen offset:0 lds
v_mfma_f32_16x16x32_bf16 v[104:107], a[168:171], a[84:87], v[104:107]
v_sub_u32 v226, v224, v226
v_lshrrev_b32 v227, 1, v225
v_mfma_f32_16x16x32_bf16 v[108:111], a[168:171], a[88:91], v[108:111]
buffer_load_dwordx4 v13, s[16:19], s44 offen offset:1024 lds
v_mfma_f32_16x16x32_bf16 v[112:115], a[168:171], a[92:95], v[112:115]
v_and_b32 v227, 2, v227
v_xor_b32 v226, v226, v227
v_mfma_f32_16x16x32_bf16 v[124:127], a[172:175], a[92:95], v[124:127]
buffer_load_dwordx4 v15, s[16:19], s44 offen offset:2048 lds
v_mfma_f32_16x16x32_bf16 v[120:123], a[172:175], a[88:91], v[120:123]
s_add_u32 m0, s37, 86016
v_mul_u32_u24 v225, 1280, v225
v_lshl_add_u32 v225, v226, 4, v225
v_mfma_f32_16x16x32_bf16 v[116:119], a[172:175], a[84:87], v[116:119]
buffer_load_dwordx4 v12, s[16:19], s44 offen offset:0 lds
v_mfma_f32_16x16x32_bf16 v[128:131], a[176:179], a[84:87], v[128:131]
s_waitcnt lgkmcnt(0)
v_add_u32 v225, s49, v225
v_mfma_f32_16x16x32_bf16 v[132:135], a[176:179], a[88:91], v[132:135]
s_barrier
v_subrev_u32 v225, 2048, v225
v_mfma_f32_16x16x32_bf16 v[136:139], a[176:179], a[92:95], v[136:139]
ds_read_b64_tr_b16 a[144:145], v25 offset:0
ds_read_b64_tr_b16 a[146:147], v25 offset:6144
v_mfma_f32_16x16x32_bf16 v[148:151], a[180:183], a[92:95], v[148:151]
ds_read_b64_tr_b16 a[148:149], v26 offset:0
ds_read_b64_tr_b16 a[150:151], v26 offset:6144
v_mfma_f32_16x16x32_bf16 v[144:147], a[180:183], a[88:91], v[144:147]
buffer_load_dwordx4 v14, s[16:19], s44 offen offset:1024 lds
v_mfma_f32_16x16x32_bf16 v[140:143], a[180:183], a[84:87], v[140:143]
v_accvgpr_write_b32 a246, v225
v_add_u32 v224, 192, v0
v_mfma_f32_16x16x32_bf16 v[152:155], a[184:187], a[84:87], v[152:155]
ds_read_b64_tr_b16 a[152:153], v27 offset:0
ds_read_b64_tr_b16 a[154:155], v27 offset:6144
v_mfma_f32_16x16x32_bf16 v[156:159], a[184:187], a[88:91], v[156:159]
buffer_load_dwordx4 v16, s[16:19], s44 offen offset:2048 lds
v_mfma_f32_16x16x32_bf16 v[160:163], a[184:187], a[92:95], v[160:163]
ds_read_b64_tr_b16 a[156:157], v28 offset:0
ds_read_b64_tr_b16 a[158:159], v28 offset:6144
v_add_u32 v252, 122880, v19
v_mfma_f32_16x16x32_bf16 v[172:175], a[188:191], a[92:95], v[172:175]
s_add_u32 s44, s44, 128
s_cmp_ge_u32 s44, 1280
s_cselect_b32 s44, 0, s44
v_add_u32 v253, 122880, v20
v_mfma_f32_16x16x32_bf16 v[168:171], a[188:191], a[88:91], v[168:171]
s_add_u32 m0, s37, 12288
v_mul_u32_u24 v225, 205, v224
v_lshrrev_b32 v225, 12, v225
v_add_u32 v254, 122880, v21
v_mfma_f32_16x16x32_bf16 v[164:167], a[188:191], a[84:87], v[164:167]
s_waitcnt lgkmcnt(6)
ds_read_b64_tr_b16 a[160:161], v25 offset:128
ds_read_b64_tr_b16 a[162:163], v25 offset:6272
v_add_u32 v255, 122880, v22
v_mfma_f32_16x16x32_bf16 v[32:35], a[144:147], a[96:99], v[32:35]
buffer_load_dwordx4 v8, s[12:15], s43 offen offset:0  lds
v_mfma_f32_16x16x32_bf16 v[36:39], a[144:147], a[100:103], v[36:39]
ds_read_b64_tr_b16 a[164:165], v26 offset:128
ds_read_b64_tr_b16 a[166:167], v26 offset:6272
v_mfma_f32_16x16x32_bf16 v[40:43], a[144:147], a[104:107], v[40:43]
s_waitcnt lgkmcnt(8)
buffer_load_dwordx4 v9, s[12:15], s43 offen offset:1024  lds
v_mfma_f32_16x16x32_bf16 v[52:55], a[148:151], a[104:107], v[52:55]
v_mul_u32_u24 v226, 20, v225
v_sub_u32 v226, v224, v226
v_mfma_f32_16x16x32_bf16 v[48:51], a[148:151], a[100:103], v[48:51]
buffer_load_dwordx4 v10, s[12:15], s43 offen offset:2048  lds
v_mfma_f32_16x16x32_bf16 v[44:47], a[148:151], a[96:99], v[44:47]
s_waitcnt lgkmcnt(6)
ds_read_b64_tr_b16 a[168:169], v27 offset:128
ds_read_b64_tr_b16 a[170:171], v27 offset:6272
v_mfma_f32_16x16x32_bf16 v[56:59], a[152:155], a[96:99], v[56:59]
s_add_u32 s43, s43, 393216
s_cmp_ge_u32 s43, 7864320
s_cselect_b32 s43, 0, s43
v_mfma_f32_16x16x32_bf16 v[60:63], a[152:155], a[100:103], v[60:63]
s_waitcnt vmcnt(12)
ds_read_b64_tr_b16 a[172:173], v28 offset:128
ds_read_b64_tr_b16 a[174:175], v28 offset:6272
v_mfma_f32_16x16x32_bf16 v[64:67], a[152:155], a[104:107], v[64:67]
s_waitcnt lgkmcnt(8)
ds_read_b128 a[24:27], v29 offset:0
ds_read_b128 a[28:31], v29 offset:1024
v_mfma_f32_16x16x32_bf16 v[76:79], a[156:159], a[104:107], v[76:79]
ds_read_b128 a[32:35], v29 offset:2048
ds_read_b128 a[36:39], v30 offset:0
v_mfma_f32_16x16x32_bf16 v[72:75], a[156:159], a[100:103], v[72:75]
ds_read_b128 a[40:43], v30 offset:1024
ds_read_b64_tr_b16 a[176:177], v25 offset:256
v_mfma_f32_16x16x32_bf16 v[68:71], a[156:159], a[96:99], v[68:71]
s_waitcnt lgkmcnt(12)
ds_read_b64_tr_b16 a[178:179], v25 offset:6400
ds_read_b128 a[44:47], v30 offset:2048
v_mfma_f32_16x16x32_bf16 v[80:83], a[160:163], a[96:99], v[80:83]
ds_read_b64_tr_b16 a[180:181], v26 offset:256
ds_read_b64_tr_b16 a[182:183], v26 offset:6400
v_mfma_f32_16x16x32_bf16 v[84:87], a[160:163], a[100:103], v[84:87]
v_lshrrev_b32 v227, 1, v225
v_and_b32 v227, 2, v227
v_mfma_f32_16x16x32_bf16 v[88:91], a[160:163], a[104:107], v[88:91]
s_waitcnt lgkmcnt(14)
ds_read_b64_tr_b16 a[184:185], v27 offset:256
ds_read_b64_tr_b16 a[186:187], v27 offset:6400
v_mfma_f32_16x16x32_bf16 v[100:103], a[164:167], a[104:107], v[100:103]
s_waitcnt lgkmcnt(4)
v_accvgpr_read_b32 v31, a44
v_xor_b32 v226, v226, v227
v_mfma_f32_16x16x32_bf16 v[96:99], a[164:167], a[100:103], v[96:99]
s_add_u32 m0, s37, 49152
ds_read_b64_tr_b16 a[188:189], v28 offset:256
ds_read_b64_tr_b16 a[190:191], v28 offset:6400
v_mfma_f32_16x16x32_bf16 v[92:95], a[164:167], a[96:99], v[92:95]
buffer_load_dwordx4 v11, s[16:19], s44 offen offset:0 lds
v_mfma_f32_16x16x32_bf16 v[104:107], a[168:171], a[96:99], v[104:107]
v_mul_u32_u24 v225, 1280, v225
v_lshl_add_u32 v225, v226, 4, v225
v_mfma_f32_16x16x32_bf16 v[108:111], a[168:171], a[100:103], v[108:111]
buffer_load_dwordx4 v13, s[16:19], s44 offen offset:1024 lds
v_mfma_f32_16x16x32_bf16 v[112:115], a[168:171], a[104:107], v[112:115]
v_add_u32 v225, s49, v225
v_subrev_u32 v225, 3072, v225
v_mfma_f32_16x16x32_bf16 v[124:127], a[172:175], a[104:107], v[124:127]
buffer_load_dwordx4 v15, s[16:19], s44 offen offset:2048 lds
v_mfma_f32_16x16x32_bf16 v[120:123], a[172:175], a[100:103], v[120:123]
s_add_u32 m0, s37, 61440
v_accvgpr_write_b32 a247, v225
v_add_u32 v224, 256, v0
v_mfma_f32_16x16x32_bf16 v[116:119], a[172:175], a[96:99], v[116:119]
buffer_load_dwordx4 v12, s[16:19], s44 offen offset:0 lds
v_mfma_f32_16x16x32_bf16 v[128:131], a[176:179], a[96:99], v[128:131]
s_waitcnt lgkmcnt(0)
v_mul_u32_u24 v225, 205, v224
v_mfma_f32_16x16x32_bf16 v[132:135], a[176:179], a[100:103], v[132:135]
s_barrier
v_lshrrev_b32 v225, 12, v225
v_mfma_f32_16x16x32_bf16 v[136:139], a[176:179], a[104:107], v[136:139]
ds_read_b64_tr_b16 a[144:145], v252 offset:0
ds_read_b64_tr_b16 a[146:147], v252 offset:6144
v_mfma_f32_16x16x32_bf16 v[148:151], a[180:183], a[104:107], v[148:151]
ds_read_b64_tr_b16 a[148:149], v253 offset:0
ds_read_b64_tr_b16 a[150:151], v253 offset:6144
v_mfma_f32_16x16x32_bf16 v[144:147], a[180:183], a[100:103], v[144:147]
buffer_load_dwordx4 v14, s[16:19], s44 offen offset:1024 lds
v_mfma_f32_16x16x32_bf16 v[140:143], a[180:183], a[96:99], v[140:143]
v_mul_u32_u24 v226, 20, v225
v_sub_u32 v226, v224, v226
v_mfma_f32_16x16x32_bf16 v[152:155], a[184:187], a[96:99], v[152:155]
ds_read_b64_tr_b16 a[152:153], v254 offset:0
ds_read_b64_tr_b16 a[154:155], v254 offset:6144
v_mfma_f32_16x16x32_bf16 v[156:159], a[184:187], a[100:103], v[156:159]
buffer_load_dwordx4 v16, s[16:19], s44 offen offset:2048 lds
v_mfma_f32_16x16x32_bf16 v[160:163], a[184:187], a[104:107], v[160:163]
ds_read_b64_tr_b16 a[156:157], v255 offset:0
ds_read_b64_tr_b16 a[158:159], v255 offset:6144
v_mfma_f32_16x16x32_bf16 v[172:175], a[188:191], a[104:107], v[172:175]
s_add_u32 s44, s44, 128
s_cmp_ge_u32 s44, 1280
s_cselect_b32 s44, 0, s44
v_mfma_f32_16x16x32_bf16 v[168:171], a[188:191], a[100:103], v[168:171]
s_add_u32 m0, s37, 98304
v_lshrrev_b32 v227, 1, v225
v_and_b32 v227, 2, v227
v_mfma_f32_16x16x32_bf16 v[164:167], a[188:191], a[96:99], v[164:167]
s_waitcnt lgkmcnt(6)
ds_read_b64_tr_b16 a[160:161], v252 offset:128
ds_read_b64_tr_b16 a[162:163], v252 offset:6272
v_mfma_f32_16x16x32_bf16 v[32:35], a[144:147], a[108:111], v[32:35]
buffer_load_dwordx4 v8, s[12:15], s43 offen offset:0  lds
v_mfma_f32_16x16x32_bf16 v[36:39], a[144:147], a[112:115], v[36:39]
ds_read_b64_tr_b16 a[164:165], v253 offset:128
ds_read_b64_tr_b16 a[166:167], v253 offset:6272
v_mfma_f32_16x16x32_bf16 v[40:43], a[144:147], a[116:119], v[40:43]
s_waitcnt lgkmcnt(8)
buffer_load_dwordx4 v9, s[12:15], s43 offen offset:1024  lds
v_mfma_f32_16x16x32_bf16 v[52:55], a[148:151], a[116:119], v[52:55]
v_xor_b32 v226, v226, v227
v_mul_u32_u24 v225, 1280, v225
v_mfma_f32_16x16x32_bf16 v[48:51], a[148:151], a[112:115], v[48:51]
buffer_load_dwordx4 v10, s[12:15], s43 offen offset:2048  lds
v_mfma_f32_16x16x32_bf16 v[44:47], a[148:151], a[108:111], v[44:47]
s_waitcnt lgkmcnt(6)
ds_read_b64_tr_b16 a[168:169], v254 offset:128
ds_read_b64_tr_b16 a[170:171], v254 offset:6272
v_mfma_f32_16x16x32_bf16 v[56:59], a[152:155], a[108:111], v[56:59]
s_add_u32 s43, s43, 393216
s_cmp_ge_u32 s43, 7864320
s_cselect_b32 s43, 0, s43
v_mfma_f32_16x16x32_bf16 v[60:63], a[152:155], a[112:115], v[60:63]
s_waitcnt vmcnt(12)
ds_read_b64_tr_b16 a[172:173], v255 offset:128
ds_read_b64_tr_b16 a[174:175], v255 offset:6272
v_mfma_f32_16x16x32_bf16 v[64:67], a[152:155], a[116:119], v[64:67]
s_waitcnt lgkmcnt(8)
ds_read_b128 a[48:51], v29 offset:24576
ds_read_b128 a[52:55], v29 offset:25600
v_mfma_f32_16x16x32_bf16 v[76:79], a[156:159], a[116:119], v[76:79]
ds_read_b128 a[56:59], v29 offset:26624
ds_read_b128 a[60:63], v30 offset:24576
v_mfma_f32_16x16x32_bf16 v[72:75], a[156:159], a[112:115], v[72:75]
ds_read_b128 a[64:67], v30 offset:25600
ds_read_b64_tr_b16 a[176:177], v252 offset:256
v_mfma_f32_16x16x32_bf16 v[68:71], a[156:159], a[108:111], v[68:71]
s_waitcnt lgkmcnt(12)
ds_read_b64_tr_b16 a[178:179], v252 offset:6400
ds_read_b128 a[68:71], v30 offset:26624
v_mfma_f32_16x16x32_bf16 v[80:83], a[160:163], a[108:111], v[80:83]
ds_read_b64_tr_b16 a[180:181], v253 offset:256
ds_read_b64_tr_b16 a[182:183], v253 offset:6400
v_mfma_f32_16x16x32_bf16 v[84:87], a[160:163], a[112:115], v[84:87]
v_lshl_add_u32 v225, v226, 4, v225
v_add_u32 v225, s49, v225
v_mfma_f32_16x16x32_bf16 v[88:91], a[160:163], a[116:119], v[88:91]
s_waitcnt lgkmcnt(14)
ds_read_b64_tr_b16 a[184:185], v254 offset:256
ds_read_b64_tr_b16 a[186:187], v254 offset:6400
v_mfma_f32_16x16x32_bf16 v[100:103], a[164:167], a[116:119], v[100:103]
s_waitcnt lgkmcnt(4)
v_accvgpr_read_b32 v31, a68
v_subrev_u32 v225, 0, v225
v_mfma_f32_16x16x32_bf16 v[96:99], a[164:167], a[112:115], v[96:99]
s_add_u32 m0, s37, 73728
ds_read_b64_tr_b16 a[188:189], v255 offset:256
ds_read_b64_tr_b16 a[190:191], v255 offset:6400
v_mfma_f32_16x16x32_bf16 v[92:95], a[164:167], a[108:111], v[92:95]
buffer_load_dwordx4 v8, s[12:15], s43 offen offset:0  lds
v_mfma_f32_16x16x32_bf16 v[104:107], a[168:171], a[108:111], v[104:107]
v_accvgpr_write_b32 a248, v225
v_add_u32 v25, 135168, v19
v_add_u32 v26, 135168, v20
v_add_u32 v27, 135168, v21
v_add_u32 v28, 135168, v22
v_mfma_f32_16x16x32_bf16 v[108:111], a[168:171], a[112:115], v[108:111]
s_lshr_b32 s49, s2, 3
buffer_load_dwordx4 v9, s[12:15], s43 offen offset:1024  lds
v_mfma_f32_16x16x32_bf16 v[112:115], a[168:171], a[116:119], v[112:115]
v_mfma_f32_16x16x32_bf16 v[124:127], a[172:175], a[116:119], v[124:127]
s_lshl_b32 s49, s49, 2
buffer_load_dwordx4 v10, s[12:15], s43 offen offset:2048  lds
v_mfma_f32_16x16x32_bf16 v[120:123], a[172:175], a[112:115], v[120:123]
s_add_u32 s43, s43, 393216
s_cmp_ge_u32 s43, 7864320
s_cselect_b32 s43, 0, s43
v_mfma_f32_16x16x32_bf16 v[116:119], a[172:175], a[108:111], v[116:119]
s_add_u32 s49, s49, s32
s_mul_i32 s49, s49, 7680
v_mfma_f32_16x16x32_bf16 v[128:131], a[176:179], a[108:111], v[128:131]
s_waitcnt lgkmcnt(0)
s_add_u32 m0, s37, 86016
v_mfma_f32_16x16x32_bf16 v[132:135], a[176:179], a[112:115], v[132:135]
s_barrier
s_add_u32 s49, s49, s47
v_mfma_f32_16x16x32_bf16 v[136:139], a[176:179], a[116:119], v[136:139]
ds_read_b64_tr_b16 a[144:145], v25 offset:0
ds_read_b64_tr_b16 a[146:147], v25 offset:6144
v_mfma_f32_16x16x32_bf16 v[148:151], a[180:183], a[116:119], v[148:151]
ds_read_b64_tr_b16 a[148:149], v26 offset:0
ds_read_b64_tr_b16 a[150:151], v26 offset:6144
v_mfma_f32_16x16x32_bf16 v[144:147], a[180:183], a[112:115], v[144:147]
buffer_load_dwordx4 v8, s[12:15], s43 offen offset:0  lds
v_mfma_f32_16x16x32_bf16 v[140:143], a[180:183], a[108:111], v[140:143]
v_lshlrev_b32 v224, 7, v0
v_add_u32 v224, s49, v224
v_mfma_f32_16x16x32_bf16 v[152:155], a[184:187], a[108:111], v[152:155]
ds_read_b64_tr_b16 a[152:153], v27 offset:0
ds_read_b64_tr_b16 a[154:155], v27 offset:6144
v_mfma_f32_16x16x32_bf16 v[156:159], a[184:187], a[112:115], v[156:159]
buffer_load_dwordx4 v9, s[12:15], s43 offen offset:1024  lds
v_mfma_f32_16x16x32_bf16 v[160:163], a[184:187], a[116:119], v[160:163]
ds_read_b64_tr_b16 a[156:157], v28 offset:0
ds_read_b64_tr_b16 a[158:159], v28 offset:6144
v_add_u32 v252, 147456, v19
v_mfma_f32_16x16x32_bf16 v[172:175], a[188:191], a[116:119], v[172:175]
buffer_load_dwordx4 v10, s[12:15], s43 offen offset:2048  lds
v_add_u32 v253, 147456, v20
v_mfma_f32_16x16x32_bf16 v[168:171], a[188:191], a[112:115], v[168:171]
s_add_u32 s43, s43, 393216
s_cmp_ge_u32 s43, 7864320
s_cselect_b32 s43, 0, s43
v_add_u32 v254, 147456, v21
v_mfma_f32_16x16x32_bf16 v[164:167], a[188:191], a[108:111], v[164:167]
s_waitcnt lgkmcnt(6)
ds_read_b64_tr_b16 a[160:161], v25 offset:128
ds_read_b64_tr_b16 a[162:163], v25 offset:6272
v_add_u32 v255, 147456, v22
v_mfma_f32_16x16x32_bf16 v[32:35], a[144:147], a[120:123], v[32:35]
s_add_u32 m0, s37, 110592
v_cmp_gt_u32 vcc, 60, v0
v_mov_b32 v225, 2130706432
s_nop 0
v_cndmask_b32 v224, v225, v224, vcc
v_mfma_f32_16x16x32_bf16 v[36:39], a[144:147], a[124:127], v[36:39]
ds_read_b64_tr_b16 a[164:165], v26 offset:128
ds_read_b64_tr_b16 a[166:167], v26 offset:6272
v_mfma_f32_16x16x32_bf16 v[40:43], a[144:147], a[128:131], v[40:43]
s_waitcnt lgkmcnt(8)
buffer_load_dwordx4 v8, s[12:15], s43 offen offset:0  lds
v_mfma_f32_16x16x32_bf16 v[52:55], a[148:151], a[128:131], v[52:55]
v_accvgpr_write_b32 a249, v224
v_mul_u32_u24 v224, 320, v234
v_mfma_f32_16x16x32_bf16 v[48:51], a[148:151], a[124:127], v[48:51]
buffer_load_dwordx4 v9, s[12:15], s43 offen offset:1024  lds
v_mfma_f32_16x16x32_bf16 v[44:47], a[148:151], a[120:123], v[44:47]
s_waitcnt lgkmcnt(6)
ds_read_b64_tr_b16 a[168:169], v27 offset:128
ds_read_b64_tr_b16 a[170:171], v27 offset:6272
v_mfma_f32_16x16x32_bf16 v[56:59], a[152:155], a[120:123], v[56:59]
buffer_load_dwordx4 v10, s[12:15], s43 offen offset:2048  lds
v_mfma_f32_16x16x32_bf16 v[60:63], a[152:155], a[124:127], v[60:63]
s_add_u32 s43, s43, 393216
s_cmp_ge_u32 s43, 7864320
s_cselect_b32 s43, 0, s43
v_mfma_f32_16x16x32_bf16 v[64:67], a[152:155], a[128:131], v[64:67]
s_waitcnt lgkmcnt(6)
ds_read_b64_tr_b16 a[172:173], v28 offset:128
ds_read_b64_tr_b16 a[174:175], v28 offset:6272
v_mfma_f32_16x16x32_bf16 v[76:79], a[156:159], a[128:131], v[76:79]
s_waitcnt vmcnt(12)
ds_read_b64_tr_b16 a[176:177], v25 offset:256
ds_read_b64_tr_b16 a[178:179], v25 offset:6400
v_mfma_f32_16x16x32_bf16 v[72:75], a[156:159], a[124:127], v[72:75]
ds_read_b128 a[72:75], v29 offset:0
ds_read_b128 a[76:79], v29 offset:1024
v_mfma_f32_16x16x32_bf16 v[68:71], a[156:159], a[120:123], v[68:71]
s_waitcnt lgkmcnt(10)
ds_read_b128 a[80:83], v29 offset:2048
ds_read_b128 a[84:87], v30 offset:0
v_mfma_f32_16x16x32_bf16 v[80:83], a[160:163], a[120:123], v[80:83]
ds_read_b128 a[88:91], v30 offset:1024
ds_read_b128 a[92:95], v30 offset:2048
v_mfma_f32_16x16x32_bf16 v[84:87], a[160:163], a[124:127], v[84:87]
ds_read_b64_tr_b16 a[180:181], v26 offset:256
ds_read_b64_tr_b16 a[182:183], v26 offset:6400
v_mfma_f32_16x16x32_bf16 v[88:91], a[160:163], a[128:131], v[88:91]
s_waitcnt lgkmcnt(14)
ds_read_b64_tr_b16 a[184:185], v27 offset:256
ds_read_b64_tr_b16 a[186:187], v27 offset:6400
v_mfma_f32_16x16x32_bf16 v[100:103], a[164:167], a[128:131], v[100:103]
v_lshl_add_u32 v224, v236, 3, v224
v_and_b32 v225, 16, v0
v_mfma_f32_16x16x32_bf16 v[96:99], a[164:167], a[124:127], v[96:99]
ds_read_b64_tr_b16 a[188:189], v28 offset:256
ds_read_b64_tr_b16 a[190:191], v28 offset:6400
v_mfma_f32_16x16x32_bf16 v[92:95], a[164:167], a[120:123], v[92:95]
s_waitcnt lgkmcnt(15)
v_lshlrev_b32 v225, 1, v225
v_add_u32 v226, v224, v225
v_mfma_f32_16x16x32_bf16 v[104:107], a[168:171], a[120:123], v[104:107]
v_sub_u32 v227, v224, v225
v_accvgpr_write_b32 a250, v226
v_mfma_f32_16x16x32_bf16 v[108:111], a[168:171], a[124:127], v[108:111]
v_accvgpr_write_b32 a251, v227
s_waitcnt lgkmcnt(6)
v_accvgpr_read_b32 v31, a92
v_mfma_f32_16x16x32_bf16 v[112:115], a[168:171], a[128:131], v[112:115]
s_add_u32 m0, s37, 122880
v_mfma_f32_16x16x32_bf16 v[124:127], a[172:175], a[128:131], v[124:127]
s_mul_i32 s96, s96, 73728
buffer_load_dwordx4 v8, s[12:15], s43 offen offset:0  lds
v_mfma_f32_16x16x32_bf16 v[120:123], a[172:175], a[124:127], v[120:123]
s_add_u32 s96, s96, s37
v_mfma_f32_16x16x32_bf16 v[116:119], a[172:175], a[120:123], v[116:119]
buffer_load_dwordx4 v9, s[12:15], s43 offen offset:1024  lds
v_mfma_f32_16x16x32_bf16 v[128:131], a[176:179], a[120:123], v[128:131]
s_waitcnt lgkmcnt(0)
s_mul_i32 s97, s97, 122880
v_mfma_f32_16x16x32_bf16 v[132:135], a[176:179], a[124:127], v[132:135]
s_barrier
s_add_u32 s97, s97, 20971520
v_mfma_f32_16x16x32_bf16 v[136:139], a[176:179], a[128:131], v[136:139]
ds_read_b64_tr_b16 a[144:145], v252 offset:0
ds_read_b64_tr_b16 a[146:147], v252 offset:6144
v_mfma_f32_16x16x32_bf16 v[148:151], a[180:183], a[128:131], v[148:151]
ds_read_b64_tr_b16 a[148:149], v253 offset:0
ds_read_b64_tr_b16 a[150:151], v253 offset:6144
v_mfma_f32_16x16x32_bf16 v[144:147], a[180:183], a[124:127], v[144:147]
v_lshlrev_b32 v224, 4, v0
v_add_u32 v226, s96, v224
v_mfma_f32_16x16x32_bf16 v[140:143], a[180:183], a[120:123], v[140:143]
v_add_u32 v227, s97, v224
v_accvgpr_write_b32 a252, v226
v_mfma_f32_16x16x32_bf16 v[152:155], a[184:187], a[120:123], v[152:155]
ds_read_b64_tr_b16 a[152:153], v254 offset:0
ds_read_b64_tr_b16 a[154:155], v254 offset:6144
v_mfma_f32_16x16x32_bf16 v[156:159], a[184:187], a[124:127], v[156:159]
v_accvgpr_write_b32 a253, v227
v_mfma_f32_16x16x32_bf16 v[160:163], a[184:187], a[128:131], v[160:163]
ds_read_b64_tr_b16 a[156:157], v255 offset:0
ds_read_b64_tr_b16 a[158:159], v255 offset:6144
v_mfma_f32_16x16x32_bf16 v[172:175], a[188:191], a[128:131], v[172:175]
s_add_u32 s48, s48, s50
buffer_load_dwordx4 v10, s[12:15], s43 offen offset:2048  lds
v_mfma_f32_16x16x32_bf16 v[168:171], a[188:191], a[124:127], v[168:171]
s_add_u32 s43, s43, 393216
v_mul_u32_u24 v224, 1280, v232
v_add3_u32 v224, v224, v225, s48
s_cmp_ge_u32 s43, 7864320
s_cselect_b32 s43, 0, s43
v_mfma_f32_16x16x32_bf16 v[164:167], a[188:191], a[120:123], v[164:167]
s_waitcnt lgkmcnt(6)
ds_read_b64_tr_b16 a[160:161], v252 offset:128
ds_read_b64_tr_b16 a[162:163], v252 offset:6272
v_mfma_f32_16x16x32_bf16 v[32:35], a[144:147], a[132:135], v[32:35]
s_add_u32 m0, s37, 135168
v_lshrrev_b32 v226, 5, v0
v_lshl_add_u32 v224, v226, 4, v224
v_mfma_f32_16x16x32_bf16 v[36:39], a[144:147], a[136:139], v[36:39]
ds_read_b64_tr_b16 a[164:165], v253 offset:128
ds_read_b64_tr_b16 a[166:167], v253 offset:6272
v_mfma_f32_16x16x32_bf16 v[40:43], a[144:147], a[140:143], v[40:43]
s_waitcnt lgkmcnt(8)
v_accvgpr_write_b32 a254, v224
v_mov_b32 v224, 0x3f803f80
v_mfma_f32_16x16x32_bf16 v[52:55], a[148:151], a[140:143], v[52:55]
v_cmp_eq_u32 vcc, 0, v236
s_nop 1
v_cndmask_b32 v224, 0, v224, vcc
v_accvgpr_write_b32 a240, v224
v_mfma_f32_16x16x32_bf16 v[48:51], a[148:151], a[136:139], v[48:51]
ds_read_b64_tr_b16 a[168:169], v254 offset:128
ds_read_b64_tr_b16 a[170:171], v254 offset:6272
v_mfma_f32_16x16x32_bf16 v[44:47], a[148:151], a[132:135], v[44:47]
s_waitcnt lgkmcnt(8)
v_accvgpr_write_b32 a241, v224
v_accvgpr_write_b32 a242, v224
v_mfma_f32_16x16x32_bf16 v[56:59], a[152:155], a[132:135], v[56:59]
ds_read_b64_tr_b16 a[172:173], v255 offset:128
ds_read_b64_tr_b16 a[174:175], v255 offset:6272
v_mfma_f32_16x16x32_bf16 v[60:63], a[152:155], a[136:139], v[60:63]
v_accvgpr_write_b32 a243, v224
v_add_u32 v25, 12288, v19
v_mfma_f32_16x16x32_bf16 v[64:67], a[152:155], a[140:143], v[64:67]
s_waitcnt lgkmcnt(8)
buffer_load_dwordx4 v8, s[12:15], s43 offen offset:0  lds
v_mfma_f32_16x16x32_bf16 v[76:79], a[156:159], a[140:143], v[76:79]
s_add_u32 s76, s36, 0
ds_read_b64_tr_b16 a[176:177], v252 offset:256
ds_read_b64_tr_b16 a[178:179], v252 offset:6400
v_mfma_f32_16x16x32_bf16 v[72:75], a[156:159], a[136:139], v[72:75]
s_and_b32 s76, s76, 3
buffer_load_dwordx4 v9, s[12:15], s43 offen offset:1024  lds
v_mfma_f32_16x16x32_bf16 v[68:71], a[156:159], a[132:135], v[68:71]
s_waitcnt lgkmcnt(8)
ds_read_b64_tr_b16 a[180:181], v253 offset:256
ds_read_b64_tr_b16 a[182:183], v253 offset:6400
v_mfma_f32_16x16x32_bf16 v[80:83], a[160:163], a[132:135], v[80:83]
s_mul_i32 s76, s76, 3
buffer_load_dwordx4 v10, s[12:15], s43 offen offset:2048  lds
v_mfma_f32_16x16x32_bf16 v[84:87], a[160:163], a[136:139], v[84:87]
s_add_u32 s77, s36, 1
s_add_u32 s43, s43, 393216
v_add_u32 v26, 12288, v20
v_mfma_f32_16x16x32_bf16 v[88:91], a[160:163], a[140:143], v[88:91]
s_waitcnt lgkmcnt(8)
ds_read_b64_tr_b16 a[184:185], v254 offset:256
ds_read_b64_tr_b16 a[186:187], v254 offset:6400
v_mfma_f32_16x16x32_bf16 v[100:103], a[164:167], a[140:143], v[100:103]
s_and_b32 s77, s77, 3
s_cmp_ge_u32 s43, 7864320
s_cselect_b32 s43, 0, s43
v_mfma_f32_16x16x32_bf16 v[96:99], a[164:167], a[136:139], v[96:99]
s_mul_i32 s77, s77, 3
ds_read_b64_tr_b16 a[188:189], v255 offset:256
ds_read_b64_tr_b16 a[190:191], v255 offset:6400
v_mfma_f32_16x16x32_bf16 v[92:95], a[164:167], a[132:135], v[92:95]
s_waitcnt lgkmcnt(10)
s_add_u32 m0, s37, 0
v_add_u32 v27, 12288, v21
v_add_u32 v28, 12288, v22
v_mfma_f32_16x16x32_bf16 v[104:107], a[168:171], a[132:135], v[104:107]
s_add_u32 s78, s36, 2
buffer_load_dwordx4 v2, s[4:7], s42 offen offset:0 nt lds
v_mfma_f32_16x16x32_bf16 v[108:111], a[168:171], a[136:139], v[108:111]
s_and_b32 s78, s78, 3
v_mfma_f32_16x16x32_bf16 v[112:115], a[168:171], a[140:143], v[112:115]
s_waitcnt lgkmcnt(8)
buffer_load_dwordx4 v3, s[4:7], s42 offen offset:1024 nt lds
v_mfma_f32_16x16x32_bf16 v[124:127], a[172:175], a[140:143], v[124:127]
s_mul_i32 s78, s78, 3
v_mfma_f32_16x16x32_bf16 v[120:123], a[172:175], a[136:139], v[120:123]
s_add_u32 s79, s36, 3
buffer_load_dwordx4 v4, s[4:7], s42 offen offset:2048 nt lds
v_mfma_f32_16x16x32_bf16 v[116:119], a[172:175], a[132:135], v[116:119]
s_waitcnt lgkmcnt(6)
s_add_u32 s42, s42, 12288
v_mfma_f32_16x16x32_bf16 v[128:131], a[176:179], a[132:135], v[128:131]
s_waitcnt vmcnt(18)
s_waitcnt lgkmcnt(0)
s_and_b32 s79, s79, 3
v_mfma_f32_16x16x32_bf16 v[132:135], a[176:179], a[136:139], v[132:135]
s_barrier
s_mul_i32 s79, s79, 3
v_mfma_f32_16x16x32_bf16 v[136:139], a[176:179], a[140:143], v[136:139]
ds_read_b64_tr_b16 a[144:145], v25 offset:0
ds_read_b64_tr_b16 a[146:147], v25 offset:6144
v_mfma_f32_16x16x32_bf16 v[148:151], a[180:183], a[140:143], v[148:151]
s_mul_i32 s45, s32, 5120
s_cmp_ge_u32 s42, 393216
s_cselect_b32 s42, 0, s42
v_mfma_f32_16x16x32_bf16 v[144:147], a[180:183], a[136:139], v[144:147]
s_mov_b32 s3, 0x53800000
ds_read_b64_tr_b16 a[148:149], v26 offset:0
ds_read_b64_tr_b16 a[150:151], v26 offset:6144
v_mfma_f32_16x16x32_bf16 v[140:143], a[180:183], a[132:135], v[140:143]
s_add_u32 m0, s37, 147456
v_mfma_f32_16x16x32_bf16 v[152:155], a[184:187], a[132:135], v[152:155]
s_mov_b32 s34, 0x3dd53b95
buffer_load_dwordx4 v8, s[12:15], s43 offen offset:0  lds
v_mfma_f32_16x16x32_bf16 v[156:159], a[184:187], a[136:139], v[156:159]
s_add_u32 s39, s37, 98304
ds_read_b64_tr_b16 a[152:153], v27 offset:0
ds_read_b64_tr_b16 a[154:155], v27 offset:6144
v_mfma_f32_16x16x32_bf16 v[160:163], a[184:187], a[140:143], v[160:163]
buffer_load_dwordx4 v9, s[12:15], s43 offen offset:1024  lds
v_mfma_f32_16x16x32_bf16 v[172:175], a[188:191], a[140:143], v[172:175]
s_mov_b32 s40, 0
v_add_u32 v252, 98304, v19
v_mfma_f32_16x16x32_bf16 v[168:171], a[188:191], a[136:139], v[168:171]
s_mov_b32 s41, 1
ds_read_b64_tr_b16 a[156:157], v28 offset:0
ds_read_b64_tr_b16 a[158:159], v28 offset:6144
v_mfma_f32_16x16x32_bf16 v[164:167], a[188:191], a[132:135], v[164:167]
s_waitcnt lgkmcnt(6)
buffer_load_dwordx4 v10, s[12:15], s43 offen offset:2048  lds
v_mfma_f32_16x16x32_bf16 v[32:35], a[144:147], a[0:3], v[32:35]
s_add_u32 s43, s43, 393216
s_cmp_ge_u32 s43, 7864320
s_cselect_b32 s43, 0, s43
v_mfma_f32_16x16x32_bf16 v[36:39], a[144:147], a[4:7], v[36:39]
s_add_u32 m0, s37, 24576
ds_read_b64_tr_b16 a[160:161], v25 offset:128
ds_read_b64_tr_b16 a[162:163], v25 offset:6272
v_mfma_f32_16x16x32_bf16 v[40:43], a[144:147], a[8:11], v[40:43]
s_waitcnt lgkmcnt(6)
buffer_load_dwordx4 v2, s[4:7], s42 offen offset:0 nt lds
v_mfma_f32_16x16x32_bf16 v[52:55], a[148:151], a[8:11], v[52:55]
v_add_u32 v253, 98304, v20
v_mfma_f32_16x16x32_bf16 v[48:51], a[148:151], a[4:7], v[48:51]
ds_read_b64_tr_b16 a[164:165], v26 offset:128
ds_read_b64_tr_b16 a[166:167], v26 offset:6272
v_mfma_f32_16x16x32_bf16 v[44:47], a[148:151], a[0:3], v[44:47]
s_waitcnt lgkmcnt(6)
buffer_load_dwordx4 v3, s[4:7], s42 offen offset:1024 nt lds
v_mfma_f32_16x16x32_bf16 v[56:59], a[152:155], a[0:3], v[56:59]
v_accvgpr_write_b32 a96, 0
v_accvgpr_write_b32 a97, 0
v_mfma_f32_16x16x32_bf16 v[60:63], a[152:155], a[4:7], v[60:63]
ds_read_b64_tr_b16 a[168:169], v27 offset:128
ds_read_b64_tr_b16 a[170:171], v27 offset:6272
v_mfma_f32_16x16x32_bf16 v[64:67], a[152:155], a[8:11], v[64:67]
s_waitcnt lgkmcnt(6)
buffer_load_dwordx4 v4, s[4:7], s42 offen offset:2048 nt lds
v_mfma_f32_16x16x32_bf16 v[76:79], a[156:159], a[8:11], v[76:79]
s_add_u32 s42, s42, 12288
s_cmp_ge_u32 s42, 393216
s_cselect_b32 s42, 0, s42
v_mfma_f32_16x16x32_bf16 v[72:75], a[156:159], a[4:7], v[72:75]
ds_read_b64_tr_b16 a[172:173], v28 offset:128
ds_read_b64_tr_b16 a[174:175], v28 offset:6272
v_mfma_f32_16x16x32_bf16 v[68:71], a[156:159], a[0:3], v[68:71]
s_waitcnt lgkmcnt(6)
v_add_u32 v254, 98304, v21
v_accvgpr_write_b32 a98, 0
v_mfma_f32_16x16x32_bf16 v[80:83], a[160:163], a[0:3], v[80:83]
v_accvgpr_write_b32 a99, 0
v_mfma_f32_16x16x32_bf16 v[84:87], a[160:163], a[4:7], v[84:87]
ds_read_b64_tr_b16 a[176:177], v25 offset:256
ds_read_b64_tr_b16 a[178:179], v25 offset:6400
v_mfma_f32_16x16x32_bf16 v[88:91], a[160:163], a[8:11], v[88:91]
s_waitcnt lgkmcnt(6)
v_add_u32 v255, 98304, v22
v_accvgpr_write_b32 a100, 0
v_mfma_f32_16x16x32_bf16 v[100:103], a[164:167], a[8:11], v[100:103]
v_mfma_f32_16x16x32_bf16 v[96:99], a[164:167], a[4:7], v[96:99]
ds_read_b64_tr_b16 a[180:181], v26 offset:256
ds_read_b64_tr_b16 a[182:183], v26 offset:6400
v_mfma_f32_16x16x32_bf16 v[92:95], a[164:167], a[0:3], v[92:95]
s_waitcnt lgkmcnt(6)
v_accvgpr_write_b32 a101, 0
v_mfma_f32_16x16x32_bf16 v[104:107], a[168:171], a[0:3], v[104:107]
v_mfma_f32_16x16x32_bf16 v[108:111], a[168:171], a[4:7], v[108:111]
ds_read_b64_tr_b16 a[184:185], v27 offset:256
ds_read_b64_tr_b16 a[186:187], v27 offset:6400
v_mfma_f32_16x16x32_bf16 v[112:115], a[168:171], a[8:11], v[112:115]
s_waitcnt lgkmcnt(6)
v_accvgpr_write_b32 a102, 0
v_mfma_f32_16x16x32_bf16 v[124:127], a[172:175], a[8:11], v[124:127]
v_accvgpr_write_b32 a103, 0
v_mfma_f32_16x16x32_bf16 v[120:123], a[172:175], a[4:7], v[120:123]
ds_read_b64_tr_b16 a[188:189], v28 offset:256
ds_read_b64_tr_b16 a[190:191], v28 offset:6400
v_mfma_f32_16x16x32_bf16 v[116:119], a[172:175], a[0:3], v[116:119]
s_waitcnt lgkmcnt(6)
v_mfma_f32_16x16x32_bf16 v[128:131], a[176:179], a[0:3], v[128:131]
v_accvgpr_write_b32 a104, 0
v_mfma_f32_16x16x32_bf16 v[132:135], a[176:179], a[4:7], v[132:135]
ds_read_b64_tr_b16 a[144:145], v252 offset:0
ds_read_b64_tr_b16 a[146:147], v252 offset:6144
v_mfma_f32_16x16x32_bf16 v[136:139], a[176:179], a[8:11], v[136:139]
s_waitcnt lgkmcnt(6)
v_accvgpr_write_b32 a105, 0
v_mfma_f32_16x16x32_bf16 v[148:151], a[180:183], a[8:11], v[148:151]
ds_read_b64_tr_b16 a[148:149], v253 offset:0
ds_read_b64_tr_b16 a[150:151], v253 offset:6144
v_mfma_f32_16x16x32_bf16 v[144:147], a[180:183], a[4:7], v[144:147]
v_mfma_f32_16x16x32_bf16 v[140:143], a[180:183], a[0:3], v[140:143]
s_waitcnt lgkmcnt(6)
v_accvgpr_write_b32 a106, 0
v_mfma_f32_16x16x32_bf16 v[152:155], a[184:187], a[0:3], v[152:155]
ds_read_b64_tr_b16 a[152:153], v254 offset:0
ds_read_b64_tr_b16 a[154:155], v254 offset:6144
v_mfma_f32_16x16x32_bf16 v[156:159], a[184:187], a[4:7], v[156:159]
v_accvgpr_write_b32 a107, 0
v_mfma_f32_16x16x32_bf16 v[160:163], a[184:187], a[8:11], v[160:163]
s_waitcnt lgkmcnt(6)
ds_read_b64_tr_b16 a[156:157], v255 offset:0
ds_read_b64_tr_b16 a[158:159], v255 offset:6144
v_mfma_f32_16x16x32_bf16 v[172:175], a[188:191], a[8:11], v[172:175]
v_add_u32 v25, 73728, v19
v_mfma_f32_16x16x32_bf16 v[168:171], a[188:191], a[4:7], v[168:171]
v_accvgpr_write_b32 a108, 0
v_mfma_f32_16x16x32_bf16 v[164:167], a[188:191], a[0:3], v[164:167]
s_waitcnt lgkmcnt(6)
ds_read_b64_tr_b16 a[160:161], v252 offset:128
ds_read_b64_tr_b16 a[162:163], v252 offset:6272
v_mfma_f32_16x16x32_bf16 v[32:35], a[144:147], a[12:15], v[32:35]
v_accvgpr_write_b32 a109, 0
v_mfma_f32_16x16x32_bf16 v[36:39], a[144:147], a[16:19], v[36:39]
ds_read_b64_tr_b16 a[164:165], v253 offset:128
ds_read_b64_tr_b16 a[166:167], v253 offset:6272
v_mfma_f32_16x16x32_bf16 v[40:43], a[144:147], a[20:23], v[40:43]
s_waitcnt lgkmcnt(8)
v_add_u32 v26, 73728, v20
v_mfma_f32_16x16x32_bf16 v[52:55], a[148:151], a[20:23], v[52:55]
v_accvgpr_write_b32 a110, 0
v_mfma_f32_16x16x32_bf16 v[48:51], a[148:151], a[16:19], v[48:51]
ds_read_b64_tr_b16 a[168:169], v254 offset:128
ds_read_b64_tr_b16 a[170:171], v254 offset:6272
v_mfma_f32_16x16x32_bf16 v[44:47], a[148:151], a[12:15], v[44:47]
s_waitcnt lgkmcnt(8)
v_accvgpr_write_b32 a111, 0
v_mfma_f32_16x16x32_bf16 v[56:59], a[152:155], a[12:15], v[56:59]
ds_read_b64_tr_b16 a[172:173], v255 offset:128
ds_read_b64_tr_b16 a[174:175], v255 offset:6272
v_mfma_f32_16x16x32_bf16 v[60:63], a[152:155], a[16:19], v[60:63]
v_add_u32 v27, 73728, v21
v_mfma_f32_16x16x32_bf16 v[64:67], a[152:155], a[20:23], v[64:67]
s_waitcnt lgkmcnt(8)
v_accvgpr_write_b32 a112, 0
v_mfma_f32_16x16x32_bf16 v[76:79], a[156:159], a[20:23], v[76:79]
ds_read_b64_tr_b16 a[176:177], v252 offset:256
ds_read_b64_tr_b16 a[178:179], v252 offset:6400
v_mfma_f32_16x16x32_bf16 v[72:75], a[156:159], a[16:19], v[72:75]
v_accvgpr_write_b32 a113, 0
v_mfma_f32_16x16x32_bf16 v[68:71], a[156:159], a[12:15], v[68:71]
s_waitcnt lgkmcnt(8)
ds_read_b64_tr_b16 a[180:181], v253 offset:256
ds_read_b64_tr_b16 a[182:183], v253 offset:6400
v_mfma_f32_16x16x32_bf16 v[80:83], a[160:163], a[12:15], v[80:83]
v_mfma_f32_16x16x32_bf16 v[84:87], a[160:163], a[16:19], v[84:87]
v_add_u32 v28, 73728, v22
v_accvgpr_write_b32 a114, 0
v_mfma_f32_16x16x32_bf16 v[88:91], a[160:163], a[20:23], v[88:91]
s_waitcnt lgkmcnt(8)
ds_read_b64_tr_b16 a[184:185], v254 offset:256
ds_read_b64_tr_b16 a[186:187], v254 offset:6400
v_mfma_f32_16x16x32_bf16 v[100:103], a[164:167], a[20:23], v[100:103]
v_accvgpr_write_b32 a115, 0
v_mfma_f32_16x16x32_bf16 v[96:99], a[164:167], a[16:19], v[96:99]
ds_read_b64_tr_b16 a[188:189], v255 offset:256
ds_read_b64_tr_b16 a[190:191], v255 offset:6400
v_mfma_f32_16x16x32_bf16 v[92:95], a[164:167], a[12:15], v[92:95]
s_waitcnt lgkmcnt(10)
v_mfma_f32_16x16x32_bf16 v[104:107], a[168:171], a[12:15], v[104:107]
v_accvgpr_write_b32 a116, 0
v_mfma_f32_16x16x32_bf16 v[108:111], a[168:171], a[16:19], v[108:111]
v_mfma_f32_16x16x32_bf16 v[112:115], a[168:171], a[20:23], v[112:115]
s_waitcnt lgkmcnt(8)
v_accvgpr_write_b32 a117, 0
v_mfma_f32_16x16x32_bf16 v[124:127], a[172:175], a[20:23], v[124:127]
v_mfma_f32_16x16x32_bf16 v[120:123], a[172:175], a[16:19], v[120:123]
v_mfma_f32_16x16x32_bf16 v[116:119], a[172:175], a[12:15], v[116:119]
s_waitcnt lgkmcnt(6)
v_mfma_f32_16x16x32_bf16 v[128:131], a[176:179], a[12:15], v[128:131]
s_waitcnt vmcnt(18)
s_waitcnt lgkmcnt(0)
v_accvgpr_write_b32 a118, 0
v_mfma_f32_16x16x32_bf16 v[132:135], a[176:179], a[16:19], v[132:135]
s_barrier
v_accvgpr_write_b32 a119, 0
v_mfma_f32_16x16x32_bf16 v[136:139], a[176:179], a[20:23], v[136:139]
ds_read_b64_tr_b16 a[144:145], v25 offset:0
ds_read_b64_tr_b16 a[146:147], v25 offset:6144
v_mfma_f32_16x16x32_bf16 v[148:151], a[180:183], a[20:23], v[148:151]
s_add_u32 m0, s37, 36864
v_mfma_f32_16x16x32_bf16 v[144:147], a[180:183], a[16:19], v[144:147]
ds_read_b64_tr_b16 a[148:149], v26 offset:0
ds_read_b64_tr_b16 a[150:151], v26 offset:6144
v_mfma_f32_16x16x32_bf16 v[140:143], a[180:183], a[12:15], v[140:143]
buffer_load_dwordx4 v5, s[8:11], s38 offen offset:0 nt lds
v_mfma_f32_16x16x32_bf16 v[152:155], a[184:187], a[12:15], v[152:155]
v_accvgpr_write_b32 a120, 0
v_mfma_f32_16x16x32_bf16 v[156:159], a[184:187], a[16:19], v[156:159]
ds_read_b64_tr_b16 a[152:153], v27 offset:0
ds_read_b64_tr_b16 a[154:155], v27 offset:6144
v_mfma_f32_16x16x32_bf16 v[160:163], a[184:187], a[20:23], v[160:163]
buffer_load_dwordx4 v6, s[8:11], s38 offen offset:1024 nt lds
v_mfma_f32_16x16x32_bf16 v[172:175], a[188:191], a[20:23], v[172:175]
v_accvgpr_write_b32 a121, 0
v_add_u32 v252, 86016, v19
v_mfma_f32_16x16x32_bf16 v[168:171], a[188:191], a[16:19], v[168:171]
ds_read_b64_tr_b16 a[156:157], v28 offset:0
ds_read_b64_tr_b16 a[158:159], v28 offset:6144
v_mfma_f32_16x16x32_bf16 v[164:167], a[188:191], a[12:15], v[164:167]
s_waitcnt lgkmcnt(6)
buffer_load_dwordx4 v7, s[8:11], s38 offen offset:2048 nt lds
v_mfma_f32_16x16x32_bf16 v[32:35], a[144:147], a[24:27], v[32:35]
s_add_u32 s38, s38, 12288
s_cmp_ge_u32 s38, 393216
s_cselect_b32 s38, 0, s38
v_mfma_f32_16x16x32_bf16 v[36:39], a[144:147], a[28:31], v[36:39]
ds_read_b64_tr_b16 a[160:161], v25 offset:128
ds_read_b64_tr_b16 a[162:163], v25 offset:6272
v_mfma_f32_16x16x32_bf16 v[40:43], a[144:147], a[32:35], v[40:43]
s_waitcnt lgkmcnt(6)
v_accvgpr_write_b32 a122, 0
v_accvgpr_write_b32 a123, 0
v_mfma_f32_16x16x32_bf16 v[52:55], a[148:151], a[32:35], v[52:55]
v_add_u32 v253, 86016, v20
v_accvgpr_write_b32 a124, 0
v_mfma_f32_16x16x32_bf16 v[48:51], a[148:151], a[28:31], v[48:51]
ds_read_b64_tr_b16 a[164:165], v26 offset:128
ds_read_b64_tr_b16 a[166:167], v26 offset:6272
v_mfma_f32_16x16x32_bf16 v[44:47], a[148:151], a[24:27], v[44:47]
s_waitcnt lgkmcnt(6)
v_accvgpr_write_b32 a125, 0
v_mfma_f32_16x16x32_bf16 v[56:59], a[152:155], a[24:27], v[56:59]
v_mfma_f32_16x16x32_bf16 v[60:63], a[152:155], a[28:31], v[60:63]
ds_read_b64_tr_b16 a[168:169], v27 offset:128
ds_read_b64_tr_b16 a[170:171], v27 offset:6272
v_mfma_f32_16x16x32_bf16 v[64:67], a[152:155], a[32:35], v[64:67]
s_waitcnt lgkmcnt(6)
v_add_u32 v254, 86016, v21
v_accvgpr_write_b32 a126, 0
v_mfma_f32_16x16x32_bf16 v[76:79], a[156:159], a[32:35], v[76:79]
v_mfma_f32_16x16x32_bf16 v[72:75], a[156:159], a[28:31], v[72:75]
ds_read_b64_tr_b16 a[172:173], v28 offset:128
ds_read_b64_tr_b16 a[174:175], v28 offset:6272
v_mfma_f32_16x16x32_bf16 v[68:71], a[156:159], a[24:27], v[68:71]
s_waitcnt lgkmcnt(6)
v_accvgpr_write_b32 a127, 0
v_mfma_f32_16x16x32_bf16 v[80:83], a[160:163], a[24:27], v[80:83]
v_accvgpr_write_b32 a128, 0
v_mfma_f32_16x16x32_bf16 v[84:87], a[160:163], a[28:31], v[84:87]
ds_read_b64_tr_b16 a[176:177], v25 offset:256
ds_read_b64_tr_b16 a[178:179], v25 offset:6400
v_mfma_f32_16x16x32_bf16 v[88:91], a[160:163], a[32:35], v[88:91]
s_waitcnt lgkmcnt(6)
v_add_u32 v255, 86016, v22
v_mfma_f32_16x16x32_bf16 v[100:103], a[164:167], a[32:35], v[100:103]
v_accvgpr_write_b32 a129, 0
v_mfma_f32_16x16x32_bf16 v[96:99], a[164:167], a[28:31], v[96:99]
ds_read_b64_tr_b16 a[180:181], v26 offset:256
ds_read_b64_tr_b16 a[182:183], v26 offset:6400
v_mfma_f32_16x16x32_bf16 v[92:95], a[164:167], a[24:27], v[92:95]
s_waitcnt lgkmcnt(6)
v_accvgpr_write_b32 a130, 0
v_mfma_f32_16x16x32_bf16 v[104:107], a[168:171], a[24:27], v[104:107]
v_mfma_f32_16x16x32_bf16 v[108:111], a[168:171], a[28:31], v[108:111]
ds_read_b64_tr_b16 a[184:185], v27 offset:256
ds_read_b64_tr_b16 a[186:187], v27 offset:6400
v_mfma_f32_16x16x32_bf16 v[112:115], a[168:171], a[32:35], v[112:115]
s_waitcnt lgkmcnt(6)
v_accvgpr_write_b32 a131, 0
v_mfma_f32_16x16x32_bf16 v[124:127], a[172:175], a[32:35], v[124:127]
v_mfma_f32_16x16x32_bf16 v[120:123], a[172:175], a[28:31], v[120:123]
ds_read_b64_tr_b16 a[188:189], v28 offset:256
ds_read_b64_tr_b16 a[190:191], v28 offset:6400
v_mfma_f32_16x16x32_bf16 v[116:119], a[172:175], a[24:27], v[116:119]
s_waitcnt lgkmcnt(6)
v_accvgpr_write_b32 a132, 0
v_mfma_f32_16x16x32_bf16 v[128:131], a[176:179], a[24:27], v[128:131]
v_mfma_f32_16x16x32_bf16 v[132:135], a[176:179], a[28:31], v[132:135]
ds_read_b64_tr_b16 a[144:145], v252 offset:0
ds_read_b64_tr_b16 a[146:147], v252 offset:6144
v_mfma_f32_16x16x32_bf16 v[136:139], a[176:179], a[32:35], v[136:139]
s_waitcnt lgkmcnt(6)
v_accvgpr_write_b32 a133, 0
v_mfma_f32_16x16x32_bf16 v[148:151], a[180:183], a[32:35], v[148:151]
s_add_u32 m0, s37, 49152
ds_read_b64_tr_b16 a[148:149], v253 offset:0
ds_read_b64_tr_b16 a[150:151], v253 offset:6144
v_mfma_f32_16x16x32_bf16 v[144:147], a[180:183], a[28:31], v[144:147]
buffer_load_dwordx4 v2, s[4:7], s42 offen offset:0 nt lds
v_mfma_f32_16x16x32_bf16 v[140:143], a[180:183], a[24:27], v[140:143]
s_waitcnt lgkmcnt(6)
v_accvgpr_write_b32 a134, 0
v_mfma_f32_16x16x32_bf16 v[152:155], a[184:187], a[24:27], v[152:155]
ds_read_b64_tr_b16 a[152:153], v254 offset:0
ds_read_b64_tr_b16 a[154:155], v254 offset:6144
v_mfma_f32_16x16x32_bf16 v[156:159], a[184:187], a[28:31], v[156:159]
buffer_load_dwordx4 v3, s[4:7], s42 offen offset:1024 nt lds
v_mfma_f32_16x16x32_bf16 v[160:163], a[184:187], a[32:35], v[160:163]
s_waitcnt lgkmcnt(6)
ds_read_b64_tr_b16 a[156:157], v255 offset:0
ds_read_b64_tr_b16 a[158:159], v255 offset:6144
v_mfma_f32_16x16x32_bf16 v[172:175], a[188:191], a[32:35], v[172:175]
buffer_load_dwordx4 v4, s[4:7], s42 offen offset:2048 nt lds
v_mfma_f32_16x16x32_bf16 v[168:171], a[188:191], a[28:31], v[168:171]
s_add_u32 s42, s42, 12288
v_accvgpr_write_b32 a135, 0
v_add_u32 v25, 110592, v19
v_mfma_f32_16x16x32_bf16 v[164:167], a[188:191], a[24:27], v[164:167]
s_waitcnt lgkmcnt(6)
ds_read_b64_tr_b16 a[160:161], v252 offset:128
ds_read_b64_tr_b16 a[162:163], v252 offset:6272
v_mfma_f32_16x16x32_bf16 v[32:35], a[144:147], a[36:39], v[32:35]
s_cmp_ge_u32 s42, 393216
s_cselect_b32 s42, 0, s42
v_accvgpr_write_b32 a136, 0
v_mfma_f32_16x16x32_bf16 v[36:39], a[144:147], a[40:43], v[36:39]
ds_read_b64_tr_b16 a[164:165], v253 offset:128
ds_read_b64_tr_b16 a[166:167], v253 offset:6272
v_mfma_f32_16x16x32_bf16 v[40:43], a[144:147], a[44:47], v[40:43]
s_waitcnt lgkmcnt(8)
v_accvgpr_write_b32 a137, 0
v_add_u32 v26, 110592, v20
v_mfma_f32_16x16x32_bf16 v[52:55], a[148:151], a[44:47], v[52:55]
v_accvgpr_write_b32 a138, 0
v_mfma_f32_16x16x32_bf16 v[48:51], a[148:151], a[40:43], v[48:51]
ds_read_b64_tr_b16 a[168:169], v254 offset:128
ds_read_b64_tr_b16 a[170:171], v254 offset:6272
v_mfma_f32_16x16x32_bf16 v[44:47], a[148:151], a[36:39], v[44:47]
s_waitcnt lgkmcnt(8)
v_accvgpr_write_b32 a139, 0
v_mfma_f32_16x16x32_bf16 v[56:59], a[152:155], a[36:39], v[56:59]
ds_read_b64_tr_b16 a[172:173], v255 offset:128
ds_read_b64_tr_b16 a[174:175], v255 offset:6272
v_mfma_f32_16x16x32_bf16 v[60:63], a[152:155], a[40:43], v[60:63]
v_accvgpr_write_b32 a140, 0
v_add_u32 v27, 110592, v21
v_mfma_f32_16x16x32_bf16 v[64:67], a[152:155], a[44:47], v[64:67]
s_waitcnt lgkmcnt(8)
v_mfma_f32_16x16x32_bf16 v[76:79], a[156:159], a[44:47], v[76:79]
ds_read_b64_tr_b16 a[176:177], v252 offset:256
ds_read_b64_tr_b16 a[178:179], v252 offset:6400
v_mfma_f32_16x16x32_bf16 v[72:75], a[156:159], a[40:43], v[72:75]
v_accvgpr_write_b32 a141, 0
v_mfma_f32_16x16x32_bf16 v[68:71], a[156:159], a[36:39], v[68:71]
s_waitcnt lgkmcnt(8)
ds_read_b64_tr_b16 a[180:181], v253 offset:256
ds_read_b64_tr_b16 a[182:183], v253 offset:6400
v_mfma_f32_16x16x32_bf16 v[80:83], a[160:163], a[36:39], v[80:83]
v_accvgpr_write_b32 a142, 0
v_mfma_f32_16x16x32_bf16 v[84:87], a[160:163], a[40:43], v[84:87]
v_add_u32 v28, 110592, v22
v_mfma_f32_16x16x32_bf16 v[88:91], a[160:163], a[44:47], v[88:91]
s_waitcnt lgkmcnt(8)
ds_read_b64_tr_b16 a[184:185], v254 offset:256
ds_read_b64_tr_b16 a[186:187], v254 offset:6400
v_mfma_f32_16x16x32_bf16 v[100:103], a[164:167], a[44:47], v[100:103]
v_accvgpr_write_b32 a143, 0
v_mfma_f32_16x16x32_bf16 v[96:99], a[164:167], a[40:43], v[96:99]
ds_read_b64_tr_b16 a[188:189], v255 offset:256
ds_read_b64_tr_b16 a[190:191], v255 offset:6400
v_mfma_f32_16x16x32_bf16 v[92:95], a[164:167], a[36:39], v[92:95]
s_waitcnt lgkmcnt(10)
v_mfma_f32_16x16x32_bf16 v[104:107], a[168:171], a[36:39], v[104:107]
v_mfma_f32_16x16x32_bf16 v[108:111], a[168:171], a[40:43], v[108:111]
v_mfma_f32_16x16x32_bf16 v[112:115], a[168:171], a[44:47], v[112:115]
s_waitcnt lgkmcnt(8)
v_mfma_f32_16x16x32_bf16 v[124:127], a[172:175], a[44:47], v[124:127]
v_mfma_f32_16x16x32_bf16 v[120:123], a[172:175], a[40:43], v[120:123]
v_mfma_f32_16x16x32_bf16 v[116:119], a[172:175], a[36:39], v[116:119]
s_waitcnt lgkmcnt(6)
v_mfma_f32_16x16x32_bf16 v[128:131], a[176:179], a[36:39], v[128:131]
s_waitcnt vmcnt(9)
s_waitcnt lgkmcnt(0)
v_mfma_f32_16x16x32_bf16 v[132:135], a[176:179], a[40:43], v[132:135]
s_barrier
v_mfma_f32_16x16x32_bf16 v[136:139], a[176:179], a[44:47], v[136:139]
ds_read_b64_tr_b16 a[144:145], v25 offset:0
ds_read_b64_tr_b16 a[146:147], v25 offset:6144
v_mfma_f32_16x16x32_bf16 v[148:151], a[180:183], a[44:47], v[148:151]
s_add_u32 m0, s37, 61440
v_mfma_f32_16x16x32_bf16 v[144:147], a[180:183], a[40:43], v[144:147]
ds_read_b64_tr_b16 a[148:149], v25 offset:12288
ds_read_b64_tr_b16 a[150:151], v25 offset:18432
v_mfma_f32_16x16x32_bf16 v[140:143], a[180:183], a[36:39], v[140:143]
v_mfma_f32_16x16x32_bf16 v[152:155], a[184:187], a[36:39], v[152:155]
v_mfma_f32_16x16x32_bf16 v[156:159], a[184:187], a[40:43], v[156:159]
ds_read_b64_tr_b16 a[152:153], v25 offset:36864
ds_read_b64_tr_b16 a[154:155], v25 offset:43008
v_mfma_f32_16x16x32_bf16 v[160:163], a[184:187], a[44:47], v[160:163]
v_mfma_f32_16x16x32_bf16 v[172:175], a[188:191], a[44:47], v[172:175]
buffer_load_dwordx4 v5, s[8:11], s38 offen offset:0 nt lds
v_mfma_f32_16x16x32_bf16 v[168:171], a[188:191], a[40:43], v[168:171]
ds_read_b64_tr_b16 a[156:157], v25 offset:24576
ds_read_b64_tr_b16 a[158:159], v25 offset:30720
v_mfma_f32_16x16x32_bf16 v[164:167], a[188:191], a[36:39], v[164:167]
s_waitcnt lgkmcnt(6)
v_mfma_f32_16x16x32_bf16 v[32:35], a[144:147], a[48:51], v[32:35]
v_mfma_f32_16x16x32_bf16 v[36:39], a[144:147], a[52:55], v[36:39]
ds_read_b64_tr_b16 a[160:161], v26 offset:0
ds_read_b64_tr_b16 a[162:163], v26 offset:6144
v_mfma_f32_16x16x32_bf16 v[40:43], a[144:147], a[56:59], v[40:43]
s_waitcnt lgkmcnt(6)
v_mfma_f32_16x16x32_bf16 v[40:43], a[148:151], a[68:71], v[40:43]
v_mfma_f32_16x16x32_bf16 v[36:39], a[148:151], a[64:67], v[36:39]
ds_read_b64_tr_b16 a[164:165], v26 offset:12288
ds_read_b64_tr_b16 a[166:167], v26 offset:18432
v_mfma_f32_16x16x32_bf16 v[32:35], a[148:151], a[60:63], v[32:35]
s_waitcnt lgkmcnt(6)
buffer_load_dwordx4 v6, s[8:11], s38 offen offset:1024 nt lds
v_mfma_f32_16x16x32_bf16 v[32:35], a[152:155], a[84:87], v[32:35]
v_mfma_f32_16x16x32_bf16 v[36:39], a[152:155], a[88:91], v[36:39]
ds_read_b64_tr_b16 a[168:169], v26 offset:36864
ds_read_b64_tr_b16 a[170:171], v26 offset:43008
v_mfma_f32_16x16x32_bf16 v[40:43], a[152:155], a[92:95], v[40:43]
s_waitcnt lgkmcnt(6)
v_mfma_f32_16x16x32_bf16 v[40:43], a[156:159], a[80:83], v[40:43]
v_mfma_f32_16x16x32_bf16 v[36:39], a[156:159], a[76:79], v[36:39]
ds_read_b64_tr_b16 a[172:173], v26 offset:24576
ds_read_b64_tr_b16 a[174:175], v26 offset:30720
v_mfma_f32_16x16x32_bf16 v[32:35], a[156:159], a[72:75], v[32:35]
s_waitcnt lgkmcnt(6)
v_mfma_f32_16x16x32_bf16 v[44:47], a[160:163], a[48:51], v[44:47]
buffer_load_dwordx4 v7, s[8:11], s38 offen offset:2048 nt lds
v_mfma_f32_16x16x32_bf16 v[48:51], a[160:163], a[52:55], v[48:51]
ds_read_b64_tr_b16 a[176:177], v27 offset:0
ds_read_b64_tr_b16 a[178:179], v27 offset:6144
v_mfma_f32_16x16x32_bf16 v[52:55], a[160:163], a[56:59], v[52:55]
s_waitcnt lgkmcnt(6)
v_mfma_f32_16x16x32_bf16 v[52:55], a[164:167], a[68:71], v[52:55]
v_mfma_f32_16x16x32_bf16 v[48:51], a[164:167], a[64:67], v[48:51]
ds_read_b64_tr_b16 a[180:181], v27 offset:12288
ds_read_b64_tr_b16 a[182:183], v27 offset:18432
v_mfma_f32_16x16x32_bf16 v[44:47], a[164:167], a[60:63], v[44:47]
s_waitcnt lgkmcnt(6)
v_mfma_f32_16x16x32_bf16 v[44:47], a[168:171], a[84:87], v[44:47]
v_mfma_f32_16x16x32_bf16 v[48:51], a[168:171], a[88:91], v[48:51]
ds_read_b64_tr_b16 a[184:185], v27 offset:36864
ds_read_b64_tr_b16 a[186:187], v27 offset:43008
v_mfma_f32_16x16x32_bf16 v[52:55], a[168:171], a[92:95], v[52:55]
s_waitcnt lgkmcnt(6)
v_mfma_f32_16x16x32_bf16 v[52:55], a[172:175], a[80:83], v[52:55]
s_add_u32 s38, s38, 12288
v_mfma_f32_16x16x32_bf16 v[48:51], a[172:175], a[76:79], v[48:51]
ds_read_b64_tr_b16 a[188:189], v27 offset:24576
ds_read_b64_tr_b16 a[190:191], v27 offset:30720
v_mfma_f32_16x16x32_bf16 v[44:47], a[172:175], a[72:75], v[44:47]
s_waitcnt lgkmcnt(6)
v_mfma_f32_16x16x32_bf16 v[56:59], a[176:179], a[48:51], v[56:59]
v_mfma_f32_16x16x32_bf16 v[60:63], a[176:179], a[52:55], v[60:63]
ds_read_b64_tr_b16 a[144:145], v28 offset:0
ds_read_b64_tr_b16 a[146:147], v28 offset:6144
v_mfma_f32_16x16x32_bf16 v[64:67], a[176:179], a[56:59], v[64:67]
s_waitcnt lgkmcnt(6)
v_mul_f32 v32, s34, v32
v_mul_f32 v33, s34, v33
v_mfma_f32_16x16x32_bf16 v[64:67], a[180:183], a[68:71], v[64:67]
s_cmp_ge_u32 s38, 393216
s_cselect_b32 s38, 0, s38
v_mul_f32 v34, s34, v34
v_mfma_f32_16x16x32_bf16 v[60:63], a[180:183], a[64:67], v[60:63]
ds_read_b64_tr_b16 a[148:149], v28 offset:12288
ds_read_b64_tr_b16 a[150:151], v28 offset:18432
v_mfma_f32_16x16x32_bf16 v[56:59], a[180:183], a[60:63], v[56:59]
s_waitcnt lgkmcnt(6)
v_mul_f32 v35, s34, v35
v_mul_f32 v44, s34, v44
v_mfma_f32_16x16x32_bf16 v[56:59], a[184:187], a[84:87], v[56:59]
v_mul_f32 v45, s34, v45
v_mul_f32 v46, s34, v46
v_mfma_f32_16x16x32_bf16 v[60:63], a[184:187], a[88:91], v[60:63]
ds_read_b64_tr_b16 a[152:153], v28 offset:36864
ds_read_b64_tr_b16 a[154:155], v28 offset:43008
v_mfma_f32_16x16x32_bf16 v[64:67], a[184:187], a[92:95], v[64:67]
s_waitcnt lgkmcnt(6)
v_mul_f32 v47, s34, v47
v_cvt_pk_bf16_f32 v176, v32, v33
v_mfma_f32_16x16x32_bf16 v[64:67], a[188:191], a[80:83], v[64:67]
v_cvt_pk_bf16_f32 v177, v34, v35
v_cvt_pk_bf16_f32 v178, v44, v45
v_mfma_f32_16x16x32_bf16 v[60:63], a[188:191], a[76:79], v[60:63]
ds_read_b64_tr_b16 a[156:157], v28 offset:24576
ds_read_b64_tr_b16 a[158:159], v28 offset:30720
v_mfma_f32_16x16x32_bf16 v[56:59], a[188:191], a[72:75], v[56:59]
s_waitcnt lgkmcnt(6)
v_cvt_pk_bf16_f32 v179, v46, v47
v_mul_f32 v36, s34, v36
v_mfma_f32_16x16x32_bf16 v[68:71], a[144:147], a[48:51], v[68:71]
s_add_u32 m0, s37, 73728
v_mul_f32 v37, s34, v37
v_mul_f32 v38, s34, v38
v_mfma_f32_16x16x32_bf16 v[72:75], a[144:147], a[52:55], v[72:75]
ds_read_b64_tr_b16 a[160:161], v25 offset:128
ds_read_b64_tr_b16 a[162:163], v25 offset:6272
v_mfma_f32_16x16x32_bf16 v[76:79], a[144:147], a[56:59], v[76:79]
s_waitcnt lgkmcnt(6)
v_mul_f32 v39, s34, v39
v_mul_f32 v48, s34, v48
v_mfma_f32_16x16x32_bf16 v[76:79], a[148:151], a[68:71], v[76:79]
v_mul_f32 v49, s34, v49
v_mul_f32 v50, s34, v50
v_mfma_f32_16x16x32_bf16 v[72:75], a[148:151], a[64:67], v[72:75]
ds_read_b64_tr_b16 a[164:165], v25 offset:12416
ds_read_b64_tr_b16 a[166:167], v25 offset:18560
v_mfma_f32_16x16x32_bf16 v[68:71], a[148:151], a[60:63], v[68:71]
s_waitcnt lgkmcnt(6)
v_mul_f32 v51, s34, v51
v_cvt_pk_bf16_f32 v200, v36, v37
v_mfma_f32_16x16x32_bf16 v[68:71], a[152:155], a[84:87], v[68:71]
buffer_load_dwordx4 v2, s[4:7], s42 offen offset:0 nt lds
v_mfma_f32_16x16x32_bf16 v[72:75], a[152:155], a[88:91], v[72:75]
ds_read_b64_tr_b16 a[168:169], v25 offset:36992
ds_read_b64_tr_b16 a[170:171], v25 offset:43136
v_mfma_f32_16x16x32_bf16 v[76:79], a[152:155], a[92:95], v[76:79]
s_waitcnt lgkmcnt(6)
v_cvt_pk_bf16_f32 v201, v38, v39
v_cvt_pk_bf16_f32 v202, v48, v49
v_mfma_f32_16x16x32_bf16 v[76:79], a[156:159], a[80:83], v[76:79]
v_cvt_pk_bf16_f32 v203, v50, v51
v_mul_f32 v40, s34, v40
v_mfma_f32_16x16x32_bf16 v[72:75], a[156:159], a[76:79], v[72:75]
ds_read_b64_tr_b16 a[172:173], v25 offset:24704
ds_read_b64_tr_b16 a[174:175], v25 offset:30848
v_mfma_f32_16x16x32_bf16 v[68:71], a[156:159], a[72:75], v[68:71]
s_waitcnt lgkmcnt(6)
v_mul_f32 v41, s34, v41
v_mul_f32 v42, s34, v42
v_mfma_f32_16x16x32_bf16 v[80:83], a[160:163], a[48:51], v[80:83]
v_mul_f32 v43, s34, v43
v_mul_f32 v52, s34, v52
v_mfma_f32_16x16x32_bf16 v[84:87], a[160:163], a[52:55], v[84:87]
ds_read_b64_tr_b16 a[176:177], v26 offset:128
ds_read_b64_tr_b16 a[178:179], v26 offset:6272
v_mfma_f32_16x16x32_bf16 v[88:91], a[160:163], a[56:59], v[88:91]
s_waitcnt lgkmcnt(6)
buffer_load_dwordx4 v3, s[4:7], s42 offen offset:1024 nt lds
v_mfma_f32_16x16x32_bf16 v[88:91], a[164:167], a[68:71], v[88:91]
v_mul_f32 v53, s34, v53
v_mul_f32 v54, s34, v54
v_mfma_f32_16x16x32_bf16 v[84:87], a[164:167], a[64:67], v[84:87]
ds_read_b64_tr_b16 a[180:181], v26 offset:12416
ds_read_b64_tr_b16 a[182:183], v26 offset:18560
v_mfma_f32_16x16x32_bf16 v[80:83], a[164:167], a[60:63], v[80:83]
s_waitcnt lgkmcnt(6)
v_mul_f32 v55, s34, v55
v_cvt_pk_bf16_f32 v224, v40, v41
v_mfma_f32_16x16x32_bf16 v[80:83], a[168:171], a[84:87], v[80:83]
v_cvt_pk_bf16_f32 v225, v42, v43
v_cvt_pk_bf16_f32 v226, v52, v53
v_mfma_f32_16x16x32_bf16 v[84:87], a[168:171], a[88:91], v[84:87]
ds_read_b64_tr_b16 a[184:185], v26 offset:36992
ds_read_b64_tr_b16 a[186:187], v26 offset:43136
v_mfma_f32_16x16x32_bf16 v[88:91], a[168:171], a[92:95], v[88:91]
s_waitcnt lgkmcnt(6)
v_cvt_pk_bf16_f32 v227, v54, v55
v_permlane16_swap_b32 v176, v178
v_mfma_f32_16x16x32_bf16 v[88:91], a[172:175], a[80:83], v[88:91]
buffer_load_dwordx4 v4, s[4:7], s42 offen offset:2048 nt lds
v_mfma_f32_16x16x32_bf16 v[84:87], a[172:175], a[76:79], v[84:87]
ds_read_b64_tr_b16 a[188:189], v26 offset:24704
ds_read_b64_tr_b16 a[190:191], v26 offset:30848
v_mfma_f32_16x16x32_bf16 v[80:83], a[172:175], a[72:75], v[80:83]
s_waitcnt lgkmcnt(6)
v_permlane16_swap_b32 v177, v179
v_permlane16_swap_b32 v200, v202
v_mfma_f32_16x16x32_bf16 v[92:95], a[176:179], a[48:51], v[92:95]
v_permlane16_swap_b32 v201, v203
v_permlane16_swap_b32 v224, v226
v_mfma_f32_16x16x32_bf16 v[96:99], a[176:179], a[52:55], v[96:99]
ds_read_b64_tr_b16 a[144:145], v27 offset:128
ds_read_b64_tr_b16 a[146:147], v27 offset:6272
v_mfma_f32_16x16x32_bf16 v[100:103], a[176:179], a[56:59], v[100:103]
s_waitcnt lgkmcnt(6)
v_permlane16_swap_b32 v225, v227
v_mul_f32 v56, s34, v56
v_mfma_f32_16x16x32_bf16 v[100:103], a[180:183], a[68:71], v[100:103]
v_mul_f32 v57, s34, v57
v_mul_f32 v58, s34, v58
v_mfma_f32_16x16x32_bf16 v[96:99], a[180:183], a[64:67], v[96:99]
ds_read_b64_tr_b16 a[148:149], v27 offset:12416
ds_read_b64_tr_b16 a[150:151], v27 offset:18560
v_mfma_f32_16x16x32_bf16 v[92:95], a[180:183], a[60:63], v[92:95]
s_waitcnt lgkmcnt(6)
v_mul_f32 v59, s34, v59
v_mul_f32 v68, s34, v68
v_mfma_f32_16x16x32_bf16 v[92:95], a[184:187], a[84:87], v[92:95]
s_add_u32 s42, s42, 12288
v_mul_f32 v69, s34, v69
v_mul_f32 v70, s34, v70
v_mfma_f32_16x16x32_bf16 v[96:99], a[184:187], a[88:91], v[96:99]
ds_read_b64_tr_b16 a[152:153], v27 offset:36992
ds_read_b64_tr_b16 a[154:155], v27 offset:43136
v_mfma_f32_16x16x32_bf16 v[100:103], a[184:187], a[92:95], v[100:103]
s_waitcnt lgkmcnt(6)
v_mul_f32 v71, s34, v71
v_cvt_pk_bf16_f32 v180, v56, v57
v_mfma_f32_16x16x32_bf16 v[100:103], a[188:191], a[80:83], v[100:103]
v_cvt_pk_bf16_f32 v181, v58, v59
v_cvt_pk_bf16_f32 v182, v68, v69
v_mfma_f32_16x16x32_bf16 v[96:99], a[188:191], a[76:79], v[96:99]
ds_read_b64_tr_b16 a[156:157], v27 offset:24704
ds_read_b64_tr_b16 a[158:159], v27 offset:30848
v_mfma_f32_16x16x32_bf16 v[92:95], a[188:191], a[72:75], v[92:95]
s_waitcnt lgkmcnt(6)
v_cvt_pk_bf16_f32 v183, v70, v71
v_mul_f32 v60, s34, v60
v_mfma_f32_16x16x32_bf16 v[104:107], a[144:147], a[48:51], v[104:107]
v_mul_f32 v61, s34, v61
v_mul_f32 v62, s34, v62
v_mfma_f32_16x16x32_bf16 v[108:111], a[144:147], a[52:55], v[108:111]
ds_read_b64_tr_b16 a[160:161], v28 offset:128
ds_read_b64_tr_b16 a[162:163], v28 offset:6272
v_mfma_f32_16x16x32_bf16 v[112:115], a[144:147], a[56:59], v[112:115]
s_waitcnt lgkmcnt(6)
s_cmp_ge_u32 s42, 393216
s_cselect_b32 s42, 0, s42
v_mfma_f32_16x16x32_bf16 v[112:115], a[148:151], a[68:71], v[112:115]
v_mul_f32 v63, s34, v63
v_mul_f32 v72, s34, v72
v_mfma_f32_16x16x32_bf16 v[108:111], a[148:151], a[64:67], v[108:111]
ds_read_b64_tr_b16 a[164:165], v28 offset:12416
ds_read_b64_tr_b16 a[166:167], v28 offset:18560
v_mfma_f32_16x16x32_bf16 v[104:107], a[148:151], a[60:63], v[104:107]
s_waitcnt lgkmcnt(6)
v_mul_f32 v73, s34, v73
v_mul_f32 v74, s34, v74
v_mfma_f32_16x16x32_bf16 v[104:107], a[152:155], a[84:87], v[104:107]
v_mul_f32 v75, s34, v75
v_cvt_pk_bf16_f32 v204, v60, v61
v_mfma_f32_16x16x32_bf16 v[108:111], a[152:155], a[88:91], v[108:111]
ds_read_b64_tr_b16 a[168:169], v28 offset:36992
ds_read_b64_tr_b16 a[170:171], v28 offset:43136
v_mfma_f32_16x16x32_bf16 v[112:115], a[152:155], a[92:95], v[112:115]
s_waitcnt lgkmcnt(6)
v_cvt_pk_bf16_f32 v205, v62, v63
v_cvt_pk_bf16_f32 v206, v72, v73
v_mfma_f32_16x16x32_bf16 v[112:115], a[156:159], a[80:83], v[112:115]
s_add_u32 m0, s37, 86016
v_cvt_pk_bf16_f32 v207, v74, v75
v_mul_f32 v64, s34, v64
v_mfma_f32_16x16x32_bf16 v[108:111], a[156:159], a[76:79], v[108:111]
ds_read_b64_tr_b16 a[172:173], v28 offset:24704
ds_read_b64_tr_b16 a[174:175], v28 offset:30848
v_mfma_f32_16x16x32_bf16 v[104:107], a[156:159], a[72:75], v[104:107]
s_waitcnt lgkmcnt(6)
v_mul_f32 v65, s34, v65
v_mul_f32 v66, s34, v66
v_mfma_f32_16x16x32_bf16 v[116:119], a[160:163], a[48:51], v[116:119]
v_mul_f32 v67, s34, v67
v_mul_f32 v76, s34, v76
v_mfma_f32_16x16x32_bf16 v[120:123], a[160:163], a[52:55], v[120:123]
ds_read_b64_tr_b16 a[176:177], v25 offset:256
ds_read_b64_tr_b16 a[178:179], v25 offset:6400
v_mfma_f32_16x16x32_bf16 v[124:127], a[160:163], a[56:59], v[124:127]
s_waitcnt lgkmcnt(6)
v_mul_f32 v77, s34, v77
v_mul_f32 v78, s34, v78
v_mfma_f32_16x16x32_bf16 v[124:127], a[164:167], a[68:71], v[124:127]
v_mul_f32 v79, s34, v79
v_cvt_pk_bf16_f32 v228, v64, v65
v_mfma_f32_16x16x32_bf16 v[120:123], a[164:167], a[64:67], v[120:123]
ds_read_b64_tr_b16 a[180:181], v25 offset:12544
ds_read_b64_tr_b16 a[182:183], v25 offset:18688
v_mfma_f32_16x16x32_bf16 v[116:119], a[164:167], a[60:63], v[116:119]
s_waitcnt lgkmcnt(6)
buffer_load_dwordx4 v5, s[8:11], s38 offen offset:0 nt lds
v_mfma_f32_16x16x32_bf16 v[116:119], a[168:171], a[84:87], v[116:119]
v_cvt_pk_bf16_f32 v229, v66, v67
v_cvt_pk_bf16_f32 v230, v76, v77
v_mfma_f32_16x16x32_bf16 v[120:123], a[168:171], a[88:91], v[120:123]
ds_read_b64_tr_b16 a[184:185], v25 offset:37120
ds_read_b64_tr_b16 a[186:187], v25 offset:43264
v_mfma_f32_16x16x32_bf16 v[124:127], a[168:171], a[92:95], v[124:127]
s_waitcnt lgkmcnt(6)
v_cvt_pk_bf16_f32 v231, v78, v79
v_permlane16_swap_b32 v180, v182
v_mfma_f32_16x16x32_bf16 v[124:127], a[172:175], a[80:83], v[124:127]
v_permlane16_swap_b32 v181, v183
v_permlane16_swap_b32 v204, v206
v_mfma_f32_16x16x32_bf16 v[120:123], a[172:175], a[76:79], v[120:123]
ds_read_b64_tr_b16 a[188:189], v25 offset:24832
ds_read_b64_tr_b16 a[190:191], v25 offset:30976
v_mfma_f32_16x16x32_bf16 v[116:119], a[172:175], a[72:75], v[116:119]
s_waitcnt lgkmcnt(6)
buffer_load_dwordx4 v6, s[8:11], s38 offen offset:1024 nt lds
v_mfma_f32_16x16x32_bf16 v[128:131], a[176:179], a[48:51], v[128:131]
v_permlane16_swap_b32 v205, v207
v_permlane16_swap_b32 v228, v230
v_mfma_f32_16x16x32_bf16 v[132:135], a[176:179], a[52:55], v[132:135]
ds_read_b64_tr_b16 a[144:145], v26 offset:256
ds_read_b64_tr_b16 a[146:147], v26 offset:6400
v_mfma_f32_16x16x32_bf16 v[136:139], a[176:179], a[56:59], v[136:139]
s_waitcnt lgkmcnt(6)
v_permlane16_swap_b32 v229, v231
v_mul_f32 v80, s34, v80
v_mfma_f32_16x16x32_bf16 v[136:139], a[180:183], a[68:71], v[136:139]
v_mul_f32 v81, s34, v81
v_mul_f32 v82, s34, v82
v_mfma_f32_16x16x32_bf16 v[132:135], a[180:183], a[64:67], v[132:135]
ds_read_b64_tr_b16 a[148:149], v26 offset:12544
ds_read_b64_tr_b16 a[150:151], v26 offset:18688
v_mfma_f32_16x16x32_bf16 v[128:131], a[180:183], a[60:63], v[128:131]
s_waitcnt lgkmcnt(6)
v_mul_f32 v83, s34, v83
v_mul_f32 v92, s34, v92
v_mfma_f32_16x16x32_bf16 v[128:131], a[184:187], a[84:87], v[128:131]
v_mul_f32 v93, s34, v93
v_mul_f32 v94, s34, v94
v_mfma_f32_16x16x32_bf16 v[132:135], a[184:187], a[88:91], v[132:135]
ds_read_b64_tr_b16 a[152:153], v26 offset:37120
ds_read_b64_tr_b16 a[154:155], v26 offset:43264
v_mfma_f32_16x16x32_bf16 v[136:139], a[184:187], a[92:95], v[136:139]
s_waitcnt lgkmcnt(6)
buffer_load_dwordx4 v7, s[8:11], s38 offen offset:2048 nt lds
v_mfma_f32_16x16x32_bf16 v[136:139], a[188:191], a[80:83], v[136:139]
v_mul_f32 v95, s34, v95
v_cvt_pk_bf16_f32 v184, v80, v81
v_mfma_f32_16x16x32_bf16 v[132:135], a[188:191], a[76:79], v[132:135]
ds_read_b64_tr_b16 a[156:157], v26 offset:24832
ds_read_b64_tr_b16 a[158:159], v26 offset:30976
v_mfma_f32_16x16x32_bf16 v[128:131], a[188:191], a[72:75], v[128:131]
s_waitcnt lgkmcnt(6)
v_cvt_pk_bf16_f32 v185, v82, v83
v_cvt_pk_bf16_f32 v186, v92, v93
v_mfma_f32_16x16x32_bf16 v[140:143], a[144:147], a[48:51], v[140:143]
v_cvt_pk_bf16_f32 v187, v94, v95
v_mul_f32 v84, s34, v84
v_mfma_f32_16x16x32_bf16 v[144:147], a[144:147], a[52:55], v[144:147]
ds_read_b64_tr_b16 a[160:161], v27 offset:256
ds_read_b64_tr_b16 a[162:163], v27 offset:6400
v_mfma_f32_16x16x32_bf16 v[148:151], a[144:147], a[56:59], v[148:151]
s_waitcnt lgkmcnt(6)
v_mul_f32 v85, s34, v85
v_mul_f32 v86, s34, v86
v_mfma_f32_16x16x32_bf16 v[148:151], a[148:151], a[68:71], v[148:151]
s_add_u32 s38, s38, 12288
v_mul_f32 v87, s34, v87
v_mul_f32 v96, s34, v96
v_mfma_f32_16x16x32_bf16 v[144:147], a[148:151], a[64:67], v[144:147]
ds_read_b64_tr_b16 a[164:165], v27 offset:12544
ds_read_b64_tr_b16 a[166:167], v27 offset:18688
v_mfma_f32_16x16x32_bf16 v[140:143], a[148:151], a[60:63], v[140:143]
s_waitcnt lgkmcnt(6)
v_mul_f32 v97, s34, v97
v_mul_f32 v98, s34, v98
v_mfma_f32_16x16x32_bf16 v[140:143], a[152:155], a[84:87], v[140:143]
v_mul_f32 v99, s34, v99
v_cvt_pk_bf16_f32 v208, v84, v85
v_mfma_f32_16x16x32_bf16 v[144:147], a[152:155], a[88:91], v[144:147]
ds_read_b64_tr_b16 a[168:169], v27 offset:37120
ds_read_b64_tr_b16 a[170:171], v27 offset:43264
v_mfma_f32_16x16x32_bf16 v[148:151], a[152:155], a[92:95], v[148:151]
s_waitcnt lgkmcnt(6)
v_cvt_pk_bf16_f32 v209, v86, v87
v_cvt_pk_bf16_f32 v210, v96, v97
v_mfma_f32_16x16x32_bf16 v[148:151], a[156:159], a[80:83], v[148:151]
v_cvt_pk_bf16_f32 v211, v98, v99
v_mul_f32 v88, s34, v88
v_mfma_f32_16x16x32_bf16 v[144:147], a[156:159], a[76:79], v[144:147]
ds_read_b64_tr_b16 a[172:173], v27 offset:24832
ds_read_b64_tr_b16 a[174:175], v27 offset:30976
v_mfma_f32_16x16x32_bf16 v[140:143], a[156:159], a[72:75], v[140:143]
s_waitcnt lgkmcnt(6)
s_cmp_ge_u32 s38, 393216
s_cselect_b32 s38, 0, s38
v_mfma_f32_16x16x32_bf16 v[152:155], a[160:163], a[48:51], v[152:155]
v_mul_f32 v89, s34, v89
v_mul_f32 v90, s34, v90
v_mfma_f32_16x16x32_bf16 v[156:159], a[160:163], a[52:55], v[156:159]
ds_read_b64_tr_b16 a[176:177], v28 offset:256
ds_read_b64_tr_b16 a[178:179], v28 offset:6400
v_mfma_f32_16x16x32_bf16 v[160:163], a[160:163], a[56:59], v[160:163]
s_waitcnt lgkmcnt(6)
v_mul_f32 v91, s34, v91
v_mul_f32 v100, s34, v100
v_mfma_f32_16x16x32_bf16 v[160:163], a[164:167], a[68:71], v[160:163]
v_mul_f32 v101, s34, v101
v_mul_f32 v102, s34, v102
v_mfma_f32_16x16x32_bf16 v[156:159], a[164:167], a[64:67], v[156:159]
ds_read_b64_tr_b16 a[180:181], v28 offset:12544
ds_read_b64_tr_b16 a[182:183], v28 offset:18688
v_mfma_f32_16x16x32_bf16 v[152:155], a[164:167], a[60:63], v[152:155]
s_waitcnt lgkmcnt(6)
v_accvgpr_read_b32 v1, a249
v_mul_f32 v103, s34, v103
v_mfma_f32_16x16x32_bf16 v[152:155], a[168:171], a[84:87], v[152:155]
v_cvt_pk_bf16_f32 v232, v88, v89
v_cvt_pk_bf16_f32 v233, v90, v91
v_mfma_f32_16x16x32_bf16 v[156:159], a[168:171], a[88:91], v[156:159]
ds_read_b64_tr_b16 a[184:185], v28 offset:37120
ds_read_b64_tr_b16 a[186:187], v28 offset:43264
v_mfma_f32_16x16x32_bf16 v[160:163], a[168:171], a[92:95], v[160:163]
s_waitcnt lgkmcnt(6)
v_cvt_pk_bf16_f32 v234, v100, v101
v_cvt_pk_bf16_f32 v235, v102, v103
v_mfma_f32_16x16x32_bf16 v[160:163], a[172:175], a[80:83], v[160:163]
v_permlane16_swap_b32 v184, v186
v_permlane16_swap_b32 v185, v187
v_mfma_f32_16x16x32_bf16 v[156:159], a[172:175], a[76:79], v[156:159]
ds_read_b64_tr_b16 a[188:189], v28 offset:24832
ds_read_b64_tr_b16 a[190:191], v28 offset:30976
v_mfma_f32_16x16x32_bf16 v[152:155], a[172:175], a[72:75], v[152:155]
s_waitcnt lgkmcnt(6)
v_permlane16_swap_b32 v208, v210
v_permlane16_swap_b32 v209, v211
v_mfma_f32_16x16x32_bf16 v[164:167], a[176:179], a[48:51], v[164:167]
v_permlane16_swap_b32 v232, v234
v_permlane16_swap_b32 v233, v235
v_mfma_f32_16x16x32_bf16 v[168:171], a[176:179], a[52:55], v[168:171]
ds_read_b128 a[144:147], v23 offset:0
v_mul_f32 v104, s34, v104
v_mfma_f32_16x16x32_bf16 v[172:175], a[176:179], a[56:59], v[172:175]
s_waitcnt lgkmcnt(5)
buffer_load_dword v248, v1, s[24:27], 0 offen
v_mfma_f32_16x16x32_bf16 v[172:175], a[180:183], a[68:71], v[172:175]
ds_read_b128 a[148:151], v23 offset:6144
v_mul_f32 v105, s34, v105
v_mfma_f32_16x16x32_bf16 v[168:171], a[180:183], a[64:67], v[168:171]
v_mul_f32 v106, s34, v106
v_mul_f32 v107, s34, v107
v_mfma_f32_16x16x32_bf16 v[164:167], a[180:183], a[60:63], v[164:167]
s_waitcnt lgkmcnt(4)
ds_read_b128 a[152:155], v24 offset:0
v_mul_f32 v116, s34, v116
v_mfma_f32_16x16x32_bf16 v[164:167], a[184:187], a[84:87], v[164:167]
v_mul_f32 v117, s34, v117
v_mul_f32 v118, s34, v118
v_mfma_f32_16x16x32_bf16 v[168:171], a[184:187], a[88:91], v[168:171]
ds_read_b128 a[156:159], v24 offset:6144
v_mul_f32 v119, s34, v119
v_mfma_f32_16x16x32_bf16 v[172:175], a[184:187], a[92:95], v[172:175]
s_waitcnt lgkmcnt(4)
v_cvt_pk_bf16_f32 v188, v104, v105
v_cvt_pk_bf16_f32 v189, v106, v107
v_mfma_f32_16x16x32_bf16 v[172:175], a[188:191], a[80:83], v[172:175]
ds_read_b128 a[160:163], v23 offset:128
v_cvt_pk_bf16_f32 v190, v116, v117
v_mfma_f32_16x16x32_bf16 v[168:171], a[188:191], a[76:79], v[168:171]
v_cvt_pk_bf16_f32 v191, v118, v119
v_mul_f32 v108, s34, v108
v_mfma_f32_16x16x32_bf16 v[164:167], a[188:191], a[72:75], v[164:167]
s_waitcnt lgkmcnt(4)
ds_read_b128 a[164:167], v23 offset:6272
v_mul_f32 v109, s34, v109
v_mfma_f32_16x16x32_bf16 v[32:35], a[144:147], v[176:179], 0
v_mul_f32 v110, s34, v110
v_mul_f32 v111, s34, v111
v_mfma_f32_16x16x32_bf16 v[40:43], a[144:147], v[200:203], 0
v_mul_f32 v120, s34, v120
v_mul_f32 v121, s34, v121
v_mfma_f32_16x16x32_bf16 v[48:51], a[144:147], v[224:227], 0
s_waitcnt lgkmcnt(4)
ds_read_b128 a[168:171], v24 offset:128
v_mov_b32 v25, v19
v_mfma_f32_16x16x32_bf16 v[52:55], a[148:151], v[224:227], 0
v_mul_f32 v122, s34, v122
v_mul_f32 v123, s34, v123
v_mfma_f32_16x16x32_bf16 v[44:47], a[148:151], v[200:203], 0
ds_read_b128 a[172:175], v24 offset:6272
v_cvt_pk_bf16_f32 v212, v108, v109
v_mfma_f32_16x16x32_bf16 v[36:39], a[148:151], v[176:179], 0
s_waitcnt lgkmcnt(5)
v_cvt_pk_bf16_f32 v213, v110, v111
v_cvt_pk_bf16_f32 v214, v120, v121
v_mfma_f32_16x16x32_bf16 v[32:35], a[152:155], v[180:183], v[32:35]
ds_read_b128 a[176:179], v23 offset:256
v_mov_b32 v26, v20
v_mfma_f32_16x16x32_bf16 v[40:43], a[152:155], v[204:207], v[40:43]
v_cvt_pk_bf16_f32 v215, v122, v123
v_mul_f32 v112, s34, v112
v_mfma_f32_16x16x32_bf16 v[48:51], a[152:155], v[228:231], v[48:51]
s_waitcnt lgkmcnt(5)
ds_read_b128 a[180:183], v23 offset:6400
v_mul_f32 v113, s34, v113
v_mfma_f32_16x16x32_bf16 v[52:55], a[156:159], v[228:231], v[52:55]
v_mul_f32 v114, s34, v114
v_mul_f32 v115, s34, v115
v_mfma_f32_16x16x32_bf16 v[44:47], a[156:159], v[204:207], v[44:47]
ds_read_b128 a[184:187], v24 offset:256
v_mov_b32 v27, v21
v_mfma_f32_16x16x32_bf16 v[36:39], a[156:159], v[180:183], v[36:39]
s_waitcnt lgkmcnt(6)
v_mul_f32 v124, s34, v124
v_mul_f32 v125, s34, v125
v_mfma_f32_16x16x32_bf16 v[32:35], a[160:163], v[184:187], v[32:35]
ds_read_b128 a[188:191], v24 offset:6400
v_mul_f32 v126, s34, v126
v_mfma_f32_16x16x32_bf16 v[40:43], a[160:163], v[208:211], v[40:43]
v_mul_f32 v127, s34, v127
v_cvt_pk_bf16_f32 v236, v112, v113
v_mfma_f32_16x16x32_bf16 v[48:51], a[160:163], v[232:235], v[48:51]
s_waitcnt lgkmcnt(6)
v_cvt_pk_bf16_f32 v237, v114, v115
v_cvt_pk_bf16_f32 v238, v124, v125
v_mfma_f32_16x16x32_bf16 v[52:55], a[164:167], v[232:235], v[52:55]
v_mov_b32 v28, v22
v_cvt_pk_bf16_f32 v239, v126, v127
v_mfma_f32_16x16x32_bf16 v[44:47], a[164:167], v[208:211], v[44:47]
v_permlane16_swap_b32 v188, v190
v_permlane16_swap_b32 v189, v191
v_permlane16_swap_b32 v212, v214
v_permlane16_swap_b32 v213, v215
v_permlane16_swap_b32 v236, v238
v_permlane16_swap_b32 v237, v239
v_mfma_f32_16x16x32_bf16 v[36:39], a[164:167], v[184:187], v[36:39]
s_waitcnt lgkmcnt(5)
v_mul_f32 v128, s34, v128
v_mul_f32 v129, s34, v129
v_mfma_f32_16x16x32_bf16 v[32:35], a[168:171], v[188:191], v[32:35]
v_mul_f32 v130, s34, v130
v_mul_f32 v131, s34, v131
v_mfma_f32_16x16x32_bf16 v[40:43], a[168:171], v[212:215], v[40:43]
v_mul_f32 v140, s34, v140
v_mul_f32 v141, s34, v141
v_mfma_f32_16x16x32_bf16 v[48:51], a[168:171], v[236:239], v[48:51]
s_waitcnt vmcnt(13)
s_waitcnt lgkmcnt(0)
v_mfma_f32_16x16x32_bf16 v[52:55], a[172:175], v[236:239], v[52:55]
s_barrier
v_mul_f32 v142, s34, v142
v_mfma_f32_16x16x32_bf16 v[44:47], a[172:175], v[212:215], v[44:47]
ds_read_b128 a[144:147], v23 offset:24576
v_mul_f32 v143, s34, v143
v_cvt_pk_bf16_f32 v192, v128, v129
v_cvt_pk_bf16_f32 v193, v130, v131
v_cvt_pk_bf16_f32 v194, v140, v141
v_cvt_pk_bf16_f32 v195, v142, v143
v_mul_f32 v132, s34, v132
v_mul_f32 v133, s34, v133
v_mul_f32 v134, s34, v134
v_mul_f32 v135, s34, v135
v_mul_f32 v144, s34, v144
v_mul_f32 v145, s34, v145
v_mul_f32 v146, s34, v146
v_mul_f32 v147, s34, v147
v_cvt_pk_bf16_f32 v216, v132, v133
v_cvt_pk_bf16_f32 v217, v134, v135
v_cvt_pk_bf16_f32 v218, v144, v145
v_cvt_pk_bf16_f32 v219, v146, v147
v_mul_f32 v136, s34, v136
v_mul_f32 v137, s34, v137
v_mul_f32 v138, s34, v138
v_mul_f32 v139, s34, v139
v_mul_f32 v148, s34, v148
v_mul_f32 v149, s34, v149
v_mul_f32 v150, s34, v150
v_mul_f32 v151, s34, v151
v_cvt_pk_bf16_f32 v240, v136, v137
v_cvt_pk_bf16_f32 v241, v138, v139
v_cvt_pk_bf16_f32 v242, v148, v149
v_cvt_pk_bf16_f32 v243, v150, v151
v_permlane16_swap_b32 v192, v194
v_permlane16_swap_b32 v193, v195
v_permlane16_swap_b32 v216, v218
v_permlane16_swap_b32 v217, v219
v_permlane16_swap_b32 v240, v242
v_permlane16_swap_b32 v241, v243
v_mfma_f32_16x16x32_bf16 v[36:39], a[172:175], v[188:191], v[36:39]
ds_read_b128 a[148:151], v24 offset:24576
v_mul_f32 v152, s34, v152
v_mfma_f32_16x16x32_bf16 v[32:35], a[176:179], v[192:195], v[32:35]
v_mul_f32 v153, s34, v153
v_mul_f32 v154, s34, v154
v_mfma_f32_16x16x32_bf16 v[40:43], a[176:179], v[216:219], v[40:43]
v_mul_f32 v155, s34, v155
v_mul_f32 v164, s34, v164
v_mfma_f32_16x16x32_bf16 v[48:51], a[176:179], v[240:243], v[48:51]
ds_read_b128 a[152:155], v23 offset:24704
v_mul_f32 v165, s34, v165
v_mfma_f32_16x16x32_bf16 v[52:55], a[180:183], v[240:243], v[52:55]
v_mul_f32 v166, s34, v166
v_mul_f32 v167, s34, v167
v_mfma_f32_16x16x32_bf16 v[44:47], a[180:183], v[216:219], v[44:47]
v_cvt_pk_bf16_f32 v196, v152, v153
v_cvt_pk_bf16_f32 v197, v154, v155
v_cvt_pk_bf16_f32 v198, v164, v165
v_cvt_pk_bf16_f32 v199, v166, v167
v_mul_f32 v156, s34, v156
v_mul_f32 v157, s34, v157
v_mul_f32 v158, s34, v158
v_mul_f32 v159, s34, v159
v_mul_f32 v168, s34, v168
v_mul_f32 v169, s34, v169
v_mul_f32 v170, s34, v170
v_mul_f32 v171, s34, v171
v_cvt_pk_bf16_f32 v220, v156, v157
v_cvt_pk_bf16_f32 v221, v158, v159
v_cvt_pk_bf16_f32 v222, v168, v169
v_cvt_pk_bf16_f32 v223, v170, v171
v_mul_f32 v160, s34, v160
v_mul_f32 v161, s34, v161
v_mul_f32 v162, s34, v162
v_mul_f32 v163, s34, v163
v_mul_f32 v172, s34, v172
v_mul_f32 v173, s34, v173
v_mul_f32 v174, s34, v174
v_mul_f32 v175, s34, v175
v_cvt_pk_bf16_f32 v244, v160, v161
v_cvt_pk_bf16_f32 v245, v162, v163
v_cvt_pk_bf16_f32 v246, v172, v173
v_cvt_pk_bf16_f32 v247, v174, v175
v_permlane16_swap_b32 v196, v198
v_permlane16_swap_b32 v197, v199
v_permlane16_swap_b32 v220, v222
v_permlane16_swap_b32 v221, v223
v_permlane16_swap_b32 v244, v246
v_permlane16_swap_b32 v245, v247
v_mfma_f32_16x16x32_bf16 v[36:39], a[180:183], v[192:195], v[36:39]
ds_read_b128 a[156:159], v24 offset:24704
v_mfma_f32_16x16x32_bf16 v[32:35], a[184:187], v[196:199], v[32:35]
s_mov_b32 m0, s39
v_mfma_f32_16x16x32_bf16 v[40:43], a[184:187], v[220:223], v[40:43]
buffer_load_dwordx4 v2, s[4:7], s42 offen offset:0 nt lds
v_mfma_f32_16x16x32_bf16 v[48:51], a[184:187], v[244:247], v[48:51]
ds_read_b128 a[160:163], v23 offset:24832
v_mfma_f32_16x16x32_bf16 v[52:55], a[188:191], v[244:247], v[52:55]
buffer_load_dwordx4 v3, s[4:7], s42 offen offset:1024 nt lds
v_mfma_f32_16x16x32_bf16 v[44:47], a[188:191], v[220:223], v[44:47]
v_mfma_f32_16x16x32_bf16 v[36:39], a[188:191], v[196:199], v[36:39]
s_waitcnt lgkmcnt(4)
ds_read_b128 a[164:167], v24 offset:24832
v_mfma_f32_16x16x32_bf16 v[56:59], a[144:147], v[176:179], 0
buffer_load_dwordx4 v4, s[4:7], s42 offen offset:2048 nt lds
v_mfma_f32_16x16x32_bf16 v[64:67], a[144:147], v[200:203], 0
s_add_u32 m0, s39, 12288
v_mfma_f32_16x16x32_bf16 v[72:75], a[144:147], v[224:227], 0
s_waitcnt lgkmcnt(4)
ds_read_b128 a[168:171], v23 offset:30720
v_mfma_f32_16x16x32_bf16 v[72:75], a[148:151], v[228:231], v[72:75]
buffer_load_dwordx4 v5, s[8:11], s38 offen offset:0 nt lds
v_mfma_f32_16x16x32_bf16 v[64:67], a[148:151], v[204:207], v[64:67]
ds_read_b128 a[172:175], v24 offset:30720
v_max3_f32 v132, v32, v33, v34
v_mfma_f32_16x16x32_bf16 v[56:59], a[148:151], v[180:183], v[56:59]
s_waitcnt lgkmcnt(5)
buffer_load_dwordx4 v6, s[8:11], s38 offen offset:1024 nt lds
v_mfma_f32_16x16x32_bf16 v[56:59], a[152:155], v[184:187], v[56:59]
v_max3_f32 v133, v40, v41, v42
v_max3_f32 v134, v48, v49, v50
v_mfma_f32_16x16x32_bf16 v[64:67], a[152:155], v[208:211], v[64:67]
ds_read_b128 a[176:179], v23 offset:30848
v_max3_f32 v136, v36, v37, v38
v_mfma_f32_16x16x32_bf16 v[72:75], a[152:155], v[232:235], v[72:75]
s_waitcnt lgkmcnt(5)
buffer_load_dwordx4 v7, s[8:11], s38 offen offset:2048 nt lds
v_mfma_f32_16x16x32_bf16 v[72:75], a[156:159], v[236:239], v[72:75]
s_mov_b32 s38, s42
v_max3_f32 v137, v44, v45, v46
v_max3_f32 v138, v52, v53, v54
v_mfma_f32_16x16x32_bf16 v[64:67], a[156:159], v[212:215], v[64:67]
s_add_u32 s42, s42, 12288
ds_read_b128 a[180:183], v24 offset:30848
v_max3_f32 v132, v132, v35, v39
v_mfma_f32_16x16x32_bf16 v[56:59], a[156:159], v[188:191], v[56:59]
s_waitcnt lgkmcnt(5)
s_cmp_ge_u32 s42, 393216
s_cselect_b32 s42, 0, s42
v_mfma_f32_16x16x32_bf16 v[56:59], a[160:163], v[192:195], v[56:59]
s_add_u32 s39, s39, 24576
v_max3_f32 v133, v133, v43, v47
v_max3_f32 v134, v134, v51, v55
v_mfma_f32_16x16x32_bf16 v[64:67], a[160:163], v[216:219], v[64:67]
s_cmp_ge_u32 s39, 147456
s_cselect_b32 s39, s37, s39
ds_read_b128 a[184:187], v23 offset:30976
v_mfma_f32_16x16x32_bf16 v[72:75], a[160:163], v[240:243], v[72:75]
s_waitcnt lgkmcnt(5)
v_max_f32 v132, v132, v136
v_max_f32 v133, v133, v137
v_mfma_f32_16x16x32_bf16 v[72:75], a[164:167], v[244:247], v[72:75]
v_max_f32 v134, v134, v138
v_mov_b32 v136, v132
v_mfma_f32_16x16x32_bf16 v[64:67], a[164:167], v[220:223], v[64:67]
ds_read_b128 a[188:191], v24 offset:30976
v_mov_b32 v137, v133
v_mov_b32 v138, v134
v_permlane32_swap_b32 v132, v136
v_permlane32_swap_b32 v133, v137
v_permlane32_swap_b32 v134, v138
v_max_f32 v132, v132, v136
v_max_f32 v133, v133, v137
v_max_f32 v134, v134, v138
v_mov_b32 v136, v132
v_mov_b32 v137, v133
v_mov_b32 v138, v134
v_permlane16_swap_b32 v132, v136
v_permlane16_swap_b32 v133, v137
v_permlane16_swap_b32 v134, v138
v_max_f32 v132, v132, v136
v_max_f32 v133, v133, v137
v_max_f32 v134, v134, v138
v_sub_f32 v104, 0, v132
v_sub_f32 v108, 0, v133
v_sub_f32 v112, 0, v134
v_sub_f32 v105, 0, v132
v_sub_f32 v109, 0, v133
v_sub_f32 v113, 0, v134
v_sub_f32 v106, 0, v132
v_sub_f32 v110, 0, v133
v_sub_f32 v114, 0, v134
v_sub_f32 v107, 0, v132
v_sub_f32 v111, 0, v133
v_sub_f32 v115, 0, v134
v_mfma_f32_16x16x32_bf16 v[56:59], a[164:167], v[196:199], v[56:59]
s_waitcnt lgkmcnt(5)
v_add_f32 v32, v32, v104
v_add_f32 v33, v33, v104
v_add_f32 v50, v50, v112
v_mfma_f32_16x16x32_bf16 v[60:63], a[168:171], v[176:179], v[104:107]
ds_read_b64_tr_b16 a[144:145], v25 offset:36864
ds_read_b64_tr_b16 a[146:147], v25 offset:43008
v_add_f32 v51, v51, v112
v_mfma_f32_16x16x32_bf16 v[68:71], a[168:171], v[200:203], v[108:111]
v_add_f32 v34, v34, v104
v_add_f32 v35, v35, v104
v_add_f32 v36, v36, v104
v_mfma_f32_16x16x32_bf16 v[76:79], a[168:171], v[224:227], v[112:115]
s_waitcnt lgkmcnt(6)
ds_read_b64_tr_b16 a[148:149], v26 offset:36864
ds_read_b64_tr_b16 a[150:151], v26 offset:43008
v_add_f32 v37, v37, v104
v_mfma_f32_16x16x32_bf16 v[76:79], a[172:175], v[228:231], v[76:79]
v_exp_f32 v120, v32
v_add_f32 v38, v38, v104
v_mfma_f32_16x16x32_bf16 v[68:71], a[172:175], v[204:207], v[68:71]
v_exp_f32 v121, v33
v_add_f32 v39, v39, v104
v_mfma_f32_16x16x32_bf16 v[60:63], a[172:175], v[180:183], v[60:63]
s_waitcnt lgkmcnt(7)
ds_read_b64_tr_b16 a[152:153], v27 offset:36864
ds_read_b64_tr_b16 a[154:155], v27 offset:43008
v_add_f32 v44, v44, v108
v_mfma_f32_16x16x32_bf16 v[60:63], a[176:179], v[184:187], v[60:63]
v_add_f32 v40, v40, v108
v_cvt_pk_bf16_f32 v80, v120, v121
v_add_f32 v45, v45, v108
v_mfma_f32_16x16x32_bf16 v[68:71], a[176:179], v[208:211], v[68:71]
v_exp_f32 v122, v34
v_add_f32 v46, v46, v108
v_mfma_f32_16x16x32_bf16 v[76:79], a[176:179], v[232:235], v[76:79]
s_waitcnt lgkmcnt(8)
ds_read_b64_tr_b16 a[156:157], v28 offset:36864
ds_read_b64_tr_b16 a[158:159], v28 offset:43008
v_add_f32 v47, v47, v108
v_mfma_f32_16x16x32_bf16 v[76:79], a[180:183], v[236:239], v[76:79]
v_add_f32 v41, v41, v108
v_add_f32 v42, v42, v108
v_add_f32 v52, v52, v112
v_mfma_f32_16x16x32_bf16 v[68:71], a[180:183], v[212:215], v[68:71]
v_exp_f32 v123, v35
v_add_f32 v53, v53, v112
v_mfma_f32_16x16x32_bf16 v[60:63], a[180:183], v[188:191], v[60:63]
s_waitcnt lgkmcnt(9)
ds_read_b64_tr_b16 a[160:161], v25 offset:36992
ds_read_b64_tr_b16 a[162:163], v25 offset:43136
v_add_f32 v54, v54, v112
v_mfma_f32_16x16x32_bf16 v[60:63], a[184:187], v[192:195], v[60:63]
v_exp_f32 v124, v40
v_add_f32 v55, v55, v112
v_mfma_f32_16x16x32_bf16 v[68:71], a[184:187], v[216:219], v[68:71]
v_cvt_pk_bf16_f32 v81, v122, v123
v_add_f32 v43, v43, v108
v_mfma_f32_16x16x32_bf16 v[76:79], a[184:187], v[240:243], v[76:79]
s_waitcnt lgkmcnt(10)
ds_read_b64_tr_b16 a[164:165], v26 offset:36992
ds_read_b64_tr_b16 a[166:167], v26 offset:43136
v_mfma_f32_16x16x32_bf16 v[76:79], a[188:191], v[244:247], v[76:79]
v_exp_f32 v125, v41
v_mfma_f32_16x16x32_bf16 v[68:71], a[188:191], v[220:223], v[68:71]
v_add_f32 v48, v48, v112
v_add_f32 v49, v49, v112
v_exp_f32 v126, v42
v_cvt_pk_bf16_f32 v84, v124, v125
v_exp_f32 v127, v43
v_exp_f32 v128, v48
v_exp_f32 v129, v49
v_cvt_pk_bf16_f32 v85, v126, v127
v_exp_f32 v120, v50
v_cvt_pk_bf16_f32 v88, v128, v129
v_exp_f32 v121, v51
v_exp_f32 v122, v36
v_cvt_pk_bf16_f32 v89, v120, v121
v_exp_f32 v123, v37
v_exp_f32 v124, v38
v_cvt_pk_bf16_f32 v82, v122, v123
v_exp_f32 v125, v39
v_exp_f32 v126, v44
v_exp_f32 v127, v45
v_cvt_pk_bf16_f32 v83, v124, v125
v_exp_f32 v128, v46
v_cvt_pk_bf16_f32 v86, v126, v127
v_exp_f32 v129, v47
v_exp_f32 v120, v52
v_cvt_pk_bf16_f32 v87, v128, v129
v_exp_f32 v121, v53
v_exp_f32 v122, v54
v_cvt_pk_bf16_f32 v90, v120, v121
v_exp_f32 v123, v55
s_nop 0
v_cvt_pk_bf16_f32 v91, v122, v123
v_mfma_f32_16x16x32_bf16 v[60:63], a[188:191], v[196:199], v[60:63]
ds_read_b64_tr_b16 a[168:169], v27 offset:36992
ds_read_b64_tr_b16 a[170:171], v27 offset:43136
v_mfma_f32_16x16x32_bf16 v[144:147], a[240:243], v[80:83], 0
v_mfma_f32_16x16x32_bf16 v[148:151], a[240:243], v[84:87], 0
ds_read_b64_tr_b16 a[172:173], v28 offset:36992
ds_read_b64_tr_b16 a[174:175], v28 offset:43136
v_mfma_f32_16x16x32_bf16 v[152:155], a[240:243], v[88:91], 0
s_waitcnt lgkmcnt(14)
v_mfma_f32_16x16x32_bf16 a[0:3], a[144:147], v[80:83], 0
s_add_u32 s40, s40, 49152
v_mfma_f32_16x16x32_bf16 a[4:7], a[144:147], v[84:87], 0
ds_read_b64_tr_b16 a[176:177], v25 offset:37120
ds_read_b64_tr_b16 a[178:179], v25 offset:43264
v_add_f32 v75, v75, v112
v_mfma_f32_16x16x32_bf16 a[8:11], a[144:147], v[88:91], 0
s_waitcnt lgkmcnt(14)
v_add_f32 v56, v56, v104
v_add_f32 v57, v57, v104
v_mfma_f32_16x16x32_bf16 a[20:23], a[148:151], v[88:91], 0
v_exp_f32 v120, v56
v_mfma_f32_16x16x32_bf16 a[16:19], a[148:151], v[84:87], 0
ds_read_b64_tr_b16 a[180:181], v26 offset:37120
ds_read_b64_tr_b16 a[182:183], v26 offset:43264
v_mfma_f32_16x16x32_bf16 a[12:15], a[148:151], v[80:83], 0
s_waitcnt lgkmcnt(14)
v_add_f32 v58, v58, v104
v_add_f32 v59, v59, v104
v_mfma_f32_16x16x32_bf16 a[24:27], a[152:155], v[80:83], 0
v_exp_f32 v121, v57
v_mfma_f32_16x16x32_bf16 a[28:31], a[152:155], v[84:87], 0
ds_read_b64_tr_b16 a[184:185], v27 offset:37120
ds_read_b64_tr_b16 a[186:187], v27 offset:43264
v_mfma_f32_16x16x32_bf16 a[32:35], a[152:155], v[88:91], 0
s_waitcnt lgkmcnt(14)
v_cvt_pk_bf16_f32 v92, v120, v121
v_add_f32 v64, v64, v108
v_mfma_f32_16x16x32_bf16 a[44:47], a[156:159], v[88:91], 0
v_exp_f32 v122, v58
v_mfma_f32_16x16x32_bf16 a[40:43], a[156:159], v[84:87], 0
ds_read_b64_tr_b16 a[188:189], v28 offset:37120
ds_read_b64_tr_b16 a[190:191], v28 offset:43264
v_mfma_f32_16x16x32_bf16 a[36:39], a[156:159], v[80:83], 0
s_waitcnt lgkmcnt(14)
s_cmp_ge_u32 s40, 147456
s_cselect_b32 s40, 0, s40
v_mfma_f32_16x16x32_bf16 a[48:51], a[160:163], v[80:83], 0
v_exp_f32 v123, v59
v_mfma_f32_16x16x32_bf16 a[52:55], a[160:163], v[84:87], 0
v_cvt_pk_bf16_f32 v93, v122, v123
v_add_f32 v65, v65, v108
v_mfma_f32_16x16x32_bf16 a[56:59], a[160:163], v[88:91], 0
s_waitcnt lgkmcnt(12)
v_exp_f32 v124, v64
v_mfma_f32_16x16x32_bf16 a[68:71], a[164:167], v[88:91], 0
v_add_f32 v66, v66, v108
v_add_f32 v67, v67, v108
v_mfma_f32_16x16x32_bf16 a[64:67], a[164:167], v[84:87], 0
v_exp_f32 v125, v65
v_mfma_f32_16x16x32_bf16 a[60:63], a[164:167], v[80:83], 0
s_waitcnt lgkmcnt(10)
v_cvt_pk_bf16_f32 v96, v124, v125
v_add_u32 v23, s40, v17
v_add_u32 v24, s40, v18
v_mfma_f32_16x16x32_bf16 a[72:75], a[168:171], v[80:83], 0
v_exp_f32 v126, v66
v_mfma_f32_16x16x32_bf16 a[76:79], a[168:171], v[84:87], 0
v_add_f32 v72, v72, v112
v_add_f32 v73, v73, v112
v_mfma_f32_16x16x32_bf16 a[80:83], a[168:171], v[88:91], 0
s_waitcnt lgkmcnt(8)
v_exp_f32 v127, v67
v_mfma_f32_16x16x32_bf16 a[92:95], a[172:175], v[88:91], 0
v_cvt_pk_bf16_f32 v97, v126, v127
v_add_f32 v74, v74, v112
v_mfma_f32_16x16x32_bf16 a[88:91], a[172:175], v[84:87], 0
v_exp_f32 v128, v72
v_mfma_f32_16x16x32_bf16 a[84:87], a[172:175], v[80:83], 0
v_exp_f32 v129, v73
s_nop 0
v_cvt_pk_bf16_f32 v100, v128, v129
v_exp_f32 v120, v74
v_exp_f32 v121, v75
s_nop 0
v_cvt_pk_bf16_f32 v101, v120, v121
L_attA0:
s_waitcnt lgkmcnt(6)
v_mfma_f32_16x16x32_bf16 a[96:99], a[176:179], v[80:83], a[96:99]
s_waitcnt vmcnt(12) lgkmcnt(0)
v_exp_f32 v122, v60
v_mfma_f32_16x16x32_bf16 a[100:103], a[176:179], v[84:87], a[100:103]
s_barrier
v_add_u32 v25, s40, v19
v_mfma_f32_16x16x32_bf16 a[104:107], a[176:179], v[88:91], a[104:107]
s_mov_b32 m0, s39
ds_read_b128 a[144:147], v23 offset:0
v_mfma_f32_16x16x32_bf16 a[116:119], a[180:183], v[88:91], a[116:119]
ds_read_b128 a[148:151], v24 offset:0
v_mfma_f32_16x16x32_bf16 a[112:115], a[180:183], v[84:87], a[112:115]
s_waitcnt vmcnt(4)
buffer_load_dwordx4 v2, s[4:7], s42 offen offset:0 nt lds
v_mfma_f32_16x16x32_bf16 a[108:111], a[180:183], v[80:83], a[108:111]
v_exp_f32 v123, v61
v_mfma_f32_16x16x32_bf16 a[120:123], a[184:187], v[80:83], a[120:123]
ds_read_b128 a[152:155], v23 offset:128
v_add_u32 v26, s40, v20
v_mfma_f32_16x16x32_bf16 a[124:127], a[184:187], v[84:87], a[124:127]
v_exp_f32 v124, v62
v_mfma_f32_16x16x32_bf16 a[128:131], a[184:187], v[88:91], a[128:131]
v_mfma_f32_16x16x32_bf16 a[140:143], a[188:191], v[88:91], a[140:143]
ds_read_b128 a[156:159], v24 offset:128
v_cvt_pk_bf16_f32 v94, v122, v123
v_mfma_f32_16x16x32_bf16 a[136:139], a[188:191], v[84:87], a[136:139]
v_exp_f32 v125, v63
v_mfma_f32_16x16x32_bf16 a[132:135], a[188:191], v[80:83], a[132:135]
s_waitcnt lgkmcnt(3)
v_mfma_f32_16x16x32_bf16 v[32:35], a[144:147], v[176:179], v[104:107]
ds_read_b128 a[160:163], v23 offset:256
v_add_u32 v27, s40, v21
v_mfma_f32_16x16x32_bf16 v[40:43], a[144:147], v[200:203], v[108:111]
v_exp_f32 v126, v68
v_mfma_f32_16x16x32_bf16 v[48:51], a[144:147], v[224:227], v[112:115]
s_waitcnt lgkmcnt(3)
ds_read_b128 a[164:167], v24 offset:256
v_cvt_pk_bf16_f32 v95, v124, v125
v_mfma_f32_16x16x32_bf16 v[48:51], a[148:151], v[228:231], v[48:51]
s_waitcnt vmcnt(4)
buffer_load_dwordx4 v3, s[4:7], s42 offen offset:1024 nt lds
v_mfma_f32_16x16x32_bf16 v[40:43], a[148:151], v[204:207], v[40:43]
v_exp_f32 v127, v69
v_mfma_f32_16x16x32_bf16 v[32:35], a[148:151], v[180:183], v[32:35]
s_waitcnt lgkmcnt(3)
ds_read_b128 a[168:171], v23 offset:6144
v_add_u32 v28, s40, v22
v_mfma_f32_16x16x32_bf16 v[32:35], a[152:155], v[184:187], v[32:35]
v_exp_f32 v128, v70
v_mfma_f32_16x16x32_bf16 v[40:43], a[152:155], v[208:211], v[40:43]
v_mfma_f32_16x16x32_bf16 v[48:51], a[152:155], v[232:235], v[48:51]
s_waitcnt lgkmcnt(3)
ds_read_b128 a[172:175], v24 offset:6144
v_cvt_pk_bf16_f32 v98, v126, v127
v_mfma_f32_16x16x32_bf16 v[48:51], a[156:159], v[236:239], v[48:51]
v_exp_f32 v129, v71
v_mfma_f32_16x16x32_bf16 v[40:43], a[156:159], v[212:215], v[40:43]
v_mfma_f32_16x16x32_bf16 v[32:35], a[156:159], v[188:191], v[32:35]
s_waitcnt lgkmcnt(3)
ds_read_b128 a[176:179], v23 offset:6272
v_cvt_pk_bf16_f32 v99, v128, v129
v_mfma_f32_16x16x32_bf16 v[32:35], a[160:163], v[192:195], v[32:35]
v_exp_f32 v120, v76
v_mfma_f32_16x16x32_bf16 v[40:43], a[160:163], v[216:219], v[40:43]
ds_read_b128 a[180:183], v24 offset:6272
v_mfma_f32_16x16x32_bf16 v[48:51], a[160:163], v[240:243], v[48:51]
s_waitcnt lgkmcnt(4)
v_mfma_f32_16x16x32_bf16 v[48:51], a[164:167], v[244:247], v[48:51]
s_waitcnt vmcnt(4)
buffer_load_dwordx4 v4, s[4:7], s42 offen offset:2048 nt lds
v_mfma_f32_16x16x32_bf16 v[40:43], a[164:167], v[220:223], v[40:43]
ds_read_b128 a[184:187], v23 offset:6400
v_mfma_f32_16x16x32_bf16 v[32:35], a[164:167], v[196:199], v[32:35]
s_waitcnt lgkmcnt(4)
v_exp_f32 v121, v77
v_mfma_f32_16x16x32_bf16 v[36:39], a[168:171], v[176:179], v[104:107]
v_exp_f32 v122, v78
v_mfma_f32_16x16x32_bf16 v[44:47], a[168:171], v[200:203], v[108:111]
ds_read_b128 a[188:191], v24 offset:6400
v_cvt_pk_bf16_f32 v102, v120, v121
v_mfma_f32_16x16x32_bf16 v[52:55], a[168:171], v[224:227], v[112:115]
s_waitcnt lgkmcnt(4)
v_mfma_f32_16x16x32_bf16 v[52:55], a[172:175], v[228:231], v[52:55]
ds_read_b64_tr_b16 a[144:145], v25 offset:12288
ds_read_b64_tr_b16 a[146:147], v25 offset:18432
v_mfma_f32_16x16x32_bf16 v[44:47], a[172:175], v[204:207], v[44:47]
v_exp_f32 v123, v79
v_mfma_f32_16x16x32_bf16 v[36:39], a[172:175], v[180:183], v[36:39]
s_waitcnt lgkmcnt(5)
ds_read_b64_tr_b16 a[148:149], v26 offset:12288
ds_read_b64_tr_b16 a[150:151], v26 offset:18432
v_mfma_f32_16x16x32_bf16 v[36:39], a[176:179], v[184:187], v[36:39]
s_add_u32 m0, s39, 12288
v_cvt_pk_bf16_f32 v103, v122, v123
v_mfma_f32_16x16x32_bf16 v[44:47], a[176:179], v[208:211], v[44:47]
v_mfma_f32_16x16x32_bf16 v[52:55], a[176:179], v[232:235], v[52:55]
ds_read_b64_tr_b16 a[152:153], v27 offset:12288
ds_read_b64_tr_b16 a[154:155], v27 offset:18432
v_mfma_f32_16x16x32_bf16 v[156:159], a[240:243], v[92:95], v[144:147]
s_waitcnt vmcnt(4)
buffer_load_dwordx4 v5, s[8:11], s38 offen offset:0 nt lds
v_mfma_f32_16x16x32_bf16 v[160:163], a[240:243], v[96:99], v[148:151]
ds_read_b64_tr_b16 a[156:157], v28 offset:12288
ds_read_b64_tr_b16 a[158:159], v28 offset:18432
v_mfma_f32_16x16x32_bf16 v[164:167], a[240:243], v[100:103], v[152:155]
s_waitcnt lgkmcnt(10)
v_mfma_f32_16x16x32_bf16 v[52:55], a[180:183], v[236:239], v[52:55]
v_mfma_f32_16x16x32_bf16 v[44:47], a[180:183], v[212:215], v[44:47]
ds_read_b64_tr_b16 a[160:161], v25 offset:12416
ds_read_b64_tr_b16 a[162:163], v25 offset:18560
v_mfma_f32_16x16x32_bf16 v[36:39], a[180:183], v[188:191], v[36:39]
s_waitcnt lgkmcnt(11)
v_mfma_f32_16x16x32_bf16 v[36:39], a[184:187], v[192:195], v[36:39]
ds_read_b64_tr_b16 a[164:165], v26 offset:12416
ds_read_b64_tr_b16 a[166:167], v26 offset:18560
v_mfma_f32_16x16x32_bf16 v[44:47], a[184:187], v[216:219], v[44:47]
v_max3_f32 v130, v156, v160, v164
v_cmp_nge_f32 vcc, s3, v130
v_mfma_f32_16x16x32_bf16 v[52:55], a[184:187], v[240:243], v[52:55]
s_waitcnt lgkmcnt(12)
v_mfma_f32_16x16x32_bf16 v[52:55], a[188:191], v[244:247], v[52:55]
ds_read_b64_tr_b16 a[168:169], v27 offset:12416
ds_read_b64_tr_b16 a[170:171], v27 offset:18560
v_mfma_f32_16x16x32_bf16 v[44:47], a[188:191], v[220:223], v[44:47]
v_mfma_f32_16x16x32_bf16 v[36:39], a[188:191], v[196:199], v[36:39]
s_cbranch_vccnz L_tramp_2
L_ret_1:
s_waitcnt lgkmcnt(12)
v_mfma_f32_16x16x32_bf16 a[0:3], a[144:147], v[92:95], a[0:3]
ds_read_b64_tr_b16 a[172:173], v28 offset:12416
ds_read_b64_tr_b16 a[174:175], v28 offset:18560
v_mfma_f32_16x16x32_bf16 a[4:7], a[144:147], v[96:99], a[4:7]
s_waitcnt vmcnt(4)
buffer_load_dwordx4 v6, s[8:11], s38 offen offset:1024 nt lds
v_mfma_f32_16x16x32_bf16 a[8:11], a[144:147], v[100:103], a[8:11]
s_waitcnt lgkmcnt(12)
ds_read_b64_tr_b16 a[176:177], v25 offset:12544
ds_read_b64_tr_b16 a[178:179], v25 offset:18688
v_mfma_f32_16x16x32_bf16 a[20:23], a[148:151], v[100:103], a[20:23]
v_exp_f32 v120, v32
v_mfma_f32_16x16x32_bf16 a[16:19], a[148:151], v[96:99], a[16:19]
v_exp_f32 v121, v33
v_mfma_f32_16x16x32_bf16 a[12:15], a[148:151], v[92:95], a[12:15]
s_waitcnt lgkmcnt(12)
ds_read_b64_tr_b16 a[180:181], v26 offset:12544
ds_read_b64_tr_b16 a[182:183], v26 offset:18688
v_mfma_f32_16x16x32_bf16 a[24:27], a[152:155], v[92:95], a[24:27]
v_cvt_pk_bf16_f32 v80, v120, v121
v_mfma_f32_16x16x32_bf16 a[28:31], a[152:155], v[96:99], a[28:31]
ds_read_b64_tr_b16 a[184:185], v27 offset:12544
ds_read_b64_tr_b16 a[186:187], v27 offset:18688
v_mfma_f32_16x16x32_bf16 a[32:35], a[152:155], v[100:103], a[32:35]
s_waitcnt lgkmcnt(14)
v_exp_f32 v122, v34
v_mfma_f32_16x16x32_bf16 a[44:47], a[156:159], v[100:103], a[44:47]
v_exp_f32 v123, v35
v_mfma_f32_16x16x32_bf16 a[40:43], a[156:159], v[96:99], a[40:43]
ds_read_b64_tr_b16 a[188:189], v28 offset:12544
ds_read_b64_tr_b16 a[190:191], v28 offset:18688
v_mfma_f32_16x16x32_bf16 a[36:39], a[156:159], v[92:95], a[36:39]
s_waitcnt lgkmcnt(14)
v_cvt_pk_bf16_f32 v81, v122, v123
v_mfma_f32_16x16x32_bf16 a[48:51], a[160:163], v[92:95], a[48:51]
v_exp_f32 v124, v40
v_mfma_f32_16x16x32_bf16 a[52:55], a[160:163], v[96:99], a[52:55]
v_exp_f32 v125, v41
v_mfma_f32_16x16x32_bf16 a[56:59], a[160:163], v[100:103], a[56:59]
s_waitcnt lgkmcnt(12)
v_cvt_pk_bf16_f32 v84, v124, v125
v_mfma_f32_16x16x32_bf16 a[68:71], a[164:167], v[100:103], a[68:71]
s_waitcnt vmcnt(4)
buffer_load_dwordx4 v7, s[8:11], s38 offen offset:2048 nt lds
v_mfma_f32_16x16x32_bf16 a[64:67], a[164:167], v[96:99], a[64:67]
s_mov_b32 s38, s42
v_exp_f32 v126, v42
v_mfma_f32_16x16x32_bf16 a[60:63], a[164:167], v[92:95], a[60:63]
s_waitcnt lgkmcnt(10)
v_exp_f32 v127, v43
v_mfma_f32_16x16x32_bf16 a[72:75], a[168:171], v[92:95], a[72:75]
s_add_u32 s42, s42, 12288
s_cmp_ge_u32 s42, 393216
s_cselect_b32 s42, 0, s42
v_mfma_f32_16x16x32_bf16 a[76:79], a[168:171], v[96:99], a[76:79]
s_add_u32 s39, s39, 24576
s_cmp_ge_u32 s39, 147456
s_cselect_b32 s39, s37, s39
v_mfma_f32_16x16x32_bf16 a[80:83], a[168:171], v[100:103], a[80:83]
s_waitcnt lgkmcnt(8)
v_cvt_pk_bf16_f32 v85, v126, v127
v_mfma_f32_16x16x32_bf16 a[92:95], a[172:175], v[100:103], a[92:95]
v_exp_f32 v128, v48
v_mfma_f32_16x16x32_bf16 a[88:91], a[172:175], v[96:99], a[88:91]
v_exp_f32 v129, v49
v_mfma_f32_16x16x32_bf16 a[84:87], a[172:175], v[92:95], a[84:87]
s_waitcnt lgkmcnt(6)
v_cvt_pk_bf16_f32 v88, v128, v129
v_exp_f32 v120, v50
v_exp_f32 v121, v51
s_nop 0
v_cvt_pk_bf16_f32 v89, v120, v121
v_mfma_f32_16x16x32_bf16 a[96:99], a[176:179], v[92:95], a[96:99]
s_waitcnt vmcnt(12) lgkmcnt(0)
v_exp_f32 v122, v36
v_mfma_f32_16x16x32_bf16 a[100:103], a[176:179], v[96:99], a[100:103]
s_barrier
v_mfma_f32_16x16x32_bf16 a[104:107], a[176:179], v[100:103], a[104:107]
s_mov_b32 m0, s39
ds_read_b128 a[144:147], v23 offset:24576
v_mfma_f32_16x16x32_bf16 a[116:119], a[180:183], v[100:103], a[116:119]
ds_read_b128 a[148:151], v24 offset:24576
v_mfma_f32_16x16x32_bf16 a[112:115], a[180:183], v[96:99], a[112:115]
s_waitcnt vmcnt(4)
buffer_load_dwordx4 v2, s[4:7], s42 offen offset:0 nt lds
v_mfma_f32_16x16x32_bf16 a[108:111], a[180:183], v[92:95], a[108:111]
v_exp_f32 v123, v37
v_mfma_f32_16x16x32_bf16 a[120:123], a[184:187], v[92:95], a[120:123]
ds_read_b128 a[152:155], v23 offset:24704
v_cvt_pk_bf16_f32 v82, v122, v123
v_mfma_f32_16x16x32_bf16 a[124:127], a[184:187], v[96:99], a[124:127]
v_exp_f32 v124, v38
v_mfma_f32_16x16x32_bf16 a[128:131], a[184:187], v[100:103], a[128:131]
v_mfma_f32_16x16x32_bf16 a[140:143], a[188:191], v[100:103], a[140:143]
ds_read_b128 a[156:159], v24 offset:24704
v_mfma_f32_16x16x32_bf16 a[136:139], a[188:191], v[96:99], a[136:139]
v_exp_f32 v125, v39
v_mfma_f32_16x16x32_bf16 a[132:135], a[188:191], v[92:95], a[132:135]
s_waitcnt lgkmcnt(3)
v_mfma_f32_16x16x32_bf16 v[56:59], a[144:147], v[176:179], v[104:107]
ds_read_b128 a[160:163], v23 offset:24832
v_cvt_pk_bf16_f32 v83, v124, v125
v_mfma_f32_16x16x32_bf16 v[64:67], a[144:147], v[200:203], v[108:111]
v_exp_f32 v126, v44
v_mfma_f32_16x16x32_bf16 v[72:75], a[144:147], v[224:227], v[112:115]
s_waitcnt lgkmcnt(3)
ds_read_b128 a[164:167], v24 offset:24832
v_mfma_f32_16x16x32_bf16 v[72:75], a[148:151], v[228:231], v[72:75]
s_waitcnt vmcnt(4)
buffer_load_dwordx4 v3, s[4:7], s42 offen offset:1024 nt lds
v_mfma_f32_16x16x32_bf16 v[64:67], a[148:151], v[204:207], v[64:67]
v_exp_f32 v127, v45
v_mfma_f32_16x16x32_bf16 v[56:59], a[148:151], v[180:183], v[56:59]
s_waitcnt lgkmcnt(3)
ds_read_b128 a[168:171], v23 offset:30720
v_cvt_pk_bf16_f32 v86, v126, v127
v_mfma_f32_16x16x32_bf16 v[56:59], a[152:155], v[184:187], v[56:59]
v_exp_f32 v128, v46
v_mfma_f32_16x16x32_bf16 v[64:67], a[152:155], v[208:211], v[64:67]
v_mfma_f32_16x16x32_bf16 v[72:75], a[152:155], v[232:235], v[72:75]
s_waitcnt lgkmcnt(3)
ds_read_b128 a[172:175], v24 offset:30720
v_mfma_f32_16x16x32_bf16 v[72:75], a[156:159], v[236:239], v[72:75]
v_exp_f32 v129, v47
v_mfma_f32_16x16x32_bf16 v[64:67], a[156:159], v[212:215], v[64:67]
v_mfma_f32_16x16x32_bf16 v[56:59], a[156:159], v[188:191], v[56:59]
s_waitcnt lgkmcnt(3)
ds_read_b128 a[176:179], v23 offset:30848
v_cvt_pk_bf16_f32 v87, v128, v129
v_mfma_f32_16x16x32_bf16 v[56:59], a[160:163], v[192:195], v[56:59]
v_exp_f32 v120, v52
v_mfma_f32_16x16x32_bf16 v[64:67], a[160:163], v[216:219], v[64:67]
ds_read_b128 a[180:183], v24 offset:30848
v_mfma_f32_16x16x32_bf16 v[72:75], a[160:163], v[240:243], v[72:75]
s_waitcnt lgkmcnt(4)
v_mfma_f32_16x16x32_bf16 v[72:75], a[164:167], v[244:247], v[72:75]
s_waitcnt vmcnt(4)
buffer_load_dwordx4 v4, s[4:7], s42 offen offset:2048 nt lds
v_mfma_f32_16x16x32_bf16 v[64:67], a[164:167], v[220:223], v[64:67]
ds_read_b128 a[184:187], v23 offset:30976
v_mfma_f32_16x16x32_bf16 v[56:59], a[164:167], v[196:199], v[56:59]
s_waitcnt lgkmcnt(4)
v_exp_f32 v121, v53
v_mfma_f32_16x16x32_bf16 v[60:63], a[168:171], v[176:179], v[104:107]
v_exp_f32 v122, v54
v_mfma_f32_16x16x32_bf16 v[68:71], a[168:171], v[200:203], v[108:111]
ds_read_b128 a[188:191], v24 offset:30976
v_cvt_pk_bf16_f32 v90, v120, v121
v_mfma_f32_16x16x32_bf16 v[76:79], a[168:171], v[224:227], v[112:115]
s_waitcnt lgkmcnt(4)
v_mfma_f32_16x16x32_bf16 v[76:79], a[172:175], v[228:231], v[76:79]
ds_read_b64_tr_b16 a[144:145], v25 offset:36864
ds_read_b64_tr_b16 a[146:147], v25 offset:43008
v_mfma_f32_16x16x32_bf16 v[68:71], a[172:175], v[204:207], v[68:71]
v_exp_f32 v123, v55
v_mfma_f32_16x16x32_bf16 v[60:63], a[172:175], v[180:183], v[60:63]
s_waitcnt lgkmcnt(5)
ds_read_b64_tr_b16 a[148:149], v26 offset:36864
ds_read_b64_tr_b16 a[150:151], v26 offset:43008
v_mfma_f32_16x16x32_bf16 v[60:63], a[176:179], v[184:187], v[60:63]
s_add_u32 m0, s39, 12288
v_cvt_pk_bf16_f32 v91, v122, v123
v_mfma_f32_16x16x32_bf16 v[68:71], a[176:179], v[208:211], v[68:71]
v_mfma_f32_16x16x32_bf16 v[76:79], a[176:179], v[232:235], v[76:79]
ds_read_b64_tr_b16 a[152:153], v27 offset:36864
ds_read_b64_tr_b16 a[154:155], v27 offset:43008
v_mfma_f32_16x16x32_bf16 v[144:147], a[240:243], v[80:83], v[156:159]
s_add_u32 s40, s40, 49152
v_mfma_f32_16x16x32_bf16 v[148:151], a[240:243], v[84:87], v[160:163]
ds_read_b64_tr_b16 a[156:157], v28 offset:36864
ds_read_b64_tr_b16 a[158:159], v28 offset:43008
v_mfma_f32_16x16x32_bf16 v[152:155], a[240:243], v[88:91], v[164:167]
s_waitcnt lgkmcnt(10)
v_mfma_f32_16x16x32_bf16 v[76:79], a[180:183], v[236:239], v[76:79]
s_waitcnt vmcnt(4)
buffer_load_dwordx4 v5, s[8:11], s38 offen offset:0 nt lds
v_mfma_f32_16x16x32_bf16 v[68:71], a[180:183], v[212:215], v[68:71]
ds_read_b64_tr_b16 a[160:161], v25 offset:36992
ds_read_b64_tr_b16 a[162:163], v25 offset:43136
v_mfma_f32_16x16x32_bf16 v[60:63], a[180:183], v[188:191], v[60:63]
s_waitcnt lgkmcnt(11)
v_mfma_f32_16x16x32_bf16 v[60:63], a[184:187], v[192:195], v[60:63]
ds_read_b64_tr_b16 a[164:165], v26 offset:36992
ds_read_b64_tr_b16 a[166:167], v26 offset:43136
v_mfma_f32_16x16x32_bf16 v[68:71], a[184:187], v[216:219], v[68:71]
v_max3_f32 v130, v144, v148, v152
v_cmp_nge_f32 vcc, s3, v130
v_mfma_f32_16x16x32_bf16 v[76:79], a[184:187], v[240:243], v[76:79]
s_waitcnt lgkmcnt(12)
s_cmp_ge_u32 s40, 147456
s_cselect_b32 s40, 0, s40
v_mfma_f32_16x16x32_bf16 v[76:79], a[188:191], v[244:247], v[76:79]
ds_read_b64_tr_b16 a[168:169], v27 offset:36992
ds_read_b64_tr_b16 a[170:171], v27 offset:43136
v_mfma_f32_16x16x32_bf16 v[68:71], a[188:191], v[220:223], v[68:71]
v_mfma_f32_16x16x32_bf16 v[60:63], a[188:191], v[196:199], v[60:63]
s_cbranch_vccnz L_tramp_4
L_ret_3:
s_waitcnt lgkmcnt(12)
v_mfma_f32_16x16x32_bf16 a[0:3], a[144:147], v[80:83], a[0:3]
ds_read_b64_tr_b16 a[172:173], v28 offset:36992
ds_read_b64_tr_b16 a[174:175], v28 offset:43136
v_mfma_f32_16x16x32_bf16 a[4:7], a[144:147], v[84:87], a[4:7]
s_waitcnt vmcnt(4)
buffer_load_dwordx4 v6, s[8:11], s38 offen offset:1024 nt lds
v_mfma_f32_16x16x32_bf16 a[8:11], a[144:147], v[88:91], a[8:11]
s_waitcnt lgkmcnt(12)
ds_read_b64_tr_b16 a[176:177], v25 offset:37120
ds_read_b64_tr_b16 a[178:179], v25 offset:43264
v_mfma_f32_16x16x32_bf16 a[20:23], a[148:151], v[88:91], a[20:23]
v_exp_f32 v120, v56
v_mfma_f32_16x16x32_bf16 a[16:19], a[148:151], v[84:87], a[16:19]
v_exp_f32 v121, v57
v_mfma_f32_16x16x32_bf16 a[12:15], a[148:151], v[80:83], a[12:15]
s_waitcnt lgkmcnt(12)
ds_read_b64_tr_b16 a[180:181], v26 offset:37120
ds_read_b64_tr_b16 a[182:183], v26 offset:43264
v_mfma_f32_16x16x32_bf16 a[24:27], a[152:155], v[80:83], a[24:27]
v_cvt_pk_bf16_f32 v92, v120, v121
v_add_u32 v23, s40, v17
v_mfma_f32_16x16x32_bf16 a[28:31], a[152:155], v[84:87], a[28:31]
ds_read_b64_tr_b16 a[184:185], v27 offset:37120
ds_read_b64_tr_b16 a[186:187], v27 offset:43264
v_mfma_f32_16x16x32_bf16 a[32:35], a[152:155], v[88:91], a[32:35]
s_waitcnt lgkmcnt(14)
v_exp_f32 v122, v58
v_mfma_f32_16x16x32_bf16 a[44:47], a[156:159], v[88:91], a[44:47]
v_exp_f32 v123, v59
v_mfma_f32_16x16x32_bf16 a[40:43], a[156:159], v[84:87], a[40:43]
ds_read_b64_tr_b16 a[188:189], v28 offset:37120
ds_read_b64_tr_b16 a[190:191], v28 offset:43264
v_mfma_f32_16x16x32_bf16 a[36:39], a[156:159], v[80:83], a[36:39]
s_waitcnt lgkmcnt(14)
v_cvt_pk_bf16_f32 v93, v122, v123
v_mfma_f32_16x16x32_bf16 a[48:51], a[160:163], v[80:83], a[48:51]
v_exp_f32 v124, v64
v_mfma_f32_16x16x32_bf16 a[52:55], a[160:163], v[84:87], a[52:55]
v_exp_f32 v125, v65
v_mfma_f32_16x16x32_bf16 a[56:59], a[160:163], v[88:91], a[56:59]
s_waitcnt lgkmcnt(12)
v_cvt_pk_bf16_f32 v96, v124, v125
v_add_u32 v24, s40, v18
v_mfma_f32_16x16x32_bf16 a[68:71], a[164:167], v[88:91], a[68:71]
s_waitcnt vmcnt(4)
buffer_load_dwordx4 v7, s[8:11], s38 offen offset:2048 nt lds
v_mfma_f32_16x16x32_bf16 a[64:67], a[164:167], v[84:87], a[64:67]
s_mov_b32 s38, s42
v_exp_f32 v126, v66
v_mfma_f32_16x16x32_bf16 a[60:63], a[164:167], v[80:83], a[60:63]
s_waitcnt lgkmcnt(10)
v_exp_f32 v127, v67
v_mfma_f32_16x16x32_bf16 a[72:75], a[168:171], v[80:83], a[72:75]
s_add_u32 s42, s42, 12288
s_cmp_ge_u32 s42, 393216
s_cselect_b32 s42, 0, s42
v_mfma_f32_16x16x32_bf16 a[76:79], a[168:171], v[84:87], a[76:79]
s_add_u32 s39, s39, 24576
s_cmp_ge_u32 s39, 147456
s_cselect_b32 s39, s37, s39
v_mfma_f32_16x16x32_bf16 a[80:83], a[168:171], v[88:91], a[80:83]
s_waitcnt lgkmcnt(8)
v_cvt_pk_bf16_f32 v97, v126, v127
v_mfma_f32_16x16x32_bf16 a[92:95], a[172:175], v[88:91], a[92:95]
s_add_u32 s41, s41, 2
v_exp_f32 v128, v72
v_mfma_f32_16x16x32_bf16 a[88:91], a[172:175], v[84:87], a[88:91]
s_cmp_lt_u32 s41, 9
v_exp_f32 v129, v73
v_mfma_f32_16x16x32_bf16 a[84:87], a[172:175], v[80:83], a[84:87]
v_cvt_pk_bf16_f32 v100, v128, v129
v_exp_f32 v120, v74
v_exp_f32 v121, v75
s_nop 0
v_cvt_pk_bf16_f32 v101, v120, v121
s_cbranch_scc1 L_attA0
L_attA1:
s_waitcnt lgkmcnt(6)
v_mfma_f32_16x16x32_bf16 a[96:99], a[176:179], v[80:83], a[96:99]
s_waitcnt vmcnt(12) lgkmcnt(0)
v_exp_f32 v122, v60
v_mfma_f32_16x16x32_bf16 a[100:103], a[176:179], v[84:87], a[100:103]
s_barrier
v_add_u32 v25, s40, v19
v_mfma_f32_16x16x32_bf16 a[104:107], a[176:179], v[88:91], a[104:107]
s_mov_b32 m0, s39
ds_read_b128 a[144:147], v23 offset:0
v_mfma_f32_16x16x32_bf16 a[116:119], a[180:183], v[88:91], a[116:119]
ds_read_b128 a[148:151], v24 offset:0
v_mfma_f32_16x16x32_bf16 a[112:115], a[180:183], v[84:87], a[112:115]
s_waitcnt vmcnt(4)
buffer_load_dwordx4 v2, s[4:7], s42 offen offset:0 nt lds
v_mfma_f32_16x16x32_bf16 a[108:111], a[180:183], v[80:83], a[108:111]
v_exp_f32 v123, v61
v_mfma_f32_16x16x32_bf16 a[120:123], a[184:187], v[80:83], a[120:123]
ds_read_b128 a[152:155], v23 offset:128
v_add_u32 v26, s40, v20
v_mfma_f32_16x16x32_bf16 a[124:127], a[184:187], v[84:87], a[124:127]
v_exp_f32 v124, v62
v_mfma_f32_16x16x32_bf16 a[128:131], a[184:187], v[88:91], a[128:131]
v_mfma_f32_16x16x32_bf16 a[140:143], a[188:191], v[88:91], a[140:143]
ds_read_b128 a[156:159], v24 offset:128
v_cvt_pk_bf16_f32 v94, v122, v123
v_mfma_f32_16x16x32_bf16 a[136:139], a[188:191], v[84:87], a[136:139]
v_exp_f32 v125, v63
v_mfma_f32_16x16x32_bf16 a[132:135], a[188:191], v[80:83], a[132:135]
s_waitcnt lgkmcnt(3)
v_mfma_f32_16x16x32_bf16 v[32:35], a[144:147], v[176:179], v[104:107]
ds_read_b128 a[160:163], v23 offset:256
v_add_u32 v27, s40, v21
v_mfma_f32_16x16x32_bf16 v[40:43], a[144:147], v[200:203], v[108:111]
v_exp_f32 v126, v68
v_mfma_f32_16x16x32_bf16 v[48:51], a[144:147], v[224:227], v[112:115]
s_waitcnt lgkmcnt(3)
ds_read_b128 a[164:167], v24 offset:256
v_cvt_pk_bf16_f32 v95, v124, v125
v_mfma_f32_16x16x32_bf16 v[48:51], a[148:151], v[228:231], v[48:51]
s_waitcnt vmcnt(4)
buffer_load_dwordx4 v3, s[4:7], s42 offen offset:1024 nt lds
v_mfma_f32_16x16x32_bf16 v[40:43], a[148:151], v[204:207], v[40:43]
v_exp_f32 v127, v69
v_mfma_f32_16x16x32_bf16 v[32:35], a[148:151], v[180:183], v[32:35]
s_waitcnt lgkmcnt(3)
ds_read_b128 a[168:171], v23 offset:6144
v_add_u32 v28, s40, v22
v_mfma_f32_16x16x32_bf16 v[32:35], a[152:155], v[184:187], v[32:35]
v_exp_f32 v128, v70
v_mfma_f32_16x16x32_bf16 v[40:43], a[152:155], v[208:211], v[40:43]
v_mfma_f32_16x16x32_bf16 v[48:51], a[152:155], v[232:235], v[48:51]
s_waitcnt lgkmcnt(3)
ds_read_b128 a[172:175], v24 offset:6144
v_cvt_pk_bf16_f32 v98, v126, v127
v_mfma_f32_16x16x32_bf16 v[48:51], a[156:159], v[236:239], v[48:51]
v_exp_f32 v129, v71
v_mfma_f32_16x16x32_bf16 v[40:43], a[156:159], v[212:215], v[40:43]
v_mfma_f32_16x16x32_bf16 v[32:35], a[156:159], v[188:191], v[32:35]
s_waitcnt lgkmcnt(3)
ds_read_b128 a[176:179], v23 offset:6272
v_cvt_pk_bf16_f32 v99, v128, v129
v_mfma_f32_16x16x32_bf16 v[32:35], a[160:163], v[192:195], v[32:35]
s_waitcnt vmcnt(4)
buffer_load_dwordx4 v4, s[4:7], s42 offen offset:2048 nt lds
v_mfma_f32_16x16x32_bf16 v[40:43], a[160:163], v[216:219], v[40:43]
ds_read_b128 a[180:183], v24 offset:6272
v_mfma_f32_16x16x32_bf16 v[48:51], a[160:163], v[240:243], v[48:51]
s_waitcnt lgkmcnt(4)
v_exp_f32 v120, v76
v_mfma_f32_16x16x32_bf16 v[48:51], a[164:167], v[244:247], v[48:51]
v_exp_f32 v121, v77
v_mfma_f32_16x16x32_bf16 v[40:43], a[164:167], v[220:223], v[40:43]
ds_read_b128 a[184:187], v23 offset:6400
v_cvt_pk_bf16_f32 v102, v120, v121
v_mfma_f32_16x16x32_bf16 v[32:35], a[164:167], v[196:199], v[32:35]
s_waitcnt lgkmcnt(4)
v_mfma_f32_16x16x32_bf16 v[36:39], a[168:171], v[176:179], v[104:107]
s_add_u32 m0, s39, 12288
v_exp_f32 v122, v78
v_mfma_f32_16x16x32_bf16 v[44:47], a[168:171], v[200:203], v[108:111]
ds_read_b128 a[188:191], v24 offset:6400
v_mfma_f32_16x16x32_bf16 v[52:55], a[168:171], v[224:227], v[112:115]
s_waitcnt lgkmcnt(4)
v_mfma_f32_16x16x32_bf16 v[52:55], a[172:175], v[228:231], v[52:55]
ds_read_b64_tr_b16 a[144:145], v25 offset:12288
ds_read_b64_tr_b16 a[146:147], v25 offset:18432
v_mfma_f32_16x16x32_bf16 v[44:47], a[172:175], v[204:207], v[44:47]
s_waitcnt vmcnt(4)
buffer_load_dwordx4 v5, s[8:11], s38 offen offset:0 nt lds
v_mfma_f32_16x16x32_bf16 v[36:39], a[172:175], v[180:183], v[36:39]
s_waitcnt lgkmcnt(5)
ds_read_b64_tr_b16 a[148:149], v26 offset:12288
ds_read_b64_tr_b16 a[150:151], v26 offset:18432
v_mfma_f32_16x16x32_bf16 v[36:39], a[176:179], v[184:187], v[36:39]
v_exp_f32 v123, v79
v_mfma_f32_16x16x32_bf16 v[44:47], a[176:179], v[208:211], v[44:47]
v_cvt_pk_bf16_f32 v103, v122, v123
v_mfma_f32_16x16x32_bf16 v[52:55], a[176:179], v[232:235], v[52:55]
ds_read_b64_tr_b16 a[152:153], v27 offset:12288
ds_read_b64_tr_b16 a[154:155], v27 offset:18432
v_mfma_f32_16x16x32_bf16 v[156:159], a[240:243], v[92:95], v[144:147]
v_mfma_f32_16x16x32_bf16 v[160:163], a[240:243], v[96:99], v[148:151]
ds_read_b64_tr_b16 a[156:157], v28 offset:12288
ds_read_b64_tr_b16 a[158:159], v28 offset:18432
v_mfma_f32_16x16x32_bf16 v[164:167], a[240:243], v[100:103], v[152:155]
s_waitcnt lgkmcnt(10)
v_mfma_f32_16x16x32_bf16 v[52:55], a[180:183], v[236:239], v[52:55]
v_mfma_f32_16x16x32_bf16 v[44:47], a[180:183], v[212:215], v[44:47]
ds_read_b64_tr_b16 a[160:161], v25 offset:12416
ds_read_b64_tr_b16 a[162:163], v25 offset:18560
v_mfma_f32_16x16x32_bf16 v[36:39], a[180:183], v[188:191], v[36:39]
s_waitcnt lgkmcnt(11)
v_mfma_f32_16x16x32_bf16 v[36:39], a[184:187], v[192:195], v[36:39]
ds_read_b64_tr_b16 a[164:165], v26 offset:12416
ds_read_b64_tr_b16 a[166:167], v26 offset:18560
v_mfma_f32_16x16x32_bf16 v[44:47], a[184:187], v[216:219], v[44:47]
v_max3_f32 v130, v156, v160, v164
v_cmp_nge_f32 vcc, s3, v130
v_mfma_f32_16x16x32_bf16 v[52:55], a[184:187], v[240:243], v[52:55]
s_waitcnt lgkmcnt(12)
v_mfma_f32_16x16x32_bf16 v[52:55], a[188:191], v[244:247], v[52:55]
ds_read_b64_tr_b16 a[168:169], v27 offset:12416
ds_read_b64_tr_b16 a[170:171], v27 offset:18560
v_mfma_f32_16x16x32_bf16 v[44:47], a[188:191], v[220:223], v[44:47]
s_waitcnt vmcnt(4)
buffer_load_dwordx4 v6, s[8:11], s38 offen offset:1024 nt lds
v_mfma_f32_16x16x32_bf16 v[36:39], a[188:191], v[196:199], v[36:39]
s_cbranch_vccnz L_tramp_6
L_ret_5:
s_waitcnt lgkmcnt(12)
v_mfma_f32_16x16x32_bf16 a[0:3], a[144:147], v[92:95], a[0:3]
ds_read_b64_tr_b16 a[172:173], v28 offset:12416
ds_read_b64_tr_b16 a[174:175], v28 offset:18560
v_mfma_f32_16x16x32_bf16 a[4:7], a[144:147], v[96:99], a[4:7]
v_exp_f32 v120, v32
v_mfma_f32_16x16x32_bf16 a[8:11], a[144:147], v[100:103], a[8:11]
s_waitcnt lgkmcnt(12)
ds_read_b64_tr_b16 a[176:177], v25 offset:12544
ds_read_b64_tr_b16 a[178:179], v25 offset:18688
v_mfma_f32_16x16x32_bf16 a[20:23], a[148:151], v[100:103], a[20:23]
s_waitcnt vmcnt(4)
buffer_load_dwordx4 v7, s[8:11], s38 offen offset:2048 nt lds
v_mfma_f32_16x16x32_bf16 a[16:19], a[148:151], v[96:99], a[16:19]
s_mov_b32 s38, s42
v_exp_f32 v121, v33
v_mfma_f32_16x16x32_bf16 a[12:15], a[148:151], v[92:95], a[12:15]
s_waitcnt lgkmcnt(12)
ds_read_b64_tr_b16 a[180:181], v26 offset:12544
ds_read_b64_tr_b16 a[182:183], v26 offset:18688
v_mfma_f32_16x16x32_bf16 a[24:27], a[152:155], v[92:95], a[24:27]
s_add_u32 s42, s42, 12288
s_cmp_ge_u32 s42, 393216
s_cselect_b32 s42, 0, s42
v_mfma_f32_16x16x32_bf16 a[28:31], a[152:155], v[96:99], a[28:31]
s_add_u32 s39, s39, 24576
ds_read_b64_tr_b16 a[184:185], v27 offset:12544
ds_read_b64_tr_b16 a[186:187], v27 offset:18688
v_mfma_f32_16x16x32_bf16 a[32:35], a[152:155], v[100:103], a[32:35]
s_waitcnt lgkmcnt(14)
s_cmp_ge_u32 s39, 147456
s_cselect_b32 s39, s37, s39
v_mfma_f32_16x16x32_bf16 a[44:47], a[156:159], v[100:103], a[44:47]
v_cvt_pk_bf16_f32 v80, v120, v121
v_mfma_f32_16x16x32_bf16 a[40:43], a[156:159], v[96:99], a[40:43]
ds_read_b64_tr_b16 a[188:189], v28 offset:12544
ds_read_b64_tr_b16 a[190:191], v28 offset:18688
v_mfma_f32_16x16x32_bf16 a[36:39], a[156:159], v[92:95], a[36:39]
s_waitcnt lgkmcnt(14)
v_exp_f32 v122, v34
v_mfma_f32_16x16x32_bf16 a[48:51], a[160:163], v[92:95], a[48:51]
v_exp_f32 v123, v35
v_mfma_f32_16x16x32_bf16 a[52:55], a[160:163], v[96:99], a[52:55]
v_cvt_pk_bf16_f32 v81, v122, v123
v_mfma_f32_16x16x32_bf16 a[56:59], a[160:163], v[100:103], a[56:59]
s_waitcnt lgkmcnt(12)
v_exp_f32 v124, v40
v_mfma_f32_16x16x32_bf16 a[68:71], a[164:167], v[100:103], a[68:71]
v_exp_f32 v125, v41
v_mfma_f32_16x16x32_bf16 a[64:67], a[164:167], v[96:99], a[64:67]
v_cvt_pk_bf16_f32 v84, v124, v125
v_mfma_f32_16x16x32_bf16 a[60:63], a[164:167], v[92:95], a[60:63]
s_waitcnt lgkmcnt(10)
v_exp_f32 v126, v42
v_mfma_f32_16x16x32_bf16 a[72:75], a[168:171], v[92:95], a[72:75]
v_exp_f32 v127, v43
v_mfma_f32_16x16x32_bf16 a[76:79], a[168:171], v[96:99], a[76:79]
v_cvt_pk_bf16_f32 v85, v126, v127
v_mfma_f32_16x16x32_bf16 a[80:83], a[168:171], v[100:103], a[80:83]
s_waitcnt lgkmcnt(8)
v_exp_f32 v128, v48
v_mfma_f32_16x16x32_bf16 a[92:95], a[172:175], v[100:103], a[92:95]
v_exp_f32 v129, v49
v_mfma_f32_16x16x32_bf16 a[88:91], a[172:175], v[96:99], a[88:91]
v_cvt_pk_bf16_f32 v88, v128, v129
v_mfma_f32_16x16x32_bf16 a[84:87], a[172:175], v[92:95], a[84:87]
s_waitcnt lgkmcnt(6)
v_exp_f32 v120, v50
v_exp_f32 v121, v51
s_nop 0
v_cvt_pk_bf16_f32 v89, v120, v121
v_mfma_f32_16x16x32_bf16 a[96:99], a[176:179], v[92:95], a[96:99]
s_waitcnt vmcnt(12) lgkmcnt(0)
v_exp_f32 v122, v36
v_mfma_f32_16x16x32_bf16 a[100:103], a[176:179], v[96:99], a[100:103]
s_barrier
v_mfma_f32_16x16x32_bf16 a[104:107], a[176:179], v[100:103], a[104:107]
s_mov_b32 m0, s39
ds_read_b128 a[144:147], v23 offset:24576
v_mfma_f32_16x16x32_bf16 a[116:119], a[180:183], v[100:103], a[116:119]
ds_read_b128 a[148:151], v24 offset:24576
v_mfma_f32_16x16x32_bf16 a[112:115], a[180:183], v[96:99], a[112:115]
s_waitcnt vmcnt(4)
buffer_load_dwordx4 v2, s[4:7], s42 offen offset:0 nt lds
v_mfma_f32_16x16x32_bf16 a[108:111], a[180:183], v[92:95], a[108:111]
v_exp_f32 v123, v37
v_mfma_f32_16x16x32_bf16 a[120:123], a[184:187], v[92:95], a[120:123]
ds_read_b128 a[152:155], v23 offset:24704
v_cvt_pk_bf16_f32 v82, v122, v123
v_mfma_f32_16x16x32_bf16 a[124:127], a[184:187], v[96:99], a[124:127]
v_exp_f32 v124, v38
v_mfma_f32_16x16x32_bf16 a[128:131], a[184:187], v[100:103], a[128:131]
v_mfma_f32_16x16x32_bf16 a[140:143], a[188:191], v[100:103], a[140:143]
ds_read_b128 a[156:159], v24 offset:24704
v_mfma_f32_16x16x32_bf16 a[136:139], a[188:191], v[96:99], a[136:139]
v_exp_f32 v125, v39
v_mfma_f32_16x16x32_bf16 a[132:135], a[188:191], v[92:95], a[132:135]
s_waitcnt lgkmcnt(3)
v_mfma_f32_16x16x32_bf16 v[56:59], a[144:147], v[176:179], v[104:107]
ds_read_b128 a[160:163], v23 offset:24832
v_cvt_pk_bf16_f32 v83, v124, v125
v_mfma_f32_16x16x32_bf16 v[64:67], a[144:147], v[200:203], v[108:111]
v_exp_f32 v126, v44
v_mfma_f32_16x16x32_bf16 v[72:75], a[144:147], v[224:227], v[112:115]
s_waitcnt lgkmcnt(3)
ds_read_b128 a[164:167], v24 offset:24832
v_mfma_f32_16x16x32_bf16 v[72:75], a[148:151], v[228:231], v[72:75]
s_waitcnt vmcnt(4)
buffer_load_dwordx4 v3, s[4:7], s42 offen offset:1024 nt lds
v_mfma_f32_16x16x32_bf16 v[64:67], a[148:151], v[204:207], v[64:67]
v_exp_f32 v127, v45
v_mfma_f32_16x16x32_bf16 v[56:59], a[148:151], v[180:183], v[56:59]
s_waitcnt lgkmcnt(3)
ds_read_b128 a[168:171], v23 offset:30720
v_cvt_pk_bf16_f32 v86, v126, v127
v_mfma_f32_16x16x32_bf16 v[56:59], a[152:155], v[184:187], v[56:59]
v_exp_f32 v128, v46
v_mfma_f32_16x16x32_bf16 v[64:67], a[152:155], v[208:211], v[64:67]
v_mfma_f32_16x16x32_bf16 v[72:75], a[152:155], v[232:235], v[72:75]
s_waitcnt lgkmcnt(3)
ds_read_b128 a[172:175], v24 offset:30720
v_mfma_f32_16x16x32_bf16 v[72:75], a[156:159], v[236:239], v[72:75]
v_exp_f32 v129, v47
v_mfma_f32_16x16x32_bf16 v[64:67], a[156:159], v[212:215], v[64:67]
v_mfma_f32_16x16x32_bf16 v[56:59], a[156:159], v[188:191], v[56:59]
s_waitcnt lgkmcnt(3)
ds_read_b128 a[176:179], v23 offset:30848
v_cvt_pk_bf16_f32 v87, v128, v129
v_mfma_f32_16x16x32_bf16 v[56:59], a[160:163], v[192:195], v[56:59]
s_waitcnt vmcnt(4)
buffer_load_dwordx4 v4, s[4:7], s42 offen offset:2048 nt lds
v_mfma_f32_16x16x32_bf16 v[64:67], a[160:163], v[216:219], v[64:67]
ds_read_b128 a[180:183], v24 offset:30848
v_mfma_f32_16x16x32_bf16 v[72:75], a[160:163], v[240:243], v[72:75]
s_waitcnt lgkmcnt(4)
v_exp_f32 v120, v52
v_mfma_f32_16x16x32_bf16 v[72:75], a[164:167], v[244:247], v[72:75]
v_exp_f32 v121, v53
v_mfma_f32_16x16x32_bf16 v[64:67], a[164:167], v[220:223], v[64:67]
ds_read_b128 a[184:187], v23 offset:30976
v_cvt_pk_bf16_f32 v90, v120, v121
v_mfma_f32_16x16x32_bf16 v[56:59], a[164:167], v[196:199], v[56:59]
s_waitcnt lgkmcnt(4)
v_mfma_f32_16x16x32_bf16 v[60:63], a[168:171], v[176:179], v[104:107]
s_add_u32 m0, s39, 12288
v_exp_f32 v122, v54
v_mfma_f32_16x16x32_bf16 v[68:71], a[168:171], v[200:203], v[108:111]
ds_read_b128 a[188:191], v24 offset:30976
v_mfma_f32_16x16x32_bf16 v[76:79], a[168:171], v[224:227], v[112:115]
s_waitcnt lgkmcnt(4)
v_mfma_f32_16x16x32_bf16 v[76:79], a[172:175], v[228:231], v[76:79]
ds_read_b64_tr_b16 a[144:145], v25 offset:36864
ds_read_b64_tr_b16 a[146:147], v25 offset:43008
v_mfma_f32_16x16x32_bf16 v[68:71], a[172:175], v[204:207], v[68:71]
s_waitcnt vmcnt(4)
buffer_load_dwordx4 v5, s[8:11], s38 offen offset:0 nt lds
v_mfma_f32_16x16x32_bf16 v[60:63], a[172:175], v[180:183], v[60:63]
s_waitcnt lgkmcnt(5)
ds_read_b64_tr_b16 a[148:149], v26 offset:36864
ds_read_b64_tr_b16 a[150:151], v26 offset:43008
v_mfma_f32_16x16x32_bf16 v[60:63], a[176:179], v[184:187], v[60:63]
v_exp_f32 v123, v55
v_mfma_f32_16x16x32_bf16 v[68:71], a[176:179], v[208:211], v[68:71]
v_cvt_pk_bf16_f32 v91, v122, v123
v_mfma_f32_16x16x32_bf16 v[76:79], a[176:179], v[232:235], v[76:79]
ds_read_b64_tr_b16 a[152:153], v27 offset:36864
ds_read_b64_tr_b16 a[154:155], v27 offset:43008
v_mfma_f32_16x16x32_bf16 v[144:147], a[240:243], v[80:83], v[156:159]
s_add_u32 s40, s40, 49152
v_mfma_f32_16x16x32_bf16 v[148:151], a[240:243], v[84:87], v[160:163]
ds_read_b64_tr_b16 a[156:157], v28 offset:36864
ds_read_b64_tr_b16 a[158:159], v28 offset:43008
v_mfma_f32_16x16x32_bf16 v[152:155], a[240:243], v[88:91], v[164:167]
s_waitcnt lgkmcnt(10)
v_mfma_f32_16x16x32_bf16 v[76:79], a[180:183], v[236:239], v[76:79]
v_mfma_f32_16x16x32_bf16 v[68:71], a[180:183], v[212:215], v[68:71]
ds_read_b64_tr_b16 a[160:161], v25 offset:36992
ds_read_b64_tr_b16 a[162:163], v25 offset:43136
v_mfma_f32_16x16x32_bf16 v[60:63], a[180:183], v[188:191], v[60:63]
s_waitcnt lgkmcnt(11)
v_mfma_f32_16x16x32_bf16 v[60:63], a[184:187], v[192:195], v[60:63]
ds_read_b64_tr_b16 a[164:165], v26 offset:36992
ds_read_b64_tr_b16 a[166:167], v26 offset:43136
v_mfma_f32_16x16x32_bf16 v[68:71], a[184:187], v[216:219], v[68:71]
v_max3_f32 v130, v144, v148, v152
v_cmp_nge_f32 vcc, s3, v130
v_mfma_f32_16x16x32_bf16 v[76:79], a[184:187], v[240:243], v[76:79]
s_waitcnt lgkmcnt(12)
s_cmp_ge_u32 s40, 147456
s_cselect_b32 s40, 0, s40
v_mfma_f32_16x16x32_bf16 v[76:79], a[188:191], v[244:247], v[76:79]
ds_read_b64_tr_b16 a[168:169], v27 offset:36992
ds_read_b64_tr_b16 a[170:171], v27 offset:43136
v_mfma_f32_16x16x32_bf16 v[68:71], a[188:191], v[220:223], v[68:71]
s_waitcnt vmcnt(4)
buffer_load_dwordx4 v6, s[8:11], s38 offen offset:1024 nt lds
v_mfma_f32_16x16x32_bf16 v[60:63], a[188:191], v[196:199], v[60:63]
s_cbranch_vccnz L_tramp_8
L_ret_7:
s_waitcnt lgkmcnt(12)
v_mfma_f32_16x16x32_bf16 a[0:3], a[144:147], v[80:83], a[0:3]
ds_read_b64_tr_b16 a[172:173], v28 offset:36992
ds_read_b64_tr_b16 a[174:175], v28 offset:43136
v_mfma_f32_16x16x32_bf16 a[4:7], a[144:147], v[84:87], a[4:7]
v_exp_f32 v120, v56
v_mfma_f32_16x16x32_bf16 a[8:11], a[144:147], v[88:91], a[8:11]
s_waitcnt lgkmcnt(12)
ds_read_b64_tr_b16 a[176:177], v25 offset:37120
ds_read_b64_tr_b16 a[178:179], v25 offset:43264
v_mfma_f32_16x16x32_bf16 a[20:23], a[148:151], v[88:91], a[20:23]
s_waitcnt vmcnt(4)
buffer_load_dwordx4 v7, s[8:11], s38 offen offset:2048 nt lds
v_mfma_f32_16x16x32_bf16 a[16:19], a[148:151], v[84:87], a[16:19]
s_mov_b32 s38, s42
v_exp_f32 v121, v57
v_mfma_f32_16x16x32_bf16 a[12:15], a[148:151], v[80:83], a[12:15]
s_waitcnt lgkmcnt(12)
ds_read_b64_tr_b16 a[180:181], v26 offset:37120
ds_read_b64_tr_b16 a[182:183], v26 offset:43264
v_mfma_f32_16x16x32_bf16 a[24:27], a[152:155], v[80:83], a[24:27]
s_add_u32 s42, s42, 12288
s_cmp_ge_u32 s42, 393216
s_cselect_b32 s42, 0, s42
v_mfma_f32_16x16x32_bf16 a[28:31], a[152:155], v[84:87], a[28:31]
s_add_u32 s39, s39, 24576
ds_read_b64_tr_b16 a[184:185], v27 offset:37120
ds_read_b64_tr_b16 a[186:187], v27 offset:43264
v_mfma_f32_16x16x32_bf16 a[32:35], a[152:155], v[88:91], a[32:35]
s_waitcnt lgkmcnt(14)
s_cmp_ge_u32 s39, 147456
s_cselect_b32 s39, s37, s39
v_mfma_f32_16x16x32_bf16 a[44:47], a[156:159], v[88:91], a[44:47]
v_cvt_pk_bf16_f32 v92, v120, v121
v_add_u32 v23, s40, v17
v_mfma_f32_16x16x32_bf16 a[40:43], a[156:159], v[84:87], a[40:43]
ds_read_b64_tr_b16 a[188:189], v28 offset:37120
ds_read_b64_tr_b16 a[190:191], v28 offset:43264
v_mfma_f32_16x16x32_bf16 a[36:39], a[156:159], v[80:83], a[36:39]
s_waitcnt lgkmcnt(14)
v_exp_f32 v122, v58
v_mfma_f32_16x16x32_bf16 a[48:51], a[160:163], v[80:83], a[48:51]
v_exp_f32 v123, v59
v_mfma_f32_16x16x32_bf16 a[52:55], a[160:163], v[84:87], a[52:55]
v_cvt_pk_bf16_f32 v93, v122, v123
v_add_u32 v24, s40, v18
v_mfma_f32_16x16x32_bf16 a[56:59], a[160:163], v[88:91], a[56:59]
s_waitcnt lgkmcnt(12)
v_exp_f32 v124, v64
v_mfma_f32_16x16x32_bf16 a[68:71], a[164:167], v[88:91], a[68:71]
v_exp_f32 v125, v65
v_mfma_f32_16x16x32_bf16 a[64:67], a[164:167], v[84:87], a[64:67]
v_cvt_pk_bf16_f32 v96, v124, v125
v_mfma_f32_16x16x32_bf16 a[60:63], a[164:167], v[80:83], a[60:63]
s_waitcnt lgkmcnt(10)
v_exp_f32 v126, v66
v_mfma_f32_16x16x32_bf16 a[72:75], a[168:171], v[80:83], a[72:75]
v_exp_f32 v127, v67
v_mfma_f32_16x16x32_bf16 a[76:79], a[168:171], v[84:87], a[76:79]
v_cvt_pk_bf16_f32 v97, v126, v127
v_mfma_f32_16x16x32_bf16 a[80:83], a[168:171], v[88:91], a[80:83]
s_waitcnt lgkmcnt(8)
v_exp_f32 v128, v72
v_mfma_f32_16x16x32_bf16 a[92:95], a[172:175], v[88:91], a[92:95]
s_add_u32 s41, s41, 2
v_exp_f32 v129, v73
v_mfma_f32_16x16x32_bf16 a[88:91], a[172:175], v[84:87], a[88:91]
s_cmp_lt_u32 s41, 27
v_cvt_pk_bf16_f32 v100, v128, v129
v_mfma_f32_16x16x32_bf16 a[84:87], a[172:175], v[80:83], a[84:87]
v_exp_f32 v120, v74
v_exp_f32 v121, v75
s_nop 0
v_cvt_pk_bf16_f32 v101, v120, v121
s_cbranch_scc1 L_attA1
L_att27:
s_waitcnt lgkmcnt(6)
v_mfma_f32_16x16x32_bf16 a[96:99], a[176:179], v[80:83], a[96:99]
s_waitcnt vmcnt(12) lgkmcnt(0)
v_exp_f32 v122, v60
v_mfma_f32_16x16x32_bf16 a[100:103], a[176:179], v[84:87], a[100:103]
s_barrier
v_add_u32 v25, s40, v19
v_mfma_f32_16x16x32_bf16 a[104:107], a[176:179], v[88:91], a[104:107]
s_mov_b32 m0, s39
ds_read_b128 a[144:147], v23 offset:0
v_mfma_f32_16x16x32_bf16 a[116:119], a[180:183], v[88:91], a[116:119]
ds_read_b128 a[148:151], v24 offset:0
v_mfma_f32_16x16x32_bf16 a[112:115], a[180:183], v[84:87], a[112:115]
s_waitcnt vmcnt(4)
buffer_load_dwordx4 v2, s[4:7], s42 offen offset:0 nt lds
v_mfma_f32_16x16x32_bf16 a[108:111], a[180:183], v[80:83], a[108:111]
v_exp_f32 v123, v61
v_mfma_f32_16x16x32_bf16 a[120:123], a[184:187], v[80:83], a[120:123]
ds_read_b128 a[152:155], v23 offset:128
v_add_u32 v26, s40, v20
v_mfma_f32_16x16x32_bf16 a[124:127], a[184:187], v[84:87], a[124:127]
v_exp_f32 v124, v62
v_mfma_f32_16x16x32_bf16 a[128:131], a[184:187], v[88:91], a[128:131]
v_mfma_f32_16x16x32_bf16 a[140:143], a[188:191], v[88:91], a[140:143]
ds_read_b128 a[156:159], v24 offset:128
v_cvt_pk_bf16_f32 v94, v122, v123
v_mfma_f32_16x16x32_bf16 a[136:139], a[188:191], v[84:87], a[136:139]
v_exp_f32 v125, v63
v_mfma_f32_16x16x32_bf16 a[132:135], a[188:191], v[80:83], a[132:135]
s_waitcnt lgkmcnt(3)
v_mfma_f32_16x16x32_bf16 v[32:35], a[144:147], v[176:179], v[104:107]
ds_read_b128 a[160:163], v23 offset:256
v_add_u32 v27, s40, v21
v_mfma_f32_16x16x32_bf16 v[40:43], a[144:147], v[200:203], v[108:111]
s_waitcnt vmcnt(4)
buffer_load_dwordx4 v3, s[4:7], s42 offen offset:1024 nt lds
v_mfma_f32_16x16x32_bf16 v[48:51], a[144:147], v[224:227], v[112:115]
s_waitcnt lgkmcnt(3)
ds_read_b128 a[164:167], v24 offset:256
v_cvt_pk_bf16_f32 v95, v124, v125
v_mfma_f32_16x16x32_bf16 v[48:51], a[148:151], v[228:231], v[48:51]
v_exp_f32 v126, v68
v_mfma_f32_16x16x32_bf16 v[40:43], a[148:151], v[204:207], v[40:43]
v_exp_f32 v127, v69
v_mfma_f32_16x16x32_bf16 v[32:35], a[148:151], v[180:183], v[32:35]
s_waitcnt lgkmcnt(3)
ds_read_b128 a[168:171], v23 offset:6144
v_add_u32 v28, s40, v22
v_mfma_f32_16x16x32_bf16 v[32:35], a[152:155], v[184:187], v[32:35]
s_waitcnt vmcnt(4)
buffer_load_dwordx4 v4, s[4:7], s42 offen offset:2048 nt lds
v_mfma_f32_16x16x32_bf16 v[40:43], a[152:155], v[208:211], v[40:43]
v_exp_f32 v128, v70
v_mfma_f32_16x16x32_bf16 v[48:51], a[152:155], v[232:235], v[48:51]
s_waitcnt lgkmcnt(3)
ds_read_b128 a[172:175], v24 offset:6144
v_cvt_pk_bf16_f32 v98, v126, v127
v_mfma_f32_16x16x32_bf16 v[48:51], a[156:159], v[236:239], v[48:51]
v_exp_f32 v129, v71
v_mfma_f32_16x16x32_bf16 v[40:43], a[156:159], v[212:215], v[40:43]
s_add_u32 m0, s39, 12288
v_mfma_f32_16x16x32_bf16 v[32:35], a[156:159], v[188:191], v[32:35]
s_waitcnt lgkmcnt(3)
ds_read_b128 a[176:179], v23 offset:6272
v_cvt_pk_bf16_f32 v99, v128, v129
v_mfma_f32_16x16x32_bf16 v[32:35], a[160:163], v[192:195], v[32:35]
v_exp_f32 v120, v76
v_mfma_f32_16x16x32_bf16 v[40:43], a[160:163], v[216:219], v[40:43]
ds_read_b128 a[180:183], v24 offset:6272
v_mfma_f32_16x16x32_bf16 v[48:51], a[160:163], v[240:243], v[48:51]
s_waitcnt lgkmcnt(4)
v_mfma_f32_16x16x32_bf16 v[48:51], a[164:167], v[244:247], v[48:51]
s_waitcnt vmcnt(4)
buffer_load_dwordx4 v5, s[8:11], s38 offen offset:0 nt lds
v_mfma_f32_16x16x32_bf16 v[40:43], a[164:167], v[220:223], v[40:43]
ds_read_b128 a[184:187], v23 offset:6400
v_mfma_f32_16x16x32_bf16 v[32:35], a[164:167], v[196:199], v[32:35]
s_waitcnt lgkmcnt(4)
v_exp_f32 v121, v77
v_mfma_f32_16x16x32_bf16 v[36:39], a[168:171], v[176:179], v[104:107]
v_exp_f32 v122, v78
v_mfma_f32_16x16x32_bf16 v[44:47], a[168:171], v[200:203], v[108:111]
ds_read_b128 a[188:191], v24 offset:6400
v_cvt_pk_bf16_f32 v102, v120, v121
v_mfma_f32_16x16x32_bf16 v[52:55], a[168:171], v[224:227], v[112:115]
s_waitcnt lgkmcnt(4)
v_mfma_f32_16x16x32_bf16 v[52:55], a[172:175], v[228:231], v[52:55]
ds_read_b64_tr_b16 a[144:145], v25 offset:12288
ds_read_b64_tr_b16 a[146:147], v25 offset:18432
v_mfma_f32_16x16x32_bf16 v[44:47], a[172:175], v[204:207], v[44:47]
s_waitcnt vmcnt(4)
buffer_load_dwordx4 v6, s[8:11], s38 offen offset:1024 nt lds
v_mfma_f32_16x16x32_bf16 v[36:39], a[172:175], v[180:183], v[36:39]
s_waitcnt lgkmcnt(5)
ds_read_b64_tr_b16 a[148:149], v26 offset:12288
ds_read_b64_tr_b16 a[150:151], v26 offset:18432
v_mfma_f32_16x16x32_bf16 v[36:39], a[176:179], v[184:187], v[36:39]
v_exp_f32 v123, v79
v_mfma_f32_16x16x32_bf16 v[44:47], a[176:179], v[208:211], v[44:47]
v_cvt_pk_bf16_f32 v103, v122, v123
v_mfma_f32_16x16x32_bf16 v[52:55], a[176:179], v[232:235], v[52:55]
ds_read_b64_tr_b16 a[152:153], v27 offset:12288
ds_read_b64_tr_b16 a[154:155], v27 offset:18432
v_mfma_f32_16x16x32_bf16 v[156:159], a[240:243], v[92:95], v[144:147]
v_mfma_f32_16x16x32_bf16 v[160:163], a[240:243], v[96:99], v[148:151]
ds_read_b64_tr_b16 a[156:157], v28 offset:12288
ds_read_b64_tr_b16 a[158:159], v28 offset:18432
v_mfma_f32_16x16x32_bf16 v[164:167], a[240:243], v[100:103], v[152:155]
s_waitcnt lgkmcnt(10)
v_mfma_f32_16x16x32_bf16 v[52:55], a[180:183], v[236:239], v[52:55]
s_waitcnt vmcnt(4)
buffer_load_dwordx4 v7, s[8:11], s38 offen offset:2048 nt lds
v_mfma_f32_16x16x32_bf16 v[44:47], a[180:183], v[212:215], v[44:47]
s_mov_b32 s38, s42
ds_read_b64_tr_b16 a[160:161], v25 offset:12416
ds_read_b64_tr_b16 a[162:163], v25 offset:18560
v_mfma_f32_16x16x32_bf16 v[36:39], a[180:183], v[188:191], v[36:39]
s_waitcnt lgkmcnt(11)
v_mfma_f32_16x16x32_bf16 v[36:39], a[184:187], v[192:195], v[36:39]
s_add_u32 s42, s42, 12288
ds_read_b64_tr_b16 a[164:165], v26 offset:12416
ds_read_b64_tr_b16 a[166:167], v26 offset:18560
v_mfma_f32_16x16x32_bf16 v[44:47], a[184:187], v[216:219], v[44:47]
v_max3_f32 v130, v156, v160, v164
v_cmp_nge_f32 vcc, s3, v130
v_mfma_f32_16x16x32_bf16 v[52:55], a[184:187], v[240:243], v[52:55]
s_waitcnt lgkmcnt(12)
s_cmp_ge_u32 s42, 393216
s_cselect_b32 s42, 0, s42
v_mfma_f32_16x16x32_bf16 v[52:55], a[188:191], v[244:247], v[52:55]
s_add_u32 s39, s39, 24576
ds_read_b64_tr_b16 a[168:169], v27 offset:12416
ds_read_b64_tr_b16 a[170:171], v27 offset:18560
v_mfma_f32_16x16x32_bf16 v[44:47], a[188:191], v[220:223], v[44:47]
s_cmp_ge_u32 s39, 147456
s_cselect_b32 s39, s37, s39
v_mfma_f32_16x16x32_bf16 v[36:39], a[188:191], v[196:199], v[36:39]
s_cbranch_vccnz L_tramp_10
L_ret_9:
s_waitcnt lgkmcnt(12)
v_mfma_f32_16x16x32_bf16 a[0:3], a[144:147], v[92:95], a[0:3]
s_add_u32 m0, s39, 12288
ds_read_b64_tr_b16 a[172:173], v28 offset:12416
ds_read_b64_tr_b16 a[174:175], v28 offset:18560
v_mfma_f32_16x16x32_bf16 a[4:7], a[144:147], v[96:99], a[4:7]
buffer_load_dwordx4 v5, s[8:11], s38 offen offset:0 nt lds
v_mfma_f32_16x16x32_bf16 a[8:11], a[144:147], v[100:103], a[8:11]
s_waitcnt lgkmcnt(12)
ds_read_b64_tr_b16 a[176:177], v25 offset:12544
ds_read_b64_tr_b16 a[178:179], v25 offset:18688
v_mfma_f32_16x16x32_bf16 a[20:23], a[148:151], v[100:103], a[20:23]
buffer_load_dwordx4 v6, s[8:11], s38 offen offset:1024 nt lds
v_mfma_f32_16x16x32_bf16 a[16:19], a[148:151], v[96:99], a[16:19]
v_exp_f32 v120, v32
v_mfma_f32_16x16x32_bf16 a[12:15], a[148:151], v[92:95], a[12:15]
s_waitcnt lgkmcnt(12)
ds_read_b64_tr_b16 a[180:181], v26 offset:12544
ds_read_b64_tr_b16 a[182:183], v26 offset:18688
v_mfma_f32_16x16x32_bf16 a[24:27], a[152:155], v[92:95], a[24:27]
buffer_load_dwordx4 v7, s[8:11], s38 offen offset:2048 nt lds
v_mfma_f32_16x16x32_bf16 a[28:31], a[152:155], v[96:99], a[28:31]
ds_read_b64_tr_b16 a[184:185], v27 offset:12544
ds_read_b64_tr_b16 a[186:187], v27 offset:18688
v_mfma_f32_16x16x32_bf16 a[32:35], a[152:155], v[100:103], a[32:35]
s_waitcnt lgkmcnt(14)
v_accvgpr_read_b32 v11, a244
v_accvgpr_read_b32 v12, a245
v_mfma_f32_16x16x32_bf16 a[44:47], a[156:159], v[100:103], a[44:47]
v_accvgpr_read_b32 v13, a246
v_accvgpr_read_b32 v14, a247
v_mfma_f32_16x16x32_bf16 a[40:43], a[156:159], v[96:99], a[40:43]
ds_read_b64_tr_b16 a[188:189], v28 offset:12544
ds_read_b64_tr_b16 a[190:191], v28 offset:18688
v_mfma_f32_16x16x32_bf16 a[36:39], a[156:159], v[92:95], a[36:39]
s_waitcnt lgkmcnt(14)
v_accvgpr_read_b32 v15, a248
v_accvgpr_read_b32 v16, a249
v_mfma_f32_16x16x32_bf16 a[48:51], a[160:163], v[92:95], a[48:51]
v_accvgpr_read_b32 v252, a250
v_accvgpr_read_b32 v253, a251
v_mfma_f32_16x16x32_bf16 a[52:55], a[160:163], v[96:99], a[52:55]
v_exp_f32 v121, v33
v_mfma_f32_16x16x32_bf16 a[56:59], a[160:163], v[100:103], a[56:59]
s_waitcnt lgkmcnt(12)
v_cvt_pk_bf16_f32 v80, v120, v121
v_accvgpr_read_b32 v30, a252
v_mfma_f32_16x16x32_bf16 a[68:71], a[164:167], v[100:103], a[68:71]
v_exp_f32 v122, v34
v_mfma_f32_16x16x32_bf16 a[64:67], a[164:167], v[96:99], a[64:67]
v_exp_f32 v123, v35
v_mfma_f32_16x16x32_bf16 a[60:63], a[164:167], v[92:95], a[60:63]
s_waitcnt lgkmcnt(10)
v_cvt_pk_bf16_f32 v81, v122, v123
v_accvgpr_read_b32 v31, a253
v_mfma_f32_16x16x32_bf16 a[72:75], a[168:171], v[92:95], a[72:75]
v_exp_f32 v124, v40
v_mfma_f32_16x16x32_bf16 a[76:79], a[168:171], v[96:99], a[76:79]
v_exp_f32 v125, v41
v_mfma_f32_16x16x32_bf16 a[80:83], a[168:171], v[100:103], a[80:83]
s_waitcnt lgkmcnt(8)
v_cvt_pk_bf16_f32 v84, v124, v125
v_accvgpr_read_b32 v254, a254
v_mfma_f32_16x16x32_bf16 a[92:95], a[172:175], v[100:103], a[92:95]
v_exp_f32 v126, v42
v_mfma_f32_16x16x32_bf16 a[88:91], a[172:175], v[96:99], a[88:91]
v_exp_f32 v127, v43
v_mfma_f32_16x16x32_bf16 a[84:87], a[172:175], v[92:95], a[84:87]
v_cvt_pk_bf16_f32 v85, v126, v127
buffer_load_dword v248, v250, s[20:23], 0 offen offset:128 sc1
v_exp_f32 v128, v48
v_exp_f32 v129, v49
s_nop 0
v_cvt_pk_bf16_f32 v88, v128, v129
v_exp_f32 v120, v50
v_exp_f32 v121, v51
s_nop 0
v_cvt_pk_bf16_f32 v89, v120, v121
s_waitcnt lgkmcnt(6)
v_mfma_f32_16x16x32_bf16 a[96:99], a[176:179], v[92:95], a[96:99]
s_waitcnt vmcnt(16) lgkmcnt(0)
v_exp_f32 v122, v36
v_mfma_f32_16x16x32_bf16 a[100:103], a[176:179], v[96:99], a[100:103]
s_barrier
v_mfma_f32_16x16x32_bf16 a[104:107], a[176:179], v[100:103], a[104:107]
s_add_u32 s43, s76, 0
ds_read_b128 a[144:147], v23 offset:24576
v_mfma_f32_16x16x32_bf16 a[116:119], a[180:183], v[100:103], a[116:119]
ds_read_b128 a[148:151], v24 offset:24576
v_mfma_f32_16x16x32_bf16 a[112:115], a[180:183], v[96:99], a[112:115]
v_exp_f32 v123, v37
v_mfma_f32_16x16x32_bf16 a[108:111], a[180:183], v[92:95], a[108:111]
s_mul_i32 s43, s43, 81920
v_mfma_f32_16x16x32_bf16 a[120:123], a[184:187], v[92:95], a[120:123]
ds_read_b128 a[152:155], v23 offset:24704
v_cvt_pk_bf16_f32 v82, v122, v123
v_mfma_f32_16x16x32_bf16 a[124:127], a[184:187], v[96:99], a[124:127]
v_exp_f32 v124, v38
v_mfma_f32_16x16x32_bf16 a[128:131], a[184:187], v[100:103], a[128:131]
s_add_u32 m0, s45, 81920
v_mfma_f32_16x16x32_bf16 a[140:143], a[188:191], v[100:103], a[140:143]
ds_read_b128 a[156:159], v24 offset:24704
v_mfma_f32_16x16x32_bf16 a[136:139], a[188:191], v[96:99], a[136:139]
v_exp_f32 v125, v39
v_mfma_f32_16x16x32_bf16 a[132:135], a[188:191], v[92:95], a[132:135]
s_waitcnt lgkmcnt(3)
buffer_load_dwordx4 v11, s[24:27], s43 offen offset:0 lds
v_mfma_f32_16x16x32_bf16 v[56:59], a[144:147], v[176:179], v[104:107]
ds_read_b128 a[160:163], v23 offset:24832
v_cvt_pk_bf16_f32 v83, v124, v125
v_mfma_f32_16x16x32_bf16 v[64:67], a[144:147], v[200:203], v[108:111]
v_exp_f32 v126, v44
v_mfma_f32_16x16x32_bf16 v[72:75], a[144:147], v[224:227], v[112:115]
s_waitcnt lgkmcnt(3)
ds_read_b128 a[164:167], v24 offset:24832
v_mfma_f32_16x16x32_bf16 v[72:75], a[148:151], v[228:231], v[72:75]
buffer_load_dwordx4 v12, s[24:27], s43 offen offset:1024 lds
v_mfma_f32_16x16x32_bf16 v[64:67], a[148:151], v[204:207], v[64:67]
v_exp_f32 v127, v45
v_mfma_f32_16x16x32_bf16 v[56:59], a[148:151], v[180:183], v[56:59]
s_waitcnt lgkmcnt(3)
ds_read_b128 a[168:171], v23 offset:30720
v_cvt_pk_bf16_f32 v86, v126, v127
v_mfma_f32_16x16x32_bf16 v[56:59], a[152:155], v[184:187], v[56:59]
buffer_load_dwordx4 v13, s[24:27], s43 offen offset:2048 lds
v_mfma_f32_16x16x32_bf16 v[64:67], a[152:155], v[208:211], v[64:67]
v_exp_f32 v128, v46
v_mfma_f32_16x16x32_bf16 v[72:75], a[152:155], v[232:235], v[72:75]
s_waitcnt lgkmcnt(3)
ds_read_b128 a[172:175], v24 offset:30720
v_mfma_f32_16x16x32_bf16 v[72:75], a[156:159], v[236:239], v[72:75]
buffer_load_dwordx4 v14, s[24:27], s43 offen offset:3072 lds
v_mfma_f32_16x16x32_bf16 v[64:67], a[156:159], v[212:215], v[64:67]
v_exp_f32 v129, v47
v_mfma_f32_16x16x32_bf16 v[56:59], a[156:159], v[188:191], v[56:59]
s_waitcnt lgkmcnt(3)
ds_read_b128 a[176:179], v23 offset:30848
v_cvt_pk_bf16_f32 v87, v128, v129
v_mfma_f32_16x16x32_bf16 v[56:59], a[160:163], v[192:195], v[56:59]
s_add_u32 m0, s45, 86016
v_exp_f32 v120, v52
v_mfma_f32_16x16x32_bf16 v[64:67], a[160:163], v[216:219], v[64:67]
ds_read_b128 a[180:183], v24 offset:30848
v_mfma_f32_16x16x32_bf16 v[72:75], a[160:163], v[240:243], v[72:75]
s_waitcnt lgkmcnt(4)
buffer_load_dwordx4 v15, s[24:27], s43 offen offset:0 lds
v_mfma_f32_16x16x32_bf16 v[72:75], a[164:167], v[244:247], v[72:75]
v_exp_f32 v121, v53
v_mfma_f32_16x16x32_bf16 v[64:67], a[164:167], v[220:223], v[64:67]
ds_read_b128 a[184:187], v23 offset:30976
v_cvt_pk_bf16_f32 v90, v120, v121
v_mfma_f32_16x16x32_bf16 v[56:59], a[164:167], v[196:199], v[56:59]
s_waitcnt lgkmcnt(4)
v_mfma_f32_16x16x32_bf16 v[60:63], a[168:171], v[176:179], v[104:107]
s_add_u32 s43, s76, 1
v_exp_f32 v122, v54
v_mfma_f32_16x16x32_bf16 v[68:71], a[168:171], v[200:203], v[108:111]
ds_read_b128 a[188:191], v24 offset:30976
v_mfma_f32_16x16x32_bf16 v[76:79], a[168:171], v[224:227], v[112:115]
s_waitcnt lgkmcnt(4)
v_mfma_f32_16x16x32_bf16 v[76:79], a[172:175], v[228:231], v[76:79]
s_mul_i32 s43, s43, 81920
ds_read_b64_tr_b16 a[144:145], v25 offset:36864
ds_read_b64_tr_b16 a[146:147], v25 offset:43008
v_mfma_f32_16x16x32_bf16 v[68:71], a[172:175], v[204:207], v[68:71]
v_exp_f32 v123, v55
v_mfma_f32_16x16x32_bf16 v[60:63], a[172:175], v[180:183], v[60:63]
s_waitcnt lgkmcnt(5)
ds_read_b64_tr_b16 a[148:149], v26 offset:36864
ds_read_b64_tr_b16 a[150:151], v26 offset:43008
v_mfma_f32_16x16x32_bf16 v[60:63], a[176:179], v[184:187], v[60:63]
s_add_u32 m0, s45, 102400
v_cvt_pk_bf16_f32 v91, v122, v123
v_mfma_f32_16x16x32_bf16 v[68:71], a[176:179], v[208:211], v[68:71]
v_mfma_f32_16x16x32_bf16 v[76:79], a[176:179], v[232:235], v[76:79]
ds_read_b64_tr_b16 a[152:153], v27 offset:36864
ds_read_b64_tr_b16 a[154:155], v27 offset:43008
v_mfma_f32_16x16x32_bf16 v[144:147], a[240:243], v[80:83], v[156:159]
s_add_u32 s40, s40, 49152
buffer_load_dwordx4 v11, s[24:27], s43 offen offset:0 lds
v_mfma_f32_16x16x32_bf16 v[148:151], a[240:243], v[84:87], v[160:163]
ds_read_b64_tr_b16 a[156:157], v28 offset:36864
ds_read_b64_tr_b16 a[158:159], v28 offset:43008
v_mfma_f32_16x16x32_bf16 v[152:155], a[240:243], v[88:91], v[164:167]
s_waitcnt lgkmcnt(10)
buffer_load_dwordx4 v12, s[24:27], s43 offen offset:1024 lds
v_mfma_f32_16x16x32_bf16 v[76:79], a[180:183], v[236:239], v[76:79]
v_mfma_f32_16x16x32_bf16 v[68:71], a[180:183], v[212:215], v[68:71]
ds_read_b64_tr_b16 a[160:161], v25 offset:36992
ds_read_b64_tr_b16 a[162:163], v25 offset:43136
v_mfma_f32_16x16x32_bf16 v[60:63], a[180:183], v[188:191], v[60:63]
s_waitcnt lgkmcnt(11)
buffer_load_dwordx4 v13, s[24:27], s43 offen offset:2048 lds
v_mfma_f32_16x16x32_bf16 v[60:63], a[184:187], v[192:195], v[60:63]
ds_read_b64_tr_b16 a[164:165], v26 offset:36992
ds_read_b64_tr_b16 a[166:167], v26 offset:43136
v_mfma_f32_16x16x32_bf16 v[68:71], a[184:187], v[216:219], v[68:71]
v_max3_f32 v130, v144, v148, v152
v_cmp_nge_f32 vcc, s3, v130
v_mfma_f32_16x16x32_bf16 v[76:79], a[184:187], v[240:243], v[76:79]
s_waitcnt lgkmcnt(12)
s_cmp_ge_u32 s40, 147456
s_cselect_b32 s40, 0, s40
v_mfma_f32_16x16x32_bf16 v[76:79], a[188:191], v[244:247], v[76:79]
ds_read_b64_tr_b16 a[168:169], v27 offset:36992
ds_read_b64_tr_b16 a[170:171], v27 offset:43136
v_mfma_f32_16x16x32_bf16 v[68:71], a[188:191], v[220:223], v[68:71]
buffer_load_dwordx4 v14, s[24:27], s43 offen offset:3072 lds
v_mfma_f32_16x16x32_bf16 v[60:63], a[188:191], v[196:199], v[60:63]
s_cbranch_vccnz L_tramp_12
L_ret_11:
s_waitcnt lgkmcnt(12)
v_mfma_f32_16x16x32_bf16 a[0:3], a[144:147], v[80:83], a[0:3]
s_add_u32 m0, s45, 106496
ds_read_b64_tr_b16 a[172:173], v28 offset:36992
ds_read_b64_tr_b16 a[174:175], v28 offset:43136
v_mfma_f32_16x16x32_bf16 a[4:7], a[144:147], v[84:87], a[4:7]
v_exp_f32 v120, v56
v_mfma_f32_16x16x32_bf16 a[8:11], a[144:147], v[88:91], a[8:11]
s_waitcnt lgkmcnt(12)
ds_read_b64_tr_b16 a[176:177], v25 offset:37120
ds_read_b64_tr_b16 a[178:179], v25 offset:43264
v_mfma_f32_16x16x32_bf16 a[20:23], a[148:151], v[88:91], a[20:23]
buffer_load_dwordx4 v15, s[24:27], s43 offen offset:0 lds
v_mfma_f32_16x16x32_bf16 a[16:19], a[148:151], v[84:87], a[16:19]
v_exp_f32 v121, v57
v_mfma_f32_16x16x32_bf16 a[12:15], a[148:151], v[80:83], a[12:15]
s_waitcnt lgkmcnt(12)
ds_read_b64_tr_b16 a[180:181], v26 offset:37120
ds_read_b64_tr_b16 a[182:183], v26 offset:43264
v_mfma_f32_16x16x32_bf16 a[24:27], a[152:155], v[80:83], a[24:27]
v_cvt_pk_bf16_f32 v92, v120, v121
v_add_u32 v23, s40, v17
v_mfma_f32_16x16x32_bf16 a[28:31], a[152:155], v[84:87], a[28:31]
ds_read_b64_tr_b16 a[184:185], v27 offset:37120
ds_read_b64_tr_b16 a[186:187], v27 offset:43264
v_mfma_f32_16x16x32_bf16 a[32:35], a[152:155], v[88:91], a[32:35]
s_waitcnt lgkmcnt(14)
v_exp_f32 v122, v58
v_mfma_f32_16x16x32_bf16 a[44:47], a[156:159], v[88:91], a[44:47]
v_exp_f32 v123, v59
v_mfma_f32_16x16x32_bf16 a[40:43], a[156:159], v[84:87], a[40:43]
ds_read_b64_tr_b16 a[188:189], v28 offset:37120
ds_read_b64_tr_b16 a[190:191], v28 offset:43264
v_mfma_f32_16x16x32_bf16 a[36:39], a[156:159], v[80:83], a[36:39]
s_waitcnt lgkmcnt(14)
v_cvt_pk_bf16_f32 v93, v122, v123
v_mfma_f32_16x16x32_bf16 a[48:51], a[160:163], v[80:83], a[48:51]
v_exp_f32 v124, v64
v_mfma_f32_16x16x32_bf16 a[52:55], a[160:163], v[84:87], a[52:55]
v_exp_f32 v125, v65
v_mfma_f32_16x16x32_bf16 a[56:59], a[160:163], v[88:91], a[56:59]
s_waitcnt lgkmcnt(12)
v_cvt_pk_bf16_f32 v96, v124, v125
v_add_u32 v24, s40, v18
v_mfma_f32_16x16x32_bf16 a[68:71], a[164:167], v[88:91], a[68:71]
v_exp_f32 v126, v66
v_mfma_f32_16x16x32_bf16 a[64:67], a[164:167], v[84:87], a[64:67]
v_exp_f32 v127, v67
v_mfma_f32_16x16x32_bf16 a[60:63], a[164:167], v[80:83], a[60:63]
s_waitcnt lgkmcnt(10)
v_cvt_pk_bf16_f32 v97, v126, v127
v_mfma_f32_16x16x32_bf16 a[72:75], a[168:171], v[80:83], a[72:75]
v_exp_f32 v128, v72
v_mfma_f32_16x16x32_bf16 a[76:79], a[168:171], v[84:87], a[76:79]
v_exp_f32 v129, v73
v_mfma_f32_16x16x32_bf16 a[80:83], a[168:171], v[88:91], a[80:83]
s_waitcnt lgkmcnt(8)
v_cvt_pk_bf16_f32 v100, v128, v129
v_mfma_f32_16x16x32_bf16 a[92:95], a[172:175], v[88:91], a[92:95]
v_exp_f32 v120, v74
v_mfma_f32_16x16x32_bf16 a[88:91], a[172:175], v[84:87], a[88:91]
v_exp_f32 v121, v75
v_mfma_f32_16x16x32_bf16 a[84:87], a[172:175], v[80:83], a[84:87]
s_waitcnt lgkmcnt(6)
v_cvt_pk_bf16_f32 v101, v120, v121
v_mfma_f32_16x16x32_bf16 a[96:99], a[176:179], v[80:83], a[96:99]
s_waitcnt vmcnt(20) lgkmcnt(0)
v_exp_f32 v122, v60
v_mfma_f32_16x16x32_bf16 a[100:103], a[176:179], v[84:87], a[100:103]
s_barrier
v_add_u32 v25, s40, v19
v_mfma_f32_16x16x32_bf16 a[104:107], a[176:179], v[88:91], a[104:107]
s_add_u32 s43, s76, 2
ds_read_b128 a[144:147], v23 offset:0
v_mfma_f32_16x16x32_bf16 a[116:119], a[180:183], v[88:91], a[116:119]
ds_read_b128 a[148:151], v24 offset:0
v_mfma_f32_16x16x32_bf16 a[112:115], a[180:183], v[84:87], a[112:115]
v_exp_f32 v123, v61
v_mfma_f32_16x16x32_bf16 a[108:111], a[180:183], v[80:83], a[108:111]
s_mul_i32 s43, s43, 81920
v_cvt_pk_bf16_f32 v94, v122, v123
v_mfma_f32_16x16x32_bf16 a[120:123], a[184:187], v[80:83], a[120:123]
ds_read_b128 a[152:155], v23 offset:128
v_add_u32 v26, s40, v20
v_mfma_f32_16x16x32_bf16 a[124:127], a[184:187], v[84:87], a[124:127]
v_exp_f32 v124, v62
v_mfma_f32_16x16x32_bf16 a[128:131], a[184:187], v[88:91], a[128:131]
s_add_u32 m0, s45, 122880
v_mfma_f32_16x16x32_bf16 a[140:143], a[188:191], v[88:91], a[140:143]
ds_read_b128 a[156:159], v24 offset:128
v_mfma_f32_16x16x32_bf16 a[136:139], a[188:191], v[84:87], a[136:139]
v_exp_f32 v125, v63
v_mfma_f32_16x16x32_bf16 a[132:135], a[188:191], v[80:83], a[132:135]
s_waitcnt lgkmcnt(3)
buffer_load_dwordx4 v11, s[24:27], s43 offen offset:0 lds
v_mfma_f32_16x16x32_bf16 v[32:35], a[144:147], v[176:179], v[104:107]
ds_read_b128 a[160:163], v23 offset:256
v_add_u32 v27, s40, v21
v_mfma_f32_16x16x32_bf16 v[40:43], a[144:147], v[200:203], v[108:111]
v_exp_f32 v126, v68
v_mfma_f32_16x16x32_bf16 v[48:51], a[144:147], v[224:227], v[112:115]
s_waitcnt lgkmcnt(3)
ds_read_b128 a[164:167], v24 offset:256
v_cvt_pk_bf16_f32 v95, v124, v125
v_mfma_f32_16x16x32_bf16 v[48:51], a[148:151], v[228:231], v[48:51]
buffer_load_dwordx4 v12, s[24:27], s43 offen offset:1024 lds
v_mfma_f32_16x16x32_bf16 v[40:43], a[148:151], v[204:207], v[40:43]
v_exp_f32 v127, v69
v_mfma_f32_16x16x32_bf16 v[32:35], a[148:151], v[180:183], v[32:35]
s_waitcnt lgkmcnt(3)
ds_read_b128 a[168:171], v23 offset:6144
v_add_u32 v28, s40, v22
v_mfma_f32_16x16x32_bf16 v[32:35], a[152:155], v[184:187], v[32:35]
buffer_load_dwordx4 v13, s[24:27], s43 offen offset:2048 lds
v_mfma_f32_16x16x32_bf16 v[40:43], a[152:155], v[208:211], v[40:43]
v_exp_f32 v128, v70
v_mfma_f32_16x16x32_bf16 v[48:51], a[152:155], v[232:235], v[48:51]
s_waitcnt lgkmcnt(3)
ds_read_b128 a[172:175], v24 offset:6144
v_cvt_pk_bf16_f32 v98, v126, v127
v_mfma_f32_16x16x32_bf16 v[48:51], a[156:159], v[236:239], v[48:51]
buffer_load_dwordx4 v14, s[24:27], s43 offen offset:3072 lds
v_mfma_f32_16x16x32_bf16 v[40:43], a[156:159], v[212:215], v[40:43]
v_exp_f32 v129, v71
v_mfma_f32_16x16x32_bf16 v[32:35], a[156:159], v[188:191], v[32:35]
s_waitcnt lgkmcnt(3)
ds_read_b128 a[176:179], v23 offset:6272
v_cvt_pk_bf16_f32 v99, v128, v129
v_mfma_f32_16x16x32_bf16 v[32:35], a[160:163], v[192:195], v[32:35]
s_add_u32 m0, s45, 126976
v_exp_f32 v120, v76
v_mfma_f32_16x16x32_bf16 v[40:43], a[160:163], v[216:219], v[40:43]
ds_read_b128 a[180:183], v24 offset:6272
v_mfma_f32_16x16x32_bf16 v[48:51], a[160:163], v[240:243], v[48:51]
s_waitcnt lgkmcnt(4)
buffer_load_dwordx4 v15, s[24:27], s43 offen offset:0 lds
v_mfma_f32_16x16x32_bf16 v[48:51], a[164:167], v[244:247], v[48:51]
v_exp_f32 v121, v77
v_mfma_f32_16x16x32_bf16 v[40:43], a[164:167], v[220:223], v[40:43]
ds_read_b128 a[184:187], v23 offset:6400
v_cvt_pk_bf16_f32 v102, v120, v121
v_mfma_f32_16x16x32_bf16 v[32:35], a[164:167], v[196:199], v[32:35]
s_waitcnt lgkmcnt(4)
v_mfma_f32_16x16x32_bf16 v[36:39], a[168:171], v[176:179], v[104:107]
s_add_u32 s43, s77, 0
v_exp_f32 v122, v78
v_mfma_f32_16x16x32_bf16 v[44:47], a[168:171], v[200:203], v[108:111]
ds_read_b128 a[188:191], v24 offset:6400
v_mfma_f32_16x16x32_bf16 v[52:55], a[168:171], v[224:227], v[112:115]
s_waitcnt lgkmcnt(4)
v_mfma_f32_16x16x32_bf16 v[52:55], a[172:175], v[228:231], v[52:55]
s_mul_i32 s43, s43, 81920
ds_read_b64_tr_b16 a[144:145], v25 offset:12288
ds_read_b64_tr_b16 a[146:147], v25 offset:18432
v_mfma_f32_16x16x32_bf16 v[44:47], a[172:175], v[204:207], v[44:47]
v_exp_f32 v123, v79
v_mfma_f32_16x16x32_bf16 v[36:39], a[172:175], v[180:183], v[36:39]
s_waitcnt lgkmcnt(5)
ds_read_b64_tr_b16 a[148:149], v26 offset:12288
ds_read_b64_tr_b16 a[150:151], v26 offset:18432
v_mfma_f32_16x16x32_bf16 v[36:39], a[176:179], v[184:187], v[36:39]
s_add_u32 m0, s45, 143360
v_cvt_pk_bf16_f32 v103, v122, v123
v_mfma_f32_16x16x32_bf16 v[44:47], a[176:179], v[208:211], v[44:47]
v_mfma_f32_16x16x32_bf16 v[52:55], a[176:179], v[232:235], v[52:55]
ds_read_b64_tr_b16 a[152:153], v27 offset:12288
ds_read_b64_tr_b16 a[154:155], v27 offset:18432
v_mfma_f32_16x16x32_bf16 v[156:159], a[240:243], v[92:95], v[144:147]
buffer_load_dwordx4 v11, s[24:27], s43 offen offset:0 lds
v_mfma_f32_16x16x32_bf16 v[160:163], a[240:243], v[96:99], v[148:151]
ds_read_b64_tr_b16 a[156:157], v28 offset:12288
ds_read_b64_tr_b16 a[158:159], v28 offset:18432
v_mfma_f32_16x16x32_bf16 v[164:167], a[240:243], v[100:103], v[152:155]
s_waitcnt lgkmcnt(10)
buffer_load_dwordx4 v12, s[24:27], s43 offen offset:1024 lds
v_mfma_f32_16x16x32_bf16 v[52:55], a[180:183], v[236:239], v[52:55]
v_mfma_f32_16x16x32_bf16 v[44:47], a[180:183], v[212:215], v[44:47]
ds_read_b64_tr_b16 a[160:161], v25 offset:12416
ds_read_b64_tr_b16 a[162:163], v25 offset:18560
v_mfma_f32_16x16x32_bf16 v[36:39], a[180:183], v[188:191], v[36:39]
s_waitcnt lgkmcnt(11)
buffer_load_dwordx4 v13, s[24:27], s43 offen offset:2048 lds
v_mfma_f32_16x16x32_bf16 v[36:39], a[184:187], v[192:195], v[36:39]
ds_read_b64_tr_b16 a[164:165], v26 offset:12416
ds_read_b64_tr_b16 a[166:167], v26 offset:18560
v_mfma_f32_16x16x32_bf16 v[44:47], a[184:187], v[216:219], v[44:47]
v_max3_f32 v130, v156, v160, v164
v_cmp_nge_f32 vcc, s3, v130
v_mfma_f32_16x16x32_bf16 v[52:55], a[184:187], v[240:243], v[52:55]
s_waitcnt lgkmcnt(12)
buffer_load_dwordx4 v14, s[24:27], s43 offen offset:3072 lds
v_mfma_f32_16x16x32_bf16 v[52:55], a[188:191], v[244:247], v[52:55]
ds_read_b64_tr_b16 a[168:169], v27 offset:12416
ds_read_b64_tr_b16 a[170:171], v27 offset:18560
v_mfma_f32_16x16x32_bf16 v[44:47], a[188:191], v[220:223], v[44:47]
v_mfma_f32_16x16x32_bf16 v[36:39], a[188:191], v[196:199], v[36:39]
s_cbranch_vccnz L_tramp_14
L_ret_13:
s_waitcnt lgkmcnt(12)
v_mfma_f32_16x16x32_bf16 a[0:3], a[144:147], v[92:95], a[0:3]
s_add_u32 m0, s45, 147456
ds_read_b64_tr_b16 a[172:173], v28 offset:12416
ds_read_b64_tr_b16 a[174:175], v28 offset:18560
v_mfma_f32_16x16x32_bf16 a[4:7], a[144:147], v[96:99], a[4:7]
v_exp_f32 v120, v32
v_mfma_f32_16x16x32_bf16 a[8:11], a[144:147], v[100:103], a[8:11]
s_waitcnt lgkmcnt(12)
ds_read_b64_tr_b16 a[176:177], v25 offset:12544
ds_read_b64_tr_b16 a[178:179], v25 offset:18688
v_mfma_f32_16x16x32_bf16 a[20:23], a[148:151], v[100:103], a[20:23]
buffer_load_dwordx4 v15, s[24:27], s43 offen offset:0 lds
v_mfma_f32_16x16x32_bf16 a[16:19], a[148:151], v[96:99], a[16:19]
v_exp_f32 v121, v33
v_mfma_f32_16x16x32_bf16 a[12:15], a[148:151], v[92:95], a[12:15]
s_waitcnt lgkmcnt(12)
ds_read_b64_tr_b16 a[180:181], v26 offset:12544
ds_read_b64_tr_b16 a[182:183], v26 offset:18688
v_mfma_f32_16x16x32_bf16 a[24:27], a[152:155], v[92:95], a[24:27]
v_cvt_pk_bf16_f32 v80, v120, v121
v_mfma_f32_16x16x32_bf16 a[28:31], a[152:155], v[96:99], a[28:31]
ds_read_b64_tr_b16 a[184:185], v27 offset:12544
ds_read_b64_tr_b16 a[186:187], v27 offset:18688
v_mfma_f32_16x16x32_bf16 a[32:35], a[152:155], v[100:103], a[32:35]
s_waitcnt lgkmcnt(14)
v_exp_f32 v122, v34
v_mfma_f32_16x16x32_bf16 a[44:47], a[156:159], v[100:103], a[44:47]
v_exp_f32 v123, v35
v_mfma_f32_16x16x32_bf16 a[40:43], a[156:159], v[96:99], a[40:43]
ds_read_b64_tr_b16 a[188:189], v28 offset:12544
ds_read_b64_tr_b16 a[190:191], v28 offset:18688
v_mfma_f32_16x16x32_bf16 a[36:39], a[156:159], v[92:95], a[36:39]
s_waitcnt lgkmcnt(14)
v_cvt_pk_bf16_f32 v81, v122, v123
v_mfma_f32_16x16x32_bf16 a[48:51], a[160:163], v[92:95], a[48:51]
v_exp_f32 v124, v40
v_mfma_f32_16x16x32_bf16 a[52:55], a[160:163], v[96:99], a[52:55]
v_exp_f32 v125, v41
v_mfma_f32_16x16x32_bf16 a[56:59], a[160:163], v[100:103], a[56:59]
s_waitcnt lgkmcnt(12)
v_cvt_pk_bf16_f32 v84, v124, v125
v_mfma_f32_16x16x32_bf16 a[68:71], a[164:167], v[100:103], a[68:71]
v_exp_f32 v126, v42
v_mfma_f32_16x16x32_bf16 a[64:67], a[164:167], v[96:99], a[64:67]
v_exp_f32 v127, v43
v_mfma_f32_16x16x32_bf16 a[60:63], a[164:167], v[92:95], a[60:63]
s_waitcnt lgkmcnt(10)
v_cvt_pk_bf16_f32 v85, v126, v127
v_mfma_f32_16x16x32_bf16 a[72:75], a[168:171], v[92:95], a[72:75]
v_exp_f32 v128, v48
v_mfma_f32_16x16x32_bf16 a[76:79], a[168:171], v[96:99], a[76:79]
v_exp_f32 v129, v49
v_mfma_f32_16x16x32_bf16 a[80:83], a[168:171], v[100:103], a[80:83]
s_waitcnt lgkmcnt(8)
v_cvt_pk_bf16_f32 v88, v128, v129
v_mfma_f32_16x16x32_bf16 a[92:95], a[172:175], v[100:103], a[92:95]
v_exp_f32 v120, v50
v_mfma_f32_16x16x32_bf16 a[88:91], a[172:175], v[96:99], a[88:91]
v_exp_f32 v121, v51
v_mfma_f32_16x16x32_bf16 a[84:87], a[172:175], v[92:95], a[84:87]
s_waitcnt lgkmcnt(6)
v_cvt_pk_bf16_f32 v89, v120, v121
v_mfma_f32_16x16x32_bf16 a[96:99], a[176:179], v[92:95], a[96:99]
s_waitcnt vmcnt(24) lgkmcnt(0)
v_exp_f32 v122, v36
v_mfma_f32_16x16x32_bf16 a[100:103], a[176:179], v[96:99], a[100:103]
s_barrier
v_mfma_f32_16x16x32_bf16 a[104:107], a[176:179], v[100:103], a[104:107]
s_add_u32 s43, s78, 0
ds_read_b128 a[144:147], v23 offset:24576
v_mfma_f32_16x16x32_bf16 a[116:119], a[180:183], v[100:103], a[116:119]
ds_read_b128 a[148:151], v24 offset:24576
v_mfma_f32_16x16x32_bf16 a[112:115], a[180:183], v[96:99], a[112:115]
v_exp_f32 v123, v37
v_mfma_f32_16x16x32_bf16 a[108:111], a[180:183], v[92:95], a[108:111]
s_mul_i32 s43, s43, 81920
ds_read_b128 a[152:155], v23 offset:24704
v_cvt_pk_bf16_f32 v82, v122, v123
v_mfma_f32_16x16x32_bf16 a[120:123], a[184:187], v[92:95], a[120:123]
v_exp_f32 v124, v38
v_mfma_f32_16x16x32_bf16 a[124:127], a[184:187], v[96:99], a[124:127]
v_mfma_f32_16x16x32_bf16 a[128:131], a[184:187], v[100:103], a[128:131]
s_add_u32 m0, s45, 0
ds_read_b128 a[156:159], v24 offset:24704
v_mfma_f32_16x16x32_bf16 a[140:143], a[188:191], v[100:103], a[140:143]
v_exp_f32 v125, v39
v_mfma_f32_16x16x32_bf16 a[136:139], a[188:191], v[96:99], a[136:139]
ds_read_b128 a[160:163], v23 offset:24832
v_cvt_pk_bf16_f32 v83, v124, v125
v_mfma_f32_16x16x32_bf16 a[132:135], a[188:191], v[92:95], a[132:135]
s_waitcnt lgkmcnt(4)
buffer_load_dwordx4 v11, s[24:27], s43 offen offset:0 lds
v_mfma_f32_16x16x32_bf16 v[56:59], a[144:147], v[176:179], v[104:107]
ds_read_b128 a[164:167], v24 offset:24832
v_mfma_f32_16x16x32_bf16 v[64:67], a[144:147], v[200:203], v[108:111]
v_exp_f32 v126, v44
v_mfma_f32_16x16x32_bf16 v[72:75], a[144:147], v[224:227], v[112:115]
s_waitcnt lgkmcnt(4)
buffer_load_dwordx4 v12, s[24:27], s43 offen offset:1024 lds
v_mfma_f32_16x16x32_bf16 v[72:75], a[148:151], v[228:231], v[72:75]
ds_read_b128 a[168:171], v23 offset:30720
v_mfma_f32_16x16x32_bf16 v[64:67], a[148:151], v[204:207], v[64:67]
v_exp_f32 v127, v45
v_mfma_f32_16x16x32_bf16 v[56:59], a[148:151], v[180:183], v[56:59]
s_waitcnt lgkmcnt(4)
ds_read_b128 a[172:175], v24 offset:30720
v_cvt_pk_bf16_f32 v86, v126, v127
v_mfma_f32_16x16x32_bf16 v[56:59], a[152:155], v[184:187], v[56:59]
buffer_load_dwordx4 v13, s[24:27], s43 offen offset:2048 lds
v_mfma_f32_16x16x32_bf16 v[64:67], a[152:155], v[208:211], v[64:67]
ds_read_b128 a[176:179], v23 offset:30848
v_mfma_f32_16x16x32_bf16 v[72:75], a[152:155], v[232:235], v[72:75]
s_waitcnt lgkmcnt(5)
v_exp_f32 v128, v46
v_mfma_f32_16x16x32_bf16 v[72:75], a[156:159], v[236:239], v[72:75]
buffer_load_dwordx4 v14, s[24:27], s43 offen offset:3072 lds
v_mfma_f32_16x16x32_bf16 v[64:67], a[156:159], v[212:215], v[64:67]
ds_read_b128 a[180:183], v24 offset:30848
v_mfma_f32_16x16x32_bf16 v[56:59], a[156:159], v[188:191], v[56:59]
s_waitcnt lgkmcnt(5)
v_exp_f32 v129, v47
v_mfma_f32_16x16x32_bf16 v[56:59], a[160:163], v[192:195], v[56:59]
s_add_u32 m0, s45, 4096
ds_read_b128 a[184:187], v23 offset:30976
v_cvt_pk_bf16_f32 v87, v128, v129
v_mfma_f32_16x16x32_bf16 v[64:67], a[160:163], v[216:219], v[64:67]
v_exp_f32 v120, v52
v_mfma_f32_16x16x32_bf16 v[72:75], a[160:163], v[240:243], v[72:75]
s_waitcnt lgkmcnt(5)
ds_read_b128 a[188:191], v24 offset:30976
v_mfma_f32_16x16x32_bf16 v[72:75], a[164:167], v[244:247], v[72:75]
buffer_load_dwordx4 v15, s[24:27], s43 offen offset:0 lds
v_mfma_f32_16x16x32_bf16 v[64:67], a[164:167], v[220:223], v[64:67]
ds_read_b64_tr_b16 a[144:145], v25 offset:36864
ds_read_b64_tr_b16 a[146:147], v25 offset:43008
v_mfma_f32_16x16x32_bf16 v[56:59], a[164:167], v[196:199], v[56:59]
s_waitcnt lgkmcnt(7)
v_exp_f32 v121, v53
v_mfma_f32_16x16x32_bf16 v[60:63], a[168:171], v[176:179], v[104:107]
ds_read_b64_tr_b16 a[148:149], v26 offset:36864
ds_read_b64_tr_b16 a[150:151], v26 offset:43008
v_mfma_f32_16x16x32_bf16 v[68:71], a[168:171], v[200:203], v[108:111]
v_cvt_pk_bf16_f32 v90, v120, v121
v_mfma_f32_16x16x32_bf16 v[76:79], a[168:171], v[224:227], v[112:115]
s_waitcnt lgkmcnt(8)
ds_read_b64_tr_b16 a[152:153], v27 offset:36864
ds_read_b64_tr_b16 a[154:155], v27 offset:43008
v_mfma_f32_16x16x32_bf16 v[76:79], a[172:175], v[228:231], v[76:79]
v_exp_f32 v122, v54
v_mfma_f32_16x16x32_bf16 v[68:71], a[172:175], v[204:207], v[68:71]
v_exp_f32 v123, v55
v_mfma_f32_16x16x32_bf16 v[60:63], a[172:175], v[180:183], v[60:63]
s_waitcnt lgkmcnt(9)
ds_read_b64_tr_b16 a[156:157], v28 offset:36864
ds_read_b64_tr_b16 a[158:159], v28 offset:43008
v_mfma_f32_16x16x32_bf16 v[60:63], a[176:179], v[184:187], v[60:63]
v_cvt_pk_bf16_f32 v91, v122, v123
v_mfma_f32_16x16x32_bf16 v[68:71], a[176:179], v[208:211], v[68:71]
ds_read_b64_tr_b16 a[160:161], v25 offset:36992
ds_read_b64_tr_b16 a[162:163], v25 offset:43136
v_mfma_f32_16x16x32_bf16 v[76:79], a[176:179], v[232:235], v[76:79]
v_mfma_f32_16x16x32_bf16 v[144:147], a[240:243], v[80:83], v[156:159]
ds_read_b64_tr_b16 a[164:165], v26 offset:36992
ds_read_b64_tr_b16 a[166:167], v26 offset:43136
v_mfma_f32_16x16x32_bf16 v[148:151], a[240:243], v[84:87], v[160:163]
v_mfma_f32_16x16x32_bf16 v[152:155], a[240:243], v[88:91], v[164:167]
s_waitcnt lgkmcnt(14)
v_mfma_f32_16x16x32_bf16 v[76:79], a[180:183], v[236:239], v[76:79]
ds_read_b64_tr_b16 a[168:169], v27 offset:36992
ds_read_b64_tr_b16 a[170:171], v27 offset:43136
v_mfma_f32_16x16x32_bf16 v[68:71], a[180:183], v[212:215], v[68:71]
v_mfma_f32_16x16x32_bf16 v[60:63], a[180:183], v[188:191], v[60:63]
s_waitcnt lgkmcnt(15)
ds_read_b64_tr_b16 a[172:173], v28 offset:36992
ds_read_b64_tr_b16 a[174:175], v28 offset:43136
v_mfma_f32_16x16x32_bf16 v[60:63], a[184:187], v[192:195], v[60:63]
v_max3_f32 v130, v144, v148, v152
v_cmp_nge_f32 vcc, s3, v130
v_mfma_f32_16x16x32_bf16 v[68:71], a[184:187], v[216:219], v[68:71]
ds_read_b64_tr_b16 a[176:177], v25 offset:37120
ds_read_b64_tr_b16 a[178:179], v25 offset:43264
v_mfma_f32_16x16x32_bf16 v[76:79], a[184:187], v[240:243], v[76:79]
s_waitcnt lgkmcnt(15)
v_mfma_f32_16x16x32_bf16 v[76:79], a[188:191], v[244:247], v[76:79]
v_mfma_f32_16x16x32_bf16 v[68:71], a[188:191], v[220:223], v[68:71]
ds_read_b64_tr_b16 a[180:181], v26 offset:37120
ds_read_b64_tr_b16 a[182:183], v26 offset:43264
v_mfma_f32_16x16x32_bf16 v[60:63], a[188:191], v[196:199], v[60:63]
s_cbranch_vccnz L_tramp_16
L_ret_15:
v_mfma_f32_16x16x32_bf16 a[0:3], a[144:147], v[80:83], a[0:3]
s_add_u32 s40, s40, 49152
ds_read_b64_tr_b16 a[184:185], v27 offset:37120
ds_read_b64_tr_b16 a[186:187], v27 offset:43264
v_mfma_f32_16x16x32_bf16 a[4:7], a[144:147], v[84:87], a[4:7]
v_exp_f32 v120, v56
v_mfma_f32_16x16x32_bf16 a[8:11], a[144:147], v[88:91], a[8:11]
s_waitcnt lgkmcnt(15)
ds_read_b64_tr_b16 a[188:189], v28 offset:37120
ds_read_b64_tr_b16 a[190:191], v28 offset:43264
v_mfma_f32_16x16x32_bf16 a[20:23], a[148:151], v[88:91], a[20:23]
v_exp_f32 v121, v57
v_mfma_f32_16x16x32_bf16 a[16:19], a[148:151], v[84:87], a[16:19]
v_exp_f32 v122, v58
v_mfma_f32_16x16x32_bf16 a[12:15], a[148:151], v[80:83], a[12:15]
v_cvt_pk_bf16_f32 v92, v120, v121
v_mfma_f32_16x16x32_bf16 a[24:27], a[152:155], v[80:83], a[24:27]
v_exp_f32 v123, v59
v_mfma_f32_16x16x32_bf16 a[28:31], a[152:155], v[84:87], a[28:31]
s_cmp_ge_u32 s40, 147456
s_cselect_b32 s40, 0, s40
v_cvt_pk_bf16_f32 v93, v122, v123
v_mfma_f32_16x16x32_bf16 a[32:35], a[152:155], v[88:91], a[32:35]
s_waitcnt lgkmcnt(15)
v_exp_f32 v124, v64
v_mfma_f32_16x16x32_bf16 a[44:47], a[156:159], v[88:91], a[44:47]
v_exp_f32 v125, v65
v_mfma_f32_16x16x32_bf16 a[40:43], a[156:159], v[84:87], a[40:43]
v_exp_f32 v126, v66
v_mfma_f32_16x16x32_bf16 a[36:39], a[156:159], v[80:83], a[36:39]
s_waitcnt lgkmcnt(14)
v_cvt_pk_bf16_f32 v96, v124, v125
v_add_u32 v25, s40, v19
v_mfma_f32_16x16x32_bf16 a[48:51], a[160:163], v[80:83], a[48:51]
v_exp_f32 v127, v67
v_mfma_f32_16x16x32_bf16 a[52:55], a[160:163], v[84:87], a[52:55]
v_cvt_pk_bf16_f32 v97, v126, v127
v_add_u32 v26, s40, v20
v_mfma_f32_16x16x32_bf16 a[56:59], a[160:163], v[88:91], a[56:59]
s_waitcnt lgkmcnt(12)
v_exp_f32 v128, v72
v_mfma_f32_16x16x32_bf16 a[68:71], a[164:167], v[88:91], a[68:71]
v_exp_f32 v129, v73
v_mfma_f32_16x16x32_bf16 a[64:67], a[164:167], v[84:87], a[64:67]
v_exp_f32 v120, v74
v_mfma_f32_16x16x32_bf16 a[60:63], a[164:167], v[80:83], a[60:63]
s_waitcnt lgkmcnt(10)
v_cvt_pk_bf16_f32 v100, v128, v129
v_add_u32 v27, s40, v21
v_mfma_f32_16x16x32_bf16 a[72:75], a[168:171], v[80:83], a[72:75]
v_exp_f32 v121, v75
v_mfma_f32_16x16x32_bf16 a[76:79], a[168:171], v[84:87], a[76:79]
v_exp_f32 v122, v60
v_mfma_f32_16x16x32_bf16 a[80:83], a[168:171], v[88:91], a[80:83]
s_waitcnt lgkmcnt(8)
v_cvt_pk_bf16_f32 v101, v120, v121
v_add_u32 v28, s40, v22
v_mfma_f32_16x16x32_bf16 a[92:95], a[172:175], v[88:91], a[92:95]
v_exp_f32 v123, v61
v_mfma_f32_16x16x32_bf16 a[88:91], a[172:175], v[84:87], a[88:91]
v_exp_f32 v124, v62
v_mfma_f32_16x16x32_bf16 a[84:87], a[172:175], v[80:83], a[84:87]
s_waitcnt lgkmcnt(6)
v_cvt_pk_bf16_f32 v94, v122, v123
v_exp_f32 v125, v63
v_exp_f32 v126, v68
v_cvt_pk_bf16_f32 v95, v124, v125
v_exp_f32 v127, v69
s_nop 0
v_cvt_pk_bf16_f32 v98, v126, v127
v_mfma_f32_16x16x32_bf16 a[96:99], a[176:179], v[80:83], a[96:99]
s_waitcnt vmcnt(20)
s_waitcnt vmcnt(26) lgkmcnt(0)
v_mfma_f32_16x16x32_bf16 a[100:103], a[176:179], v[84:87], a[100:103]
s_barrier
v_mfma_f32_16x16x32_bf16 a[104:107], a[176:179], v[88:91], a[104:107]
ds_read_b64_tr_b16 a[144:145], v25 offset:12288
ds_read_b64_tr_b16 a[146:147], v25 offset:18432
v_mfma_f32_16x16x32_bf16 a[116:119], a[180:183], v[88:91], a[116:119]
ds_read_b64_tr_b16 a[148:149], v26 offset:12288
ds_read_b64_tr_b16 a[150:151], v26 offset:18432
v_mfma_f32_16x16x32_bf16 a[112:115], a[180:183], v[84:87], a[112:115]
s_add_u32 s43, s79, 0
v_exp_f32 v128, v70
v_mfma_f32_16x16x32_bf16 a[108:111], a[180:183], v[80:83], a[108:111]
ds_read_b64_tr_b16 a[152:153], v27 offset:12288
ds_read_b64_tr_b16 a[154:155], v27 offset:18432
v_exp_f32 v129, v71
v_exp_f32 v120, v76
v_cvt_pk_bf16_f32 v99, v128, v129
v_exp_f32 v121, v77
v_exp_f32 v122, v78
v_cvt_pk_bf16_f32 v102, v120, v121
v_exp_f32 v123, v79
s_nop 0
v_cvt_pk_bf16_f32 v103, v122, v123
v_mfma_f32_16x16x32_bf16 v[156:159], a[240:243], v[92:95], v[144:147]
s_mul_i32 s43, s43, 81920
s_add_u32 m0, s45, 20480
v_add_u32 v23, 81920, v252
v_mfma_f32_16x16x32_bf16 v[160:163], a[240:243], v[96:99], v[148:151]
buffer_load_dwordx4 v11, s[24:27], s43 offen offset:0 lds
v_mfma_f32_16x16x32_bf16 v[164:167], a[240:243], v[100:103], v[152:155]
ds_read_b64_tr_b16 a[156:157], v28 offset:12288
ds_read_b64_tr_b16 a[158:159], v28 offset:18432
v_mfma_f32_16x16x32_bf16 a[120:123], a[184:187], v[80:83], a[120:123]
v_add_u32 v24, 81920, v253
v_mfma_f32_16x16x32_bf16 a[124:127], a[184:187], v[84:87], a[124:127]
ds_read_b64_tr_b16 a[160:161], v25 offset:12416
ds_read_b64_tr_b16 a[162:163], v25 offset:18560
v_mfma_f32_16x16x32_bf16 a[128:131], a[184:187], v[88:91], a[128:131]
v_max3_f32 v130, v156, v160, v164
v_cmp_nge_f32 vcc, s3, v130
v_mfma_f32_16x16x32_bf16 a[140:143], a[188:191], v[88:91], a[140:143]
buffer_load_dwordx4 v12, s[24:27], s43 offen offset:1024 lds
v_mfma_f32_16x16x32_bf16 a[136:139], a[188:191], v[84:87], a[136:139]
ds_read_b64_tr_b16 a[164:165], v26 offset:12416
ds_read_b64_tr_b16 a[166:167], v26 offset:18560
v_mfma_f32_16x16x32_bf16 a[132:135], a[188:191], v[80:83], a[132:135]
buffer_load_dwordx4 v13, s[24:27], s43 offen offset:2048 lds
s_cbranch_vccnz L_tramp_18
L_ret_17:
s_waitcnt lgkmcnt(10)
v_mfma_f32_16x16x32_bf16 a[0:3], a[144:147], v[92:95], a[0:3]
s_mul_i32 s38, s36, 73728
ds_read_b64_tr_b16 a[168:169], v27 offset:12416
ds_read_b64_tr_b16 a[170:171], v27 offset:18560
v_mfma_f32_16x16x32_bf16 a[4:7], a[144:147], v[96:99], a[4:7]
s_mul_i32 s41, s35, 15360
v_mov_b32 v6, s92
v_mov_b32 v7, s93
v_mfma_f32_16x16x32_bf16 a[8:11], a[144:147], v[100:103], a[8:11]
s_waitcnt lgkmcnt(10)
ds_read_b64_tr_b16 a[172:173], v28 offset:12416
ds_read_b64_tr_b16 a[174:175], v28 offset:18560
v_mfma_f32_16x16x32_bf16 a[20:23], a[148:151], v[100:103], a[20:23]
buffer_load_dwordx4 v14, s[24:27], s43 offen offset:3072 lds
v_mfma_f32_16x16x32_bf16 a[16:19], a[148:151], v[96:99], a[16:19]
s_add_u32 m0, s45, 24576
v_rcp_f32 v1, v156
v_mfma_f32_16x16x32_bf16 a[12:15], a[148:151], v[92:95], a[12:15]
s_waitcnt lgkmcnt(10)
ds_read_b64_tr_b16 a[176:177], v25 offset:12544
ds_read_b64_tr_b16 a[178:179], v25 offset:18688
v_mfma_f32_16x16x32_bf16 a[24:27], a[152:155], v[92:95], a[24:27]
buffer_load_dwordx4 v15, s[24:27], s43 offen offset:0 lds
v_mfma_f32_16x16x32_bf16 a[28:31], a[152:155], v[96:99], a[28:31]
ds_read_b64_tr_b16 a[180:181], v26 offset:12544
ds_read_b64_tr_b16 a[182:183], v26 offset:18688
v_mfma_f32_16x16x32_bf16 a[32:35], a[152:155], v[100:103], a[32:35]
s_waitcnt lgkmcnt(12)
v_rcp_f32 v10, v160
v_mfma_f32_16x16x32_bf16 a[44:47], a[156:159], v[100:103], a[44:47]
s_add_u32 s44, s38, 0
v_rcp_f32 v249, v164
v_mfma_f32_16x16x32_bf16 a[40:43], a[156:159], v[96:99], a[40:43]
ds_read_b64_tr_b16 a[184:185], v27 offset:12544
ds_read_b64_tr_b16 a[186:187], v27 offset:18688
v_mfma_f32_16x16x32_bf16 a[36:39], a[156:159], v[92:95], a[36:39]
s_waitcnt lgkmcnt(12)
v_accvgpr_read_b32 v32, a0
v_accvgpr_read_b32 v33, a1
v_mfma_f32_16x16x32_bf16 a[48:51], a[160:163], v[92:95], a[48:51]
ds_read_b64_tr_b16 a[188:189], v28 offset:12544
ds_read_b64_tr_b16 a[190:191], v28 offset:18688
v_mfma_f32_16x16x32_bf16 a[52:55], a[160:163], v[96:99], a[52:55]
v_accvgpr_read_b32 v34, a2
v_accvgpr_read_b32 v35, a3
v_accvgpr_read_b32 v36, a12
v_accvgpr_read_b32 v37, a13
v_accvgpr_read_b32 v38, a14
v_accvgpr_read_b32 v39, a15
v_mul_f32 v32, v32, v1
v_mul_f32 v33, v33, v1
v_mul_f32 v34, v34, v1
v_mul_f32 v35, v35, v1
v_mul_f32 v36, v36, v1
v_mul_f32 v37, v37, v1
v_mul_f32 v38, v38, v1
v_mul_f32 v39, v39, v1
v_cvt_pk_bf16_f32 v176, v32, v33
v_cvt_pk_bf16_f32 v177, v34, v35
v_cvt_pk_bf16_f32 v178, v36, v37
v_cvt_pk_bf16_f32 v179, v38, v39
v_mfma_f32_16x16x32_bf16 a[56:59], a[160:163], v[100:103], a[56:59]
s_waitcnt lgkmcnt(12)
buffer_store_dwordx4 v[176:179], v30, s[20:23], s44 offen offset:0 sc1
v_mfma_f32_16x16x32_bf16 a[68:71], a[164:167], v[100:103], a[68:71]
v_accvgpr_read_b32 v40, a4
v_accvgpr_read_b32 v41, a5
v_mfma_f32_16x16x32_bf16 a[64:67], a[164:167], v[96:99], a[64:67]
v_accvgpr_read_b32 v42, a6
v_accvgpr_read_b32 v43, a7
v_mfma_f32_16x16x32_bf16 a[60:63], a[164:167], v[92:95], a[60:63]
v_accvgpr_read_b32 v44, a16
v_accvgpr_read_b32 v45, a17
v_accvgpr_read_b32 v46, a18
v_accvgpr_read_b32 v47, a19
v_mul_f32 v40, v40, v10
v_mul_f32 v41, v41, v10
v_mul_f32 v42, v42, v10
v_mul_f32 v43, v43, v10
v_mul_f32 v44, v44, v10
v_mul_f32 v45, v45, v10
v_mul_f32 v46, v46, v10
v_mul_f32 v47, v47, v10
v_cvt_pk_bf16_f32 v180, v40, v41
v_cvt_pk_bf16_f32 v181, v42, v43
v_cvt_pk_bf16_f32 v182, v44, v45
v_cvt_pk_bf16_f32 v183, v46, v47
s_waitcnt lgkmcnt(10)
v_mfma_f32_16x16x32_bf16 a[72:75], a[168:171], v[92:95], a[72:75]
v_accvgpr_read_b32 v48, a8
v_accvgpr_read_b32 v49, a9
buffer_store_dwordx4 v[180:183], v30, s[20:23], s44 offen offset:1024 sc1
v_mfma_f32_16x16x32_bf16 a[76:79], a[168:171], v[96:99], a[76:79]
v_accvgpr_read_b32 v50, a10
v_accvgpr_read_b32 v51, a11
v_mfma_f32_16x16x32_bf16 a[80:83], a[168:171], v[100:103], a[80:83]
s_waitcnt lgkmcnt(8)
v_accvgpr_read_b32 v52, a20
v_accvgpr_read_b32 v53, a21
v_mfma_f32_16x16x32_bf16 a[92:95], a[172:175], v[100:103], a[92:95]
v_accvgpr_read_b32 v54, a22
v_accvgpr_read_b32 v55, a23
v_mul_f32 v48, v48, v249
v_mul_f32 v49, v49, v249
v_mul_f32 v50, v50, v249
v_mul_f32 v51, v51, v249
v_mul_f32 v52, v52, v249
v_mul_f32 v53, v53, v249
v_mul_f32 v54, v54, v249
v_mul_f32 v55, v55, v249
v_cvt_pk_bf16_f32 v184, v48, v49
v_cvt_pk_bf16_f32 v185, v50, v51
v_cvt_pk_bf16_f32 v186, v52, v53
v_cvt_pk_bf16_f32 v187, v54, v55
v_mfma_f32_16x16x32_bf16 a[88:91], a[172:175], v[96:99], a[88:91]
buffer_store_dwordx4 v[184:187], v30, s[20:23], s44 offen offset:2048 sc1
v_mfma_f32_16x16x32_bf16 a[84:87], a[172:175], v[92:95], a[84:87]
s_waitcnt lgkmcnt(6)
v_accvgpr_read_b32 v32, a24
v_accvgpr_read_b32 v33, a25
v_mfma_f32_16x16x32_bf16 a[96:99], a[176:179], v[92:95], a[96:99]
s_add_u32 s44, s38, 12288
v_accvgpr_read_b32 v34, a26
v_accvgpr_read_b32 v35, a27
v_accvgpr_read_b32 v36, a36
v_mfma_f32_16x16x32_bf16 a[100:103], a[176:179], v[96:99], a[100:103]
ds_read_b64_tr_b16 a[144:145], v23 offset:0
ds_read_b64_tr_b16 a[146:147], v23 offset:5120
v_accvgpr_read_b32 v37, a37
v_accvgpr_read_b32 v38, a38
v_accvgpr_read_b32 v39, a39
v_mul_f32 v32, v32, v1
v_mul_f32 v33, v33, v1
v_mul_f32 v34, v34, v1
v_mul_f32 v35, v35, v1
v_mul_f32 v36, v36, v1
v_mul_f32 v37, v37, v1
v_mul_f32 v38, v38, v1
v_mul_f32 v39, v39, v1
v_cvt_pk_bf16_f32 v188, v32, v33
v_cvt_pk_bf16_f32 v189, v34, v35
v_cvt_pk_bf16_f32 v190, v36, v37
v_cvt_pk_bf16_f32 v191, v38, v39
v_mfma_f32_16x16x32_bf16 a[104:107], a[176:179], v[100:103], a[104:107]
s_waitcnt lgkmcnt(6)
buffer_store_dwordx4 v[188:191], v30, s[20:23], s44 offen offset:0 sc1
v_mfma_f32_16x16x32_bf16 a[116:119], a[180:183], v[100:103], a[116:119]
ds_read_b64_tr_b16 a[148:149], v24 offset:32
ds_read_b64_tr_b16 a[150:151], v24 offset:5152
v_mfma_f32_16x16x32_bf16 a[112:115], a[180:183], v[96:99], a[112:115]
v_accvgpr_read_b32 v40, a28
v_accvgpr_read_b32 v41, a29
v_mfma_f32_16x16x32_bf16 a[108:111], a[180:183], v[92:95], a[108:111]
v_accvgpr_read_b32 v42, a30
v_accvgpr_read_b32 v43, a31
v_accvgpr_read_b32 v44, a40
v_accvgpr_read_b32 v45, a41
v_accvgpr_read_b32 v46, a42
v_accvgpr_read_b32 v47, a43
v_mul_f32 v40, v40, v10
v_mul_f32 v41, v41, v10
v_mul_f32 v42, v42, v10
v_mul_f32 v43, v43, v10
v_mul_f32 v44, v44, v10
v_mul_f32 v45, v45, v10
v_mul_f32 v46, v46, v10
v_mul_f32 v47, v47, v10
v_cvt_pk_bf16_f32 v192, v40, v41
v_cvt_pk_bf16_f32 v193, v42, v43
v_cvt_pk_bf16_f32 v194, v44, v45
v_cvt_pk_bf16_f32 v195, v46, v47
s_waitcnt lgkmcnt(6)
v_mfma_f32_16x16x32_bf16 a[120:123], a[184:187], v[92:95], a[120:123]
ds_read_b64_tr_b16 a[152:153], v23 offset:64
ds_read_b64_tr_b16 a[154:155], v23 offset:5184
buffer_store_dwordx4 v[192:195], v30, s[20:23], s44 offen offset:1024 sc1
v_mfma_f32_16x16x32_bf16 a[124:127], a[184:187], v[96:99], a[124:127]
v_accvgpr_read_b32 v48, a32
v_accvgpr_read_b32 v49, a33
v_mfma_f32_16x16x32_bf16 a[128:131], a[184:187], v[100:103], a[128:131]
s_waitcnt lgkmcnt(6)
v_accvgpr_read_b32 v50, a34
v_accvgpr_read_b32 v51, a35
v_accvgpr_read_b32 v52, a44
v_mfma_f32_16x16x32_bf16 a[140:143], a[188:191], v[100:103], a[140:143]
ds_read_b64_tr_b16 a[156:157], v24 offset:96
ds_read_b64_tr_b16 a[158:159], v24 offset:5216
v_accvgpr_read_b32 v53, a45
v_accvgpr_read_b32 v54, a46
v_accvgpr_read_b32 v55, a47
v_mul_f32 v48, v48, v249
v_mul_f32 v49, v49, v249
v_mul_f32 v50, v50, v249
v_mul_f32 v51, v51, v249
v_mul_f32 v52, v52, v249
v_mul_f32 v53, v53, v249
v_mul_f32 v54, v54, v249
v_mul_f32 v55, v55, v249
v_cvt_pk_bf16_f32 v196, v48, v49
v_cvt_pk_bf16_f32 v197, v50, v51
v_cvt_pk_bf16_f32 v198, v52, v53
v_cvt_pk_bf16_f32 v199, v54, v55
v_mfma_f32_16x16x32_bf16 a[136:139], a[188:191], v[96:99], a[136:139]
buffer_store_dwordx4 v[196:199], v30, s[20:23], s44 offen offset:2048 sc1
v_mfma_f32_16x16x32_bf16 a[132:135], a[188:191], v[92:95], a[132:135]
s_waitcnt lgkmcnt(6)
ds_read_b64_tr_b16 a[160:161], v23 offset:128
ds_read_b64_tr_b16 a[162:163], v23 offset:5248
v_mfma_f32_16x16x32_bf16 v[64:67], a[144:147], v[184:187], 0
s_add_u32 s43, s77, 1
v_accvgpr_read_b32 v32, a48
v_accvgpr_read_b32 v33, a49
v_mfma_f32_16x16x32_bf16 v[60:63], a[144:147], v[180:183], 0
v_accvgpr_read_b32 v34, a50
v_accvgpr_read_b32 v35, a51
v_mfma_f32_16x16x32_bf16 v[56:59], a[144:147], v[176:179], 0
s_waitcnt lgkmcnt(6)
ds_read_b64_tr_b16 a[164:165], v24 offset:160
ds_read_b64_tr_b16 a[166:167], v24 offset:5280
v_mfma_f32_16x16x32_bf16 v[68:71], a[148:151], v[176:179], 0
s_mul_i32 s43, s43, 81920
v_add_u32 v20, 102400, v252
v_accvgpr_read_b32 v36, a60
v_mfma_f32_16x16x32_bf16 v[72:75], a[148:151], v[180:183], 0
s_add_u32 m0, s45, 40960
v_accvgpr_read_b32 v37, a61
v_accvgpr_read_b32 v38, a62
v_mfma_f32_16x16x32_bf16 v[76:79], a[148:151], v[184:187], 0
s_waitcnt lgkmcnt(6)
ds_read_b64_tr_b16 a[168:169], v23 offset:192
ds_read_b64_tr_b16 a[170:171], v23 offset:5312
v_mfma_f32_16x16x32_bf16 v[88:91], a[152:155], v[184:187], 0
buffer_load_dwordx4 v11, s[24:27], s43 offen offset:0 lds
v_mfma_f32_16x16x32_bf16 v[84:87], a[152:155], v[180:183], 0
ds_read_b64_tr_b16 a[172:173], v24 offset:224
ds_read_b64_tr_b16 a[174:175], v24 offset:5344
v_mfma_f32_16x16x32_bf16 v[80:83], a[152:155], v[176:179], 0
s_waitcnt lgkmcnt(8)
buffer_load_dwordx4 v12, s[24:27], s43 offen offset:1024 lds
v_mfma_f32_16x16x32_bf16 v[92:95], a[156:159], v[176:179], 0
v_accvgpr_read_b32 v39, a63
v_mul_f32 v32, v32, v1
v_mfma_f32_16x16x32_bf16 v[96:99], a[156:159], v[180:183], 0
ds_read_b64_tr_b16 a[176:177], v23 offset:256
ds_read_b64_tr_b16 a[178:179], v23 offset:5376
v_mfma_f32_16x16x32_bf16 v[100:103], a[156:159], v[184:187], 0
s_waitcnt lgkmcnt(8)
v_add_u32 v21, 102400, v253
v_mul_f32 v33, v33, v1
v_mfma_f32_16x16x32_bf16 v[112:115], a[160:163], v[184:187], 0
buffer_load_dwordx4 v13, s[24:27], s43 offen offset:2048 lds
v_mfma_f32_16x16x32_bf16 v[108:111], a[160:163], v[180:183], 0
ds_read_b64_tr_b16 a[180:181], v24 offset:288
ds_read_b64_tr_b16 a[182:183], v24 offset:5408
v_mfma_f32_16x16x32_bf16 v[104:107], a[160:163], v[176:179], 0
s_waitcnt lgkmcnt(8)
buffer_load_dwordx4 v14, s[24:27], s43 offen offset:3072 lds
v_mfma_f32_16x16x32_bf16 v[116:119], a[164:167], v[176:179], 0
s_add_u32 m0, s45, 45056
v_mul_f32 v34, v34, v1
v_mul_f32 v35, v35, v1
v_mfma_f32_16x16x32_bf16 v[120:123], a[164:167], v[180:183], 0
ds_read_b64_tr_b16 a[184:185], v23 offset:10240
ds_read_b64_tr_b16 a[186:187], v23 offset:15360
v_mfma_f32_16x16x32_bf16 v[124:127], a[164:167], v[184:187], 0
s_waitcnt lgkmcnt(8)
buffer_load_dwordx4 v15, s[24:27], s43 offen offset:0 lds
v_mfma_f32_16x16x32_bf16 v[136:139], a[168:171], v[184:187], 0
ds_read_b64_tr_b16 a[188:189], v24 offset:10272
ds_read_b64_tr_b16 a[190:191], v24 offset:15392
v_mfma_f32_16x16x32_bf16 v[132:135], a[168:171], v[180:183], 0
v_mul_f32 v36, v36, v1
v_mul_f32 v37, v37, v1
v_mfma_f32_16x16x32_bf16 v[128:131], a[168:171], v[176:179], 0
s_waitcnt lgkmcnt(8)
v_mul_f32 v38, v38, v1
v_mul_f32 v39, v39, v1
v_mfma_f32_16x16x32_bf16 v[140:143], a[172:175], v[176:179], 0
ds_read_b64_tr_b16 a[144:145], v23 offset:10304
ds_read_b64_tr_b16 a[146:147], v23 offset:15424
v_mfma_f32_16x16x32_bf16 v[144:147], a[172:175], v[180:183], 0
v_cvt_pk_bf16_f32 v200, v32, v33
v_cvt_pk_bf16_f32 v201, v34, v35
v_mfma_f32_16x16x32_bf16 v[148:151], a[172:175], v[184:187], 0
s_waitcnt lgkmcnt(8)
v_cvt_pk_bf16_f32 v202, v36, v37
v_cvt_pk_bf16_f32 v203, v38, v39
v_mfma_f32_16x16x32_bf16 v[160:163], a[176:179], v[184:187], 0
ds_read_b64_tr_b16 a[148:149], v24 offset:10336
ds_read_b64_tr_b16 a[150:151], v24 offset:15456
v_mfma_f32_16x16x32_bf16 v[156:159], a[176:179], v[180:183], 0
v_accvgpr_read_b32 v40, a52
v_accvgpr_read_b32 v41, a53
v_mfma_f32_16x16x32_bf16 v[152:155], a[176:179], v[176:179], 0
s_waitcnt lgkmcnt(8)
ds_read_b64_tr_b16 a[152:153], v23 offset:10368
ds_read_b64_tr_b16 a[154:155], v23 offset:15488
v_mfma_f32_16x16x32_bf16 v[164:167], a[180:183], v[176:179], 0
v_accvgpr_read_b32 v42, a54
v_accvgpr_read_b32 v43, a55
v_mfma_f32_16x16x32_bf16 v[168:171], a[180:183], v[180:183], 0
v_accvgpr_read_b32 v44, a64
v_accvgpr_read_b32 v45, a65
v_mfma_f32_16x16x32_bf16 v[172:175], a[180:183], v[184:187], 0
s_waitcnt lgkmcnt(8)
ds_read_b64_tr_b16 a[156:157], v24 offset:10400
ds_read_b64_tr_b16 a[158:159], v24 offset:15520
v_mfma_f32_16x16x32_bf16 v[64:67], a[184:187], v[196:199], v[64:67]
v_accvgpr_read_b32 v46, a66
v_accvgpr_read_b32 v47, a67
v_mfma_f32_16x16x32_bf16 v[60:63], a[184:187], v[192:195], v[60:63]
v_mul_f32 v40, v40, v10
v_mul_f32 v41, v41, v10
v_mfma_f32_16x16x32_bf16 v[56:59], a[184:187], v[188:191], v[56:59]
s_waitcnt lgkmcnt(8)
ds_read_b64_tr_b16 a[160:161], v23 offset:10432
ds_read_b64_tr_b16 a[162:163], v23 offset:15552
v_mfma_f32_16x16x32_bf16 v[68:71], a[188:191], v[188:191], v[68:71]
v_mul_f32 v42, v42, v10
v_mul_f32 v43, v43, v10
v_mfma_f32_16x16x32_bf16 v[72:75], a[188:191], v[192:195], v[72:75]
ds_read_b64_tr_b16 a[164:165], v24 offset:10464
ds_read_b64_tr_b16 a[166:167], v24 offset:15584
v_mfma_f32_16x16x32_bf16 v[76:79], a[188:191], v[196:199], v[76:79]
s_waitcnt lgkmcnt(10)
v_mul_f32 v44, v44, v10
v_mul_f32 v45, v45, v10
v_mfma_f32_16x16x32_bf16 v[88:91], a[144:147], v[196:199], v[88:91]
v_mul_f32 v46, v46, v10
v_mul_f32 v47, v47, v10
v_mfma_f32_16x16x32_bf16 v[84:87], a[144:147], v[192:195], v[84:87]
ds_read_b64_tr_b16 a[168:169], v23 offset:10496
ds_read_b64_tr_b16 a[170:171], v23 offset:15616
v_mfma_f32_16x16x32_bf16 v[80:83], a[144:147], v[188:191], v[80:83]
s_waitcnt lgkmcnt(10)
v_cvt_pk_bf16_f32 v204, v40, v41
v_cvt_pk_bf16_f32 v205, v42, v43
v_mfma_f32_16x16x32_bf16 v[92:95], a[148:151], v[188:191], v[92:95]
v_cvt_pk_bf16_f32 v206, v44, v45
v_cvt_pk_bf16_f32 v207, v46, v47
v_mfma_f32_16x16x32_bf16 v[96:99], a[148:151], v[192:195], v[96:99]
ds_read_b64_tr_b16 a[172:173], v24 offset:10528
ds_read_b64_tr_b16 a[174:175], v24 offset:15648
v_mfma_f32_16x16x32_bf16 v[100:103], a[148:151], v[196:199], v[100:103]
s_waitcnt lgkmcnt(10)
v_accvgpr_read_b32 v48, a56
v_accvgpr_read_b32 v49, a57
v_mfma_f32_16x16x32_bf16 v[112:115], a[152:155], v[196:199], v[112:115]
v_accvgpr_read_b32 v50, a58
v_accvgpr_read_b32 v51, a59
v_mfma_f32_16x16x32_bf16 v[108:111], a[152:155], v[192:195], v[108:111]
v_accvgpr_read_b32 v52, a68
v_accvgpr_read_b32 v53, a69
v_mfma_f32_16x16x32_bf16 v[104:107], a[152:155], v[188:191], v[104:107]
s_waitcnt lgkmcnt(8)
v_accvgpr_read_b32 v54, a70
v_accvgpr_read_b32 v55, a71
v_mfma_f32_16x16x32_bf16 v[116:119], a[156:159], v[188:191], v[116:119]
v_mul_f32 v48, v48, v249
v_mul_f32 v49, v49, v249
v_mfma_f32_16x16x32_bf16 v[120:123], a[156:159], v[192:195], v[120:123]
v_mul_f32 v50, v50, v249
v_mul_f32 v51, v51, v249
v_mfma_f32_16x16x32_bf16 v[124:127], a[156:159], v[196:199], v[124:127]
s_waitcnt lgkmcnt(6)
v_mul_f32 v52, v52, v249
v_mul_f32 v53, v53, v249
v_mfma_f32_16x16x32_bf16 v[136:139], a[160:163], v[196:199], v[136:139]
s_waitcnt vmcnt(31)
s_waitcnt lgkmcnt(0)
v_mul_f32 v54, v54, v249
v_mfma_f32_16x16x32_bf16 v[132:135], a[160:163], v[192:195], v[132:135]
s_barrier
v_mul_f32 v55, v55, v249
v_mfma_f32_16x16x32_bf16 v[128:131], a[160:163], v[188:191], v[128:131]
ds_read_b64_tr_b16 a[176:177], v20 offset:0
ds_read_b64_tr_b16 a[178:179], v20 offset:5120
v_mfma_f32_16x16x32_bf16 v[140:143], a[164:167], v[188:191], v[140:143]
s_add_u32 s44, s38, 24576
ds_read_b64_tr_b16 a[180:181], v21 offset:32
ds_read_b64_tr_b16 a[182:183], v21 offset:5152
v_mfma_f32_16x16x32_bf16 v[144:147], a[164:167], v[192:195], v[144:147]
buffer_store_dwordx4 v[200:203], v30, s[20:23], s44 offen offset:0 sc1
v_mfma_f32_16x16x32_bf16 v[148:151], a[164:167], v[196:199], v[148:151]
v_cvt_pk_bf16_f32 v208, v48, v49
v_cvt_pk_bf16_f32 v209, v50, v51
v_mfma_f32_16x16x32_bf16 v[160:163], a[168:171], v[196:199], v[160:163]
ds_read_b64_tr_b16 a[184:185], v20 offset:64
ds_read_b64_tr_b16 a[186:187], v20 offset:5184
v_mfma_f32_16x16x32_bf16 v[156:159], a[168:171], v[192:195], v[156:159]
buffer_store_dwordx4 v[204:207], v30, s[20:23], s44 offen offset:1024 sc1
v_mfma_f32_16x16x32_bf16 v[152:155], a[168:171], v[188:191], v[152:155]
v_cvt_pk_bf16_f32 v210, v52, v53
v_cvt_pk_bf16_f32 v211, v54, v55
v_mfma_f32_16x16x32_bf16 v[164:167], a[172:175], v[188:191], v[164:167]
ds_read_b64_tr_b16 a[188:189], v21 offset:96
ds_read_b64_tr_b16 a[190:191], v21 offset:5216
v_mfma_f32_16x16x32_bf16 v[168:171], a[172:175], v[192:195], v[168:171]
buffer_store_dwordx4 v[208:211], v30, s[20:23], s44 offen offset:2048 sc1
v_mfma_f32_16x16x32_bf16 v[172:175], a[172:175], v[196:199], v[172:175]
s_waitcnt lgkmcnt(6)
ds_read_b64_tr_b16 a[144:145], v20 offset:128
ds_read_b64_tr_b16 a[146:147], v20 offset:5248
v_mfma_f32_16x16x32_bf16 v[64:67], a[176:179], v[208:211], v[64:67]
v_accvgpr_read_b32 v32, a72
v_accvgpr_read_b32 v33, a73
v_mfma_f32_16x16x32_bf16 v[60:63], a[176:179], v[204:207], v[60:63]
v_accvgpr_read_b32 v34, a74
v_accvgpr_read_b32 v35, a75
v_mfma_f32_16x16x32_bf16 v[56:59], a[176:179], v[200:203], v[56:59]
s_waitcnt lgkmcnt(6)
ds_read_b64_tr_b16 a[148:149], v21 offset:160
ds_read_b64_tr_b16 a[150:151], v21 offset:5280
v_mfma_f32_16x16x32_bf16 v[68:71], a[180:183], v[200:203], v[68:71]
v_add_u32 v23, 122880, v252
v_accvgpr_read_b32 v36, a84
v_mfma_f32_16x16x32_bf16 v[72:75], a[180:183], v[204:207], v[72:75]
s_waitcnt vmcnt(8)
s_lshl_b64 exec, 1, s36
buffer_store_dwordx2 v[6:7], v250, s[20:23], 0 offen offset:128
buffer_store_dwordx2 v[6:7], v250, s[20:23], 0 offen offset:0 sc1
s_mov_b64 exec, -1
v_mfma_f32_16x16x32_bf16 v[76:79], a[180:183], v[208:211], v[76:79]
s_waitcnt lgkmcnt(6)
ds_read_b64_tr_b16 a[152:153], v20 offset:192
ds_read_b64_tr_b16 a[154:155], v20 offset:5312
v_mfma_f32_16x16x32_bf16 v[88:91], a[184:187], v[208:211], v[88:91]
v_accvgpr_read_b32 v37, a85
v_accvgpr_read_b32 v38, a86
v_mfma_f32_16x16x32_bf16 v[84:87], a[184:187], v[204:207], v[84:87]
ds_read_b64_tr_b16 a[156:157], v21 offset:224
ds_read_b64_tr_b16 a[158:159], v21 offset:5344
v_mfma_f32_16x16x32_bf16 v[80:83], a[184:187], v[200:203], v[80:83]
s_waitcnt lgkmcnt(8)
v_accvgpr_read_b32 v39, a87
v_mul_f32 v32, v32, v1
v_mfma_f32_16x16x32_bf16 v[92:95], a[188:191], v[200:203], v[92:95]
v_mul_f32 v33, v33, v1
v_mul_f32 v34, v34, v1
v_mfma_f32_16x16x32_bf16 v[96:99], a[188:191], v[204:207], v[96:99]
ds_read_b64_tr_b16 a[160:161], v20 offset:256
ds_read_b64_tr_b16 a[162:163], v20 offset:5376
v_mfma_f32_16x16x32_bf16 v[100:103], a[188:191], v[208:211], v[100:103]
s_waitcnt lgkmcnt(8)
v_add_u32 v24, 122880, v253
v_mul_f32 v35, v35, v1
v_mfma_f32_16x16x32_bf16 v[112:115], a[144:147], v[208:211], v[112:115]
v_mul_f32 v36, v36, v1
v_mul_f32 v37, v37, v1
v_mfma_f32_16x16x32_bf16 v[108:111], a[144:147], v[204:207], v[108:111]
ds_read_b64_tr_b16 a[164:165], v21 offset:288
ds_read_b64_tr_b16 a[166:167], v21 offset:5408
v_mfma_f32_16x16x32_bf16 v[104:107], a[144:147], v[200:203], v[104:107]
s_waitcnt lgkmcnt(8)
v_mul_f32 v38, v38, v1
v_mul_f32 v39, v39, v1
v_mfma_f32_16x16x32_bf16 v[116:119], a[148:151], v[200:203], v[116:119]
v_cvt_pk_bf16_f32 v212, v32, v33
v_cvt_pk_bf16_f32 v213, v34, v35
v_mfma_f32_16x16x32_bf16 v[120:123], a[148:151], v[204:207], v[120:123]
s_add_u32 s44, s38, 36864
ds_read_b64_tr_b16 a[168:169], v20 offset:10240
ds_read_b64_tr_b16 a[170:171], v20 offset:15360
v_mfma_f32_16x16x32_bf16 v[124:127], a[148:151], v[208:211], v[124:127]
s_waitcnt lgkmcnt(8)
v_cvt_pk_bf16_f32 v214, v36, v37
v_cvt_pk_bf16_f32 v215, v38, v39
v_mfma_f32_16x16x32_bf16 v[136:139], a[152:155], v[208:211], v[136:139]
ds_read_b64_tr_b16 a[172:173], v21 offset:10272
ds_read_b64_tr_b16 a[174:175], v21 offset:15392
v_mfma_f32_16x16x32_bf16 v[132:135], a[152:155], v[204:207], v[132:135]
buffer_store_dwordx4 v[212:215], v30, s[20:23], s44 offen offset:0 sc1
v_mfma_f32_16x16x32_bf16 v[128:131], a[152:155], v[200:203], v[128:131]
s_waitcnt lgkmcnt(8)
v_accvgpr_read_b32 v40, a76
v_accvgpr_read_b32 v41, a77
v_mfma_f32_16x16x32_bf16 v[140:143], a[156:159], v[200:203], v[140:143]
ds_read_b64_tr_b16 a[176:177], v20 offset:10304
ds_read_b64_tr_b16 a[178:179], v20 offset:15424
v_mfma_f32_16x16x32_bf16 v[144:147], a[156:159], v[204:207], v[144:147]
v_accvgpr_read_b32 v42, a78
v_accvgpr_read_b32 v43, a79
v_mfma_f32_16x16x32_bf16 v[148:151], a[156:159], v[208:211], v[148:151]
s_waitcnt lgkmcnt(8)
v_accvgpr_read_b32 v44, a88
v_accvgpr_read_b32 v45, a89
v_mfma_f32_16x16x32_bf16 v[160:163], a[160:163], v[208:211], v[160:163]
ds_read_b64_tr_b16 a[180:181], v21 offset:10336
ds_read_b64_tr_b16 a[182:183], v21 offset:15456
v_mfma_f32_16x16x32_bf16 v[156:159], a[160:163], v[204:207], v[156:159]
v_accvgpr_read_b32 v46, a90
v_accvgpr_read_b32 v47, a91
v_mfma_f32_16x16x32_bf16 v[152:155], a[160:163], v[200:203], v[152:155]
s_waitcnt lgkmcnt(8)
ds_read_b64_tr_b16 a[184:185], v20 offset:10368
ds_read_b64_tr_b16 a[186:187], v20 offset:15488
v_mfma_f32_16x16x32_bf16 v[164:167], a[164:167], v[200:203], v[164:167]
v_mul_f32 v40, v40, v10
v_mul_f32 v41, v41, v10
v_mul_f32 v42, v42, v10
v_mul_f32 v43, v43, v10
v_mul_f32 v44, v44, v10
v_mul_f32 v45, v45, v10
v_mul_f32 v46, v46, v10
v_mul_f32 v47, v47, v10
v_cvt_pk_bf16_f32 v216, v40, v41
v_cvt_pk_bf16_f32 v217, v42, v43
v_cvt_pk_bf16_f32 v218, v44, v45
v_cvt_pk_bf16_f32 v219, v46, v47
v_accvgpr_read_b32 v48, a80
v_accvgpr_read_b32 v49, a81
v_accvgpr_read_b32 v50, a82
v_accvgpr_read_b32 v51, a83
v_accvgpr_read_b32 v52, a92
v_accvgpr_read_b32 v53, a93
v_accvgpr_read_b32 v54, a94
v_accvgpr_read_b32 v55, a95
v_mul_f32 v48, v48, v249
v_mul_f32 v49, v49, v249
v_mul_f32 v50, v50, v249
v_mul_f32 v51, v51, v249
v_mul_f32 v52, v52, v249
v_mul_f32 v53, v53, v249
v_mul_f32 v54, v54, v249
v_mul_f32 v55, v55, v249
v_cvt_pk_bf16_f32 v220, v48, v49
v_cvt_pk_bf16_f32 v221, v50, v51
v_cvt_pk_bf16_f32 v222, v52, v53
v_cvt_pk_bf16_f32 v223, v54, v55
v_mfma_f32_16x16x32_bf16 v[168:171], a[164:167], v[204:207], v[168:171]
buffer_store_dwordx4 v[216:219], v30, s[20:23], s44 offen offset:1024 sc1
v_mfma_f32_16x16x32_bf16 v[172:175], a[164:167], v[208:211], v[172:175]
s_waitcnt lgkmcnt(8)
ds_read_b64_tr_b16 a[188:189], v21 offset:10400
ds_read_b64_tr_b16 a[190:191], v21 offset:15520
v_mfma_f32_16x16x32_bf16 v[64:67], a[168:171], v[220:223], v[64:67]
buffer_store_dwordx4 v[220:223], v30, s[20:23], s44 offen offset:2048 sc1
v_mfma_f32_16x16x32_bf16 v[60:63], a[168:171], v[216:219], v[60:63]
s_add_u32 s43, s78, 1
v_accvgpr_read_b32 v32, a96
v_accvgpr_read_b32 v33, a97
v_mfma_f32_16x16x32_bf16 v[56:59], a[168:171], v[212:215], v[56:59]
s_waitcnt lgkmcnt(8)
ds_read_b64_tr_b16 a[144:145], v20 offset:10432
ds_read_b64_tr_b16 a[146:147], v20 offset:15552
v_mfma_f32_16x16x32_bf16 v[68:71], a[172:175], v[212:215], v[68:71]
s_mul_i32 s43, s43, 81920
v_accvgpr_read_b32 v34, a98
v_accvgpr_read_b32 v35, a99
v_mfma_f32_16x16x32_bf16 v[72:75], a[172:175], v[216:219], v[72:75]
s_add_u32 m0, s45, 61440
ds_read_b64_tr_b16 a[148:149], v21 offset:10464
ds_read_b64_tr_b16 a[150:151], v21 offset:15584
v_mfma_f32_16x16x32_bf16 v[76:79], a[172:175], v[220:223], v[76:79]
s_waitcnt lgkmcnt(10)
v_accvgpr_read_b32 v36, a108
v_accvgpr_read_b32 v37, a109
v_mfma_f32_16x16x32_bf16 v[88:91], a[176:179], v[220:223], v[88:91]
buffer_load_dwordx4 v11, s[24:27], s43 offen offset:0 lds
v_mfma_f32_16x16x32_bf16 v[84:87], a[176:179], v[216:219], v[84:87]
ds_read_b64_tr_b16 a[152:153], v20 offset:10496
ds_read_b64_tr_b16 a[154:155], v20 offset:15616
v_mfma_f32_16x16x32_bf16 v[80:83], a[176:179], v[212:215], v[80:83]
s_waitcnt lgkmcnt(10)
buffer_load_dwordx4 v12, s[24:27], s43 offen offset:1024 lds
v_mfma_f32_16x16x32_bf16 v[92:95], a[180:183], v[212:215], v[92:95]
v_accvgpr_read_b32 v38, a110
v_accvgpr_read_b32 v39, a111
v_mfma_f32_16x16x32_bf16 v[96:99], a[180:183], v[216:219], v[96:99]
ds_read_b64_tr_b16 a[156:157], v21 offset:10528
ds_read_b64_tr_b16 a[158:159], v21 offset:15648
v_mfma_f32_16x16x32_bf16 v[100:103], a[180:183], v[220:223], v[100:103]
s_waitcnt lgkmcnt(10)
buffer_load_dwordx4 v13, s[24:27], s43 offen offset:2048 lds
v_mfma_f32_16x16x32_bf16 v[112:115], a[184:187], v[220:223], v[112:115]
v_mul_f32 v32, v32, v1
v_mul_f32 v33, v33, v1
v_mfma_f32_16x16x32_bf16 v[108:111], a[184:187], v[216:219], v[108:111]
buffer_load_dwordx4 v14, s[24:27], s43 offen offset:3072 lds
v_mfma_f32_16x16x32_bf16 v[104:107], a[184:187], v[212:215], v[104:107]
s_waitcnt lgkmcnt(8)
v_mul_f32 v34, v34, v1
v_mul_f32 v35, v35, v1
v_mfma_f32_16x16x32_bf16 v[116:119], a[188:191], v[212:215], v[116:119]
s_add_u32 m0, s45, 65536
v_mul_f32 v36, v36, v1
v_mul_f32 v37, v37, v1
v_mfma_f32_16x16x32_bf16 v[120:123], a[188:191], v[216:219], v[120:123]
buffer_load_dwordx4 v15, s[24:27], s43 offen offset:0 lds
v_mfma_f32_16x16x32_bf16 v[124:127], a[188:191], v[220:223], v[124:127]
s_waitcnt lgkmcnt(6)
v_mul_f32 v38, v38, v1
v_mul_f32 v39, v39, v1
v_mfma_f32_16x16x32_bf16 v[136:139], a[144:147], v[220:223], v[136:139]
s_waitcnt lgkmcnt(0)
v_cvt_pk_bf16_f32 v224, v32, v33
v_mfma_f32_16x16x32_bf16 v[132:135], a[144:147], v[216:219], v[132:135]
s_barrier
v_cvt_pk_bf16_f32 v225, v34, v35
v_mfma_f32_16x16x32_bf16 v[128:131], a[144:147], v[212:215], v[128:131]
ds_read_b64_tr_b16 a[160:161], v23 offset:0
ds_read_b64_tr_b16 a[162:163], v23 offset:5120
v_mfma_f32_16x16x32_bf16 v[140:143], a[148:151], v[212:215], v[140:143]
ds_read_b64_tr_b16 a[164:165], v24 offset:32
ds_read_b64_tr_b16 a[166:167], v24 offset:5152
v_mfma_f32_16x16x32_bf16 v[144:147], a[148:151], v[216:219], v[144:147]
v_cvt_pk_bf16_f32 v226, v36, v37
v_cvt_pk_bf16_f32 v227, v38, v39
v_mfma_f32_16x16x32_bf16 v[148:151], a[148:151], v[220:223], v[148:151]
v_accvgpr_read_b32 v40, a100
v_accvgpr_read_b32 v41, a101
v_mfma_f32_16x16x32_bf16 v[160:163], a[152:155], v[220:223], v[160:163]
ds_read_b64_tr_b16 a[168:169], v23 offset:64
ds_read_b64_tr_b16 a[170:171], v23 offset:5184
v_mfma_f32_16x16x32_bf16 v[156:159], a[152:155], v[216:219], v[156:159]
buffer_load_dwordx2 v[2:3], v250, s[20:23], 0 offen offset:128 sc1
v_mfma_f32_16x16x32_bf16 v[152:155], a[152:155], v[212:215], v[152:155]
v_accvgpr_read_b32 v42, a102
v_accvgpr_read_b32 v43, a103
v_accvgpr_read_b32 v44, a112
v_mfma_f32_16x16x32_bf16 v[164:167], a[156:159], v[212:215], v[164:167]
ds_read_b64_tr_b16 a[172:173], v24 offset:96
ds_read_b64_tr_b16 a[174:175], v24 offset:5216
v_accvgpr_read_b32 v45, a113
v_accvgpr_read_b32 v46, a114
v_accvgpr_read_b32 v47, a115
v_mul_f32 v40, v40, v10
v_mul_f32 v41, v41, v10
v_mul_f32 v42, v42, v10
v_mul_f32 v43, v43, v10
v_mul_f32 v44, v44, v10
v_mul_f32 v45, v45, v10
v_mul_f32 v46, v46, v10
v_mul_f32 v47, v47, v10
v_cvt_pk_bf16_f32 v228, v40, v41
v_cvt_pk_bf16_f32 v229, v42, v43
v_cvt_pk_bf16_f32 v230, v44, v45
v_cvt_pk_bf16_f32 v231, v46, v47
v_accvgpr_read_b32 v48, a104
v_accvgpr_read_b32 v49, a105
v_accvgpr_read_b32 v50, a106
v_accvgpr_read_b32 v51, a107
v_accvgpr_read_b32 v52, a116
v_accvgpr_read_b32 v53, a117
v_accvgpr_read_b32 v54, a118
v_accvgpr_read_b32 v55, a119
v_mul_f32 v48, v48, v249
v_mul_f32 v49, v49, v249
v_mul_f32 v50, v50, v249
v_mul_f32 v51, v51, v249
v_mul_f32 v52, v52, v249
v_mul_f32 v53, v53, v249
v_mul_f32 v54, v54, v249
v_mul_f32 v55, v55, v249
v_cvt_pk_bf16_f32 v232, v48, v49
v_cvt_pk_bf16_f32 v233, v50, v51
v_cvt_pk_bf16_f32 v234, v52, v53
v_cvt_pk_bf16_f32 v235, v54, v55
v_mfma_f32_16x16x32_bf16 v[168:171], a[156:159], v[216:219], v[168:171]
v_accvgpr_read_b32 v32, a120
v_accvgpr_read_b32 v33, a121
v_mfma_f32_16x16x32_bf16 v[172:175], a[156:159], v[220:223], v[172:175]
s_waitcnt lgkmcnt(6)
ds_read_b64_tr_b16 a[176:177], v23 offset:128
ds_read_b64_tr_b16 a[178:179], v23 offset:5248
v_mfma_f32_16x16x32_bf16 v[64:67], a[160:163], v[232:235], v[64:67]
v_accvgpr_read_b32 v34, a122
v_accvgpr_read_b32 v35, a123
v_mfma_f32_16x16x32_bf16 v[60:63], a[160:163], v[228:231], v[60:63]
v_accvgpr_read_b32 v36, a132
v_accvgpr_read_b32 v37, a133
v_mfma_f32_16x16x32_bf16 v[56:59], a[160:163], v[224:227], v[56:59]
s_waitcnt lgkmcnt(6)
ds_read_b64_tr_b16 a[180:181], v24 offset:160
ds_read_b64_tr_b16 a[182:183], v24 offset:5280
v_mfma_f32_16x16x32_bf16 v[68:71], a[164:167], v[224:227], v[68:71]
v_add_u32 v20, 143360, v252
v_accvgpr_read_b32 v38, a134
v_mfma_f32_16x16x32_bf16 v[72:75], a[164:167], v[228:231], v[72:75]
v_accvgpr_read_b32 v39, a135
v_mul_f32 v32, v32, v1
v_mfma_f32_16x16x32_bf16 v[76:79], a[164:167], v[232:235], v[76:79]
s_waitcnt lgkmcnt(6)
ds_read_b64_tr_b16 a[184:185], v23 offset:192
ds_read_b64_tr_b16 a[186:187], v23 offset:5312
v_mfma_f32_16x16x32_bf16 v[88:91], a[168:171], v[232:235], v[88:91]
v_mul_f32 v33, v33, v1
v_mul_f32 v34, v34, v1
v_mfma_f32_16x16x32_bf16 v[84:87], a[168:171], v[228:231], v[84:87]
ds_read_b64_tr_b16 a[188:189], v24 offset:224
ds_read_b64_tr_b16 a[190:191], v24 offset:5344
v_mfma_f32_16x16x32_bf16 v[80:83], a[168:171], v[224:227], v[80:83]
s_waitcnt lgkmcnt(8)
v_mul_f32 v35, v35, v1
v_mul_f32 v36, v36, v1
v_mfma_f32_16x16x32_bf16 v[92:95], a[172:175], v[224:227], v[92:95]
v_mul_f32 v37, v37, v1
v_mul_f32 v38, v38, v1
v_mfma_f32_16x16x32_bf16 v[96:99], a[172:175], v[228:231], v[96:99]
ds_read_b64_tr_b16 a[144:145], v23 offset:256
ds_read_b64_tr_b16 a[146:147], v23 offset:5376
v_mfma_f32_16x16x32_bf16 v[100:103], a[172:175], v[232:235], v[100:103]
s_waitcnt lgkmcnt(8)
v_add_u32 v21, 143360, v253
v_mul_f32 v39, v39, v1
v_mfma_f32_16x16x32_bf16 v[112:115], a[176:179], v[232:235], v[112:115]
s_waitcnt vmcnt(0)
v_cmp_ne_u64 vcc, s[92:93], v[2:3]
v_cvt_pk_bf16_f32 v236, v32, v33
v_mfma_f32_16x16x32_bf16 v[108:111], a[176:179], v[228:231], v[108:111]
ds_read_b64_tr_b16 a[148:149], v24 offset:288
ds_read_b64_tr_b16 a[150:151], v24 offset:5408
v_mfma_f32_16x16x32_bf16 v[104:107], a[176:179], v[224:227], v[104:107]
s_waitcnt lgkmcnt(8)
v_cvt_pk_bf16_f32 v237, v34, v35
v_cvt_pk_bf16_f32 v238, v36, v37
v_mfma_f32_16x16x32_bf16 v[116:119], a[180:183], v[224:227], v[116:119]
s_cbranch_vccnz L_spin0
L_spinr0:
v_cvt_pk_bf16_f32 v239, v38, v39
v_accvgpr_read_b32 v40, a124
v_mfma_f32_16x16x32_bf16 v[120:123], a[180:183], v[228:231], v[120:123]
s_add_u32 s44, s77, 0
ds_read_b64_tr_b16 a[152:153], v23 offset:10240
ds_read_b64_tr_b16 a[154:155], v23 offset:15360
v_mfma_f32_16x16x32_bf16 v[124:127], a[180:183], v[232:235], v[124:127]
s_waitcnt lgkmcnt(8)
v_accvgpr_read_b32 v41, a125
v_accvgpr_read_b32 v42, a126
v_mfma_f32_16x16x32_bf16 v[136:139], a[184:187], v[232:235], v[136:139]
s_mul_i32 s44, s44, 24576
ds_read_b64_tr_b16 a[156:157], v24 offset:10272
ds_read_b64_tr_b16 a[158:159], v24 offset:15392
v_mfma_f32_16x16x32_bf16 v[132:135], a[184:187], v[228:231], v[132:135]
v_accvgpr_read_b32 v43, a127
v_accvgpr_read_b32 v44, a136
v_mfma_f32_16x16x32_bf16 v[128:131], a[184:187], v[224:227], v[128:131]
s_waitcnt lgkmcnt(8)
buffer_load_dwordx4 a[192:195], v30, s[20:23], s44 offen offset:0 sc1
v_mfma_f32_16x16x32_bf16 v[140:143], a[188:191], v[224:227], v[140:143]
ds_read_b64_tr_b16 a[160:161], v23 offset:10304
ds_read_b64_tr_b16 a[162:163], v23 offset:15424
v_mfma_f32_16x16x32_bf16 v[144:147], a[188:191], v[228:231], v[144:147]
buffer_load_dwordx4 a[196:199], v30, s[20:23], s44 offen offset:1024 sc1
v_mfma_f32_16x16x32_bf16 v[148:151], a[188:191], v[232:235], v[148:151]
s_waitcnt lgkmcnt(8)
v_accvgpr_read_b32 v45, a137
v_accvgpr_read_b32 v46, a138
v_mfma_f32_16x16x32_bf16 v[160:163], a[144:147], v[232:235], v[160:163]
ds_read_b64_tr_b16 a[164:165], v24 offset:10336
ds_read_b64_tr_b16 a[166:167], v24 offset:15456
v_mfma_f32_16x16x32_bf16 v[156:159], a[144:147], v[228:231], v[156:159]
buffer_load_dwordx4 a[200:203], v30, s[20:23], s44 offen offset:2048 sc1
v_mfma_f32_16x16x32_bf16 v[152:155], a[144:147], v[224:227], v[152:155]
s_waitcnt lgkmcnt(8)
ds_read_b64_tr_b16 a[168:169], v23 offset:10368
ds_read_b64_tr_b16 a[170:171], v23 offset:15488
v_mfma_f32_16x16x32_bf16 v[164:167], a[148:151], v[224:227], v[164:167]
s_add_u32 s44, s44, 12288
v_accvgpr_read_b32 v47, a139
v_mul_f32 v40, v40, v10
v_mul_f32 v41, v41, v10
v_mul_f32 v42, v42, v10
v_mul_f32 v43, v43, v10
v_mul_f32 v44, v44, v10
v_mul_f32 v45, v45, v10
v_mul_f32 v46, v46, v10
v_mul_f32 v47, v47, v10
v_cvt_pk_bf16_f32 v240, v40, v41
v_cvt_pk_bf16_f32 v241, v42, v43
v_cvt_pk_bf16_f32 v242, v44, v45
v_cvt_pk_bf16_f32 v243, v46, v47
v_accvgpr_read_b32 v48, a128
v_accvgpr_read_b32 v49, a129
v_accvgpr_read_b32 v50, a130
v_accvgpr_read_b32 v51, a131
v_accvgpr_read_b32 v52, a140
v_accvgpr_read_b32 v53, a141
v_accvgpr_read_b32 v54, a142
v_accvgpr_read_b32 v55, a143
v_mul_f32 v48, v48, v249
v_mul_f32 v49, v49, v249
v_mul_f32 v50, v50, v249
v_mul_f32 v51, v51, v249
v_mul_f32 v52, v52, v249
v_mul_f32 v53, v53, v249
v_mul_f32 v54, v54, v249
v_mul_f32 v55, v55, v249
v_cvt_pk_bf16_f32 v244, v48, v49
v_cvt_pk_bf16_f32 v245, v50, v51
v_cvt_pk_bf16_f32 v246, v52, v53
v_cvt_pk_bf16_f32 v247, v54, v55
v_mfma_f32_16x16x32_bf16 v[168:171], a[148:151], v[228:231], v[168:171]
buffer_load_dwordx4 a[204:207], v30, s[20:23], s44 offen offset:0 sc1
v_mfma_f32_16x16x32_bf16 v[172:175], a[148:151], v[232:235], v[172:175]
s_waitcnt lgkmcnt(8)
ds_read_b64_tr_b16 a[172:173], v24 offset:10400
ds_read_b64_tr_b16 a[174:175], v24 offset:15520
v_mfma_f32_16x16x32_bf16 v[64:67], a[152:155], v[244:247], v[64:67]
buffer_load_dwordx4 a[208:211], v30, s[20:23], s44 offen offset:1024 sc1
v_mfma_f32_16x16x32_bf16 v[60:63], a[152:155], v[240:243], v[60:63]
v_mfma_f32_16x16x32_bf16 v[56:59], a[152:155], v[236:239], v[56:59]
s_waitcnt lgkmcnt(8)
ds_read_b64_tr_b16 a[176:177], v23 offset:10432
ds_read_b64_tr_b16 a[178:179], v23 offset:15552
v_mfma_f32_16x16x32_bf16 v[68:71], a[156:159], v[236:239], v[68:71]
buffer_load_dwordx4 a[212:215], v30, s[20:23], s44 offen offset:2048 sc1
v_mfma_f32_16x16x32_bf16 v[72:75], a[156:159], v[240:243], v[72:75]
ds_read_b64_tr_b16 a[180:181], v24 offset:10464
ds_read_b64_tr_b16 a[182:183], v24 offset:15584
v_mfma_f32_16x16x32_bf16 v[76:79], a[156:159], v[244:247], v[76:79]
s_waitcnt lgkmcnt(10)
v_mfma_f32_16x16x32_bf16 v[88:91], a[160:163], v[244:247], v[88:91]
v_mfma_f32_16x16x32_bf16 v[84:87], a[160:163], v[240:243], v[84:87]
ds_read_b64_tr_b16 a[184:185], v23 offset:10496
ds_read_b64_tr_b16 a[186:187], v23 offset:15616
v_mfma_f32_16x16x32_bf16 v[80:83], a[160:163], v[236:239], v[80:83]
s_waitcnt lgkmcnt(10)
v_mfma_f32_16x16x32_bf16 v[92:95], a[164:167], v[236:239], v[92:95]
v_mfma_f32_16x16x32_bf16 v[96:99], a[164:167], v[240:243], v[96:99]
ds_read_b64_tr_b16 a[188:189], v24 offset:10528
ds_read_b64_tr_b16 a[190:191], v24 offset:15648
v_mfma_f32_16x16x32_bf16 v[100:103], a[164:167], v[244:247], v[100:103]
s_lshl_b64 exec, 1, s36
buffer_store_dwordx2 v[6:7], v250, s[20:23], 0 offen offset:160
buffer_store_dwordx2 v[6:7], v250, s[20:23], 0 offen offset:32 sc1
s_mov_b64 exec, -1
s_waitcnt lgkmcnt(10)
v_mfma_f32_16x16x32_bf16 v[112:115], a[168:171], v[244:247], v[112:115]
v_mfma_f32_16x16x32_bf16 v[108:111], a[168:171], v[240:243], v[108:111]
v_mfma_f32_16x16x32_bf16 v[104:107], a[168:171], v[236:239], v[104:107]
s_waitcnt lgkmcnt(8)
v_mfma_f32_16x16x32_bf16 v[116:119], a[172:175], v[236:239], v[116:119]
s_add_u32 s44, s78, 0
v_mfma_f32_16x16x32_bf16 v[120:123], a[172:175], v[240:243], v[120:123]
s_mul_i32 s44, s44, 24576
v_mfma_f32_16x16x32_bf16 v[124:127], a[172:175], v[244:247], v[124:127]
s_waitcnt lgkmcnt(6)
v_mfma_f32_16x16x32_bf16 v[136:139], a[176:179], v[244:247], v[136:139]
s_waitcnt lgkmcnt(0)
v_mfma_f32_16x16x32_bf16 v[132:135], a[176:179], v[240:243], v[132:135]
s_barrier
v_mfma_f32_16x16x32_bf16 v[128:131], a[176:179], v[236:239], v[128:131]
ds_read_b64_tr_b16 a[144:145], v20 offset:0
ds_read_b64_tr_b16 a[146:147], v20 offset:5120
v_mfma_f32_16x16x32_bf16 v[140:143], a[180:183], v[236:239], v[140:143]
ds_read_b64_tr_b16 a[148:149], v21 offset:32
ds_read_b64_tr_b16 a[150:151], v21 offset:5152
v_mfma_f32_16x16x32_bf16 v[144:147], a[180:183], v[240:243], v[144:147]
buffer_load_dwordx4 a[216:219], v30, s[20:23], s44 offen offset:0 sc1
v_mfma_f32_16x16x32_bf16 v[148:151], a[180:183], v[244:247], v[148:151]
v_mfma_f32_16x16x32_bf16 v[160:163], a[184:187], v[244:247], v[160:163]
ds_read_b64_tr_b16 a[152:153], v20 offset:64
ds_read_b64_tr_b16 a[154:155], v20 offset:5184
v_mfma_f32_16x16x32_bf16 v[156:159], a[184:187], v[240:243], v[156:159]
buffer_load_dwordx4 a[220:223], v30, s[20:23], s44 offen offset:1024 sc1
v_mfma_f32_16x16x32_bf16 v[152:155], a[184:187], v[236:239], v[152:155]
v_mfma_f32_16x16x32_bf16 v[164:167], a[188:191], v[236:239], v[164:167]
ds_read_b64_tr_b16 a[156:157], v21 offset:96
ds_read_b64_tr_b16 a[158:159], v21 offset:5216
v_mfma_f32_16x16x32_bf16 v[168:171], a[188:191], v[240:243], v[168:171]
buffer_load_dwordx4 a[224:227], v30, s[20:23], s44 offen offset:2048 sc1
v_mfma_f32_16x16x32_bf16 v[172:175], a[188:191], v[244:247], v[172:175]
s_waitcnt vmcnt(8) lgkmcnt(6)
ds_read_b64_tr_b16 a[160:161], v20 offset:128
ds_read_b64_tr_b16 a[162:163], v20 offset:5248
v_mfma_f32_16x16x32_bf16 v[64:67], a[144:147], a[200:203], v[64:67]
s_add_u32 s44, s44, 12288
v_add_u32 v25, 40960, v252
v_mfma_f32_16x16x32_bf16 v[60:63], a[144:147], a[196:199], v[60:63]
buffer_load_dwordx4 a[228:231], v30, s[20:23], s44 offen offset:0 sc1
v_mfma_f32_16x16x32_bf16 v[56:59], a[144:147], a[192:195], v[56:59]
s_waitcnt lgkmcnt(6)
ds_read_b64_tr_b16 a[164:165], v21 offset:160
ds_read_b64_tr_b16 a[166:167], v21 offset:5280
v_mfma_f32_16x16x32_bf16 v[68:71], a[148:151], a[192:195], v[68:71]
buffer_load_dwordx4 a[232:235], v30, s[20:23], s44 offen offset:1024 sc1
v_mfma_f32_16x16x32_bf16 v[72:75], a[148:151], a[196:199], v[72:75]
v_add_u32 v23, 0, v252
v_mfma_f32_16x16x32_bf16 v[76:79], a[148:151], a[200:203], v[76:79]
s_waitcnt lgkmcnt(6)
ds_read_b64_tr_b16 a[168:169], v20 offset:192
ds_read_b64_tr_b16 a[170:171], v20 offset:5312
v_mfma_f32_16x16x32_bf16 v[88:91], a[152:155], a[200:203], v[88:91]
buffer_load_dwordx4 a[236:239], v30, s[20:23], s44 offen offset:2048 sc1
v_mfma_f32_16x16x32_bf16 v[84:87], a[152:155], a[196:199], v[84:87]
s_add_u32 s44, s38, 49152
ds_read_b64_tr_b16 a[172:173], v21 offset:224
ds_read_b64_tr_b16 a[174:175], v21 offset:5344
v_mfma_f32_16x16x32_bf16 v[80:83], a[152:155], a[192:195], v[80:83]
s_waitcnt lgkmcnt(8)
buffer_store_dwordx4 v[224:227], v30, s[20:23], s44 offen offset:0 sc1
v_mfma_f32_16x16x32_bf16 v[92:95], a[156:159], a[192:195], v[92:95]
v_add_u32 v26, 40960, v253
v_mfma_f32_16x16x32_bf16 v[96:99], a[156:159], a[196:199], v[96:99]
ds_read_b64_tr_b16 a[176:177], v20 offset:256
ds_read_b64_tr_b16 a[178:179], v20 offset:5376
v_mfma_f32_16x16x32_bf16 v[100:103], a[156:159], a[200:203], v[100:103]
s_waitcnt lgkmcnt(8)
buffer_store_dwordx4 v[228:231], v30, s[20:23], s44 offen offset:1024 sc1
v_mfma_f32_16x16x32_bf16 v[112:115], a[160:163], a[200:203], v[112:115]
v_add_u32 v24, 0, v253
v_mfma_f32_16x16x32_bf16 v[108:111], a[160:163], a[196:199], v[108:111]
ds_read_b64_tr_b16 a[180:181], v21 offset:288
ds_read_b64_tr_b16 a[182:183], v21 offset:5408
v_mfma_f32_16x16x32_bf16 v[104:107], a[160:163], a[192:195], v[104:107]
s_waitcnt lgkmcnt(8)
buffer_store_dwordx4 v[232:235], v30, s[20:23], s44 offen offset:2048 sc1
v_mfma_f32_16x16x32_bf16 v[116:119], a[164:167], a[192:195], v[116:119]
s_add_u32 s44, s38, 61440
v_mfma_f32_16x16x32_bf16 v[120:123], a[164:167], a[196:199], v[120:123]
ds_read_b64_tr_b16 a[184:185], v20 offset:10240
ds_read_b64_tr_b16 a[186:187], v20 offset:15360
v_mfma_f32_16x16x32_bf16 v[124:127], a[164:167], a[200:203], v[124:127]
s_waitcnt lgkmcnt(8)
buffer_store_dwordx4 v[236:239], v30, s[20:23], s44 offen offset:0 sc1
v_mfma_f32_16x16x32_bf16 v[136:139], a[168:171], a[200:203], v[136:139]
ds_read_b64_tr_b16 a[188:189], v21 offset:10272
ds_read_b64_tr_b16 a[190:191], v21 offset:15392
v_mfma_f32_16x16x32_bf16 v[132:135], a[168:171], a[196:199], v[132:135]
buffer_store_dwordx4 v[240:243], v30, s[20:23], s44 offen offset:1024 sc1
v_mfma_f32_16x16x32_bf16 v[128:131], a[168:171], a[192:195], v[128:131]
s_waitcnt lgkmcnt(8)
v_add_u32 v16, 102400, v252
v_mfma_f32_16x16x32_bf16 v[140:143], a[172:175], a[192:195], v[140:143]
ds_read_b64_tr_b16 a[144:145], v20 offset:10304
ds_read_b64_tr_b16 a[146:147], v20 offset:15424
v_mfma_f32_16x16x32_bf16 v[144:147], a[172:175], a[196:199], v[144:147]
buffer_store_dwordx4 v[244:247], v30, s[20:23], s44 offen offset:2048 sc1
v_mfma_f32_16x16x32_bf16 v[148:151], a[172:175], a[200:203], v[148:151]
s_waitcnt lgkmcnt(8)
v_mfma_f32_16x16x32_bf16 v[160:163], a[176:179], a[200:203], v[160:163]
ds_read_b64_tr_b16 a[148:149], v21 offset:10336
ds_read_b64_tr_b16 a[150:151], v21 offset:15456
v_mfma_f32_16x16x32_bf16 v[156:159], a[176:179], a[196:199], v[156:159]
v_mfma_f32_16x16x32_bf16 v[152:155], a[176:179], a[192:195], v[152:155]
s_waitcnt lgkmcnt(8)
ds_read_b64_tr_b16 a[152:153], v20 offset:10368
ds_read_b64_tr_b16 a[154:155], v20 offset:15488
v_mfma_f32_16x16x32_bf16 v[164:167], a[180:183], a[192:195], v[164:167]
s_add_u32 s44, s79, 0
v_add_u32 v17, 102400, v253
v_mfma_f32_16x16x32_bf16 v[168:171], a[180:183], a[196:199], v[168:171]
s_mul_i32 s44, s44, 24576
v_mfma_f32_16x16x32_bf16 v[172:175], a[180:183], a[200:203], v[172:175]
s_waitcnt vmcnt(14) lgkmcnt(8)
ds_read_b64_tr_b16 a[156:157], v21 offset:10400
ds_read_b64_tr_b16 a[158:159], v21 offset:15520
v_mfma_f32_16x16x32_bf16 v[64:67], a[184:187], a[212:215], v[64:67]
buffer_load_dwordx4 a[240:243], v30, s[20:23], s44 offen offset:0 sc1
v_mfma_f32_16x16x32_bf16 v[60:63], a[184:187], a[208:211], v[60:63]
v_mfma_f32_16x16x32_bf16 v[56:59], a[184:187], a[204:207], v[56:59]
s_waitcnt lgkmcnt(8)
ds_read_b64_tr_b16 a[160:161], v20 offset:10432
ds_read_b64_tr_b16 a[162:163], v20 offset:15552
v_mfma_f32_16x16x32_bf16 v[68:71], a[188:191], a[204:207], v[68:71]
buffer_load_dwordx4 a[244:247], v30, s[20:23], s44 offen offset:1024 sc1
v_mfma_f32_16x16x32_bf16 v[72:75], a[188:191], a[208:211], v[72:75]
ds_read_b64_tr_b16 a[164:165], v21 offset:10464
ds_read_b64_tr_b16 a[166:167], v21 offset:15584
v_mfma_f32_16x16x32_bf16 v[76:79], a[188:191], a[212:215], v[76:79]
s_waitcnt lgkmcnt(10)
buffer_load_dwordx4 a[248:251], v30, s[20:23], s44 offen offset:2048 sc1
v_mfma_f32_16x16x32_bf16 v[88:91], a[144:147], a[212:215], v[88:91]
s_add_u32 s44, s44, 12288
v_mov_b32 v18, s94
v_mfma_f32_16x16x32_bf16 v[84:87], a[144:147], a[208:211], v[84:87]
ds_read_b64_tr_b16 a[168:169], v20 offset:10496
ds_read_b64_tr_b16 a[170:171], v20 offset:15616
v_mfma_f32_16x16x32_bf16 v[80:83], a[144:147], a[204:207], v[80:83]
s_waitcnt lgkmcnt(10)
buffer_load_dwordx4 a[252:255], v30, s[20:23], s44 offen offset:0 sc1
v_mfma_f32_16x16x32_bf16 v[92:95], a[148:151], a[204:207], v[92:95]
v_mfma_f32_16x16x32_bf16 v[96:99], a[148:151], a[208:211], v[96:99]
ds_read_b64_tr_b16 a[172:173], v21 offset:10528
ds_read_b64_tr_b16 a[174:175], v21 offset:15648
v_mfma_f32_16x16x32_bf16 v[100:103], a[148:151], a[212:215], v[100:103]
s_waitcnt lgkmcnt(10)
buffer_load_dwordx4 a[0:3], v30, s[20:23], s44 offen offset:1024 sc1
v_mfma_f32_16x16x32_bf16 v[112:115], a[152:155], a[212:215], v[112:115]
v_mfma_f32_16x16x32_bf16 v[108:111], a[152:155], a[208:211], v[108:111]
buffer_load_dwordx4 a[4:7], v30, s[20:23], s44 offen offset:2048 sc1
v_mfma_f32_16x16x32_bf16 v[104:107], a[152:155], a[204:207], v[104:107]
s_waitcnt lgkmcnt(8)
v_mfma_f32_16x16x32_bf16 v[116:119], a[156:159], a[204:207], v[116:119]
v_mfma_f32_16x16x32_bf16 v[120:123], a[156:159], a[208:211], v[120:123]
v_mfma_f32_16x16x32_bf16 v[124:127], a[156:159], a[212:215], v[124:127]
s_waitcnt lgkmcnt(6)
v_mfma_f32_16x16x32_bf16 v[136:139], a[160:163], a[212:215], v[136:139]
s_waitcnt lgkmcnt(0)
v_mov_b32 v19, s95
v_mfma_f32_16x16x32_bf16 v[132:135], a[160:163], a[208:211], v[132:135]
s_barrier
v_mfma_f32_16x16x32_bf16 v[128:131], a[160:163], a[204:207], v[128:131]
ds_read_b64_tr_b16 a[176:177], v23 offset:0
ds_read_b64_tr_b16 a[178:179], v23 offset:5120
v_mfma_f32_16x16x32_bf16 v[140:143], a[164:167], a[204:207], v[140:143]
buffer_load_dwordx2 v[4:5], v250, s[20:23], 0 offen offset:160 sc1
v_mfma_f32_16x16x32_bf16 v[144:147], a[164:167], a[208:211], v[144:147]
s_add_u32 s43, s79, 1
ds_read_b64_tr_b16 a[180:181], v24 offset:32
ds_read_b64_tr_b16 a[182:183], v24 offset:5152
v_mfma_f32_16x16x32_bf16 v[148:151], a[164:167], a[212:215], v[148:151]
v_mfma_f32_16x16x32_bf16 v[160:163], a[168:171], a[212:215], v[160:163]
s_mul_i32 s43, s43, 81920
v_mfma_f32_16x16x32_bf16 v[156:159], a[168:171], a[208:211], v[156:159]
s_add_u32 m0, s45, 81920
ds_read_b64_tr_b16 a[184:185], v23 offset:64
ds_read_b64_tr_b16 a[186:187], v23 offset:5184
v_mfma_f32_16x16x32_bf16 v[152:155], a[168:171], a[204:207], v[152:155]
s_cmp_ge_u32 s33, 4
s_cselect_b32 s48, 8, 0
v_mfma_f32_16x16x32_bf16 v[164:167], a[172:175], a[204:207], v[164:167]
buffer_load_dwordx4 v11, s[24:27], s43 offen offset:0 lds
v_mfma_f32_16x16x32_bf16 v[168:171], a[172:175], a[208:211], v[168:171]
ds_read_b64_tr_b16 a[188:189], v24 offset:96
ds_read_b64_tr_b16 a[190:191], v24 offset:5216
v_mfma_f32_16x16x32_bf16 v[172:175], a[172:175], a[212:215], v[172:175]
s_waitcnt vmcnt(17) lgkmcnt(6)
buffer_load_dwordx4 v12, s[24:27], s43 offen offset:1024 lds
v_mfma_f32_16x16x32_bf16 v[64:67], a[176:179], a[224:227], v[64:67]
v_mfma_f32_16x16x32_bf16 v[60:63], a[176:179], a[220:223], v[60:63]
ds_read_b64_tr_b16 a[144:145], v23 offset:128
ds_read_b64_tr_b16 a[146:147], v23 offset:5248
v_mfma_f32_16x16x32_bf16 v[56:59], a[176:179], a[216:219], v[56:59]
s_waitcnt lgkmcnt(6)
buffer_load_dwordx4 v13, s[24:27], s43 offen offset:2048 lds
v_mfma_f32_16x16x32_bf16 v[68:71], a[180:183], a[216:219], v[68:71]
v_add_u32 v20, 20480, v252
v_mfma_f32_16x16x32_bf16 v[72:75], a[180:183], a[220:223], v[72:75]
s_mov_b32 s48, 8
ds_read_b64_tr_b16 a[148:149], v24 offset:160
ds_read_b64_tr_b16 a[150:151], v24 offset:5280
v_mfma_f32_16x16x32_bf16 v[76:79], a[180:183], a[224:227], v[76:79]
s_waitcnt lgkmcnt(6)
buffer_load_dwordx4 v14, s[24:27], s43 offen offset:3072 lds
v_mfma_f32_16x16x32_bf16 v[88:91], a[184:187], a[224:227], v[88:91]
s_add_u32 m0, s45, 86016
v_mfma_f32_16x16x32_bf16 v[84:87], a[184:187], a[220:223], v[84:87]
ds_read_b64_tr_b16 a[152:153], v23 offset:192
ds_read_b64_tr_b16 a[154:155], v23 offset:5312
v_mfma_f32_16x16x32_bf16 v[80:83], a[184:187], a[216:219], v[80:83]
s_waitcnt lgkmcnt(6)
buffer_load_dwordx4 v15, s[24:27], s43 offen offset:0 lds
v_mfma_f32_16x16x32_bf16 v[92:95], a[188:191], a[216:219], v[92:95]
v_mfma_f32_16x16x32_bf16 v[96:99], a[188:191], a[220:223], v[96:99]
ds_read_b64_tr_b16 a[156:157], v24 offset:224
ds_read_b64_tr_b16 a[158:159], v24 offset:5344
v_mfma_f32_16x16x32_bf16 v[100:103], a[188:191], a[224:227], v[100:103]
s_waitcnt lgkmcnt(6)
v_add_u32 v21, 20480, v253
v_mfma_f32_16x16x32_bf16 v[112:115], a[144:147], a[224:227], v[112:115]
v_mfma_f32_16x16x32_bf16 v[108:111], a[144:147], a[220:223], v[108:111]
ds_read_b64_tr_b16 a[160:161], v23 offset:256
ds_read_b64_tr_b16 a[162:163], v23 offset:5376
v_mfma_f32_16x16x32_bf16 v[104:107], a[144:147], a[216:219], v[104:107]
s_waitcnt lgkmcnt(6)
v_and_b32 v22, 8, v0
v_mfma_f32_16x16x32_bf16 v[116:119], a[148:151], a[216:219], v[116:119]
v_mfma_f32_16x16x32_bf16 v[120:123], a[148:151], a[220:223], v[120:123]
ds_read_b64_tr_b16 a[164:165], v24 offset:288
ds_read_b64_tr_b16 a[166:167], v24 offset:5408
v_mfma_f32_16x16x32_bf16 v[124:127], a[148:151], a[224:227], v[124:127]
s_waitcnt lgkmcnt(6)
v_mfma_f32_16x16x32_bf16 v[136:139], a[152:155], a[224:227], v[136:139]
v_mfma_f32_16x16x32_bf16 v[132:135], a[152:155], a[220:223], v[132:135]
ds_read_b64_tr_b16 a[168:169], v23 offset:10240
ds_read_b64_tr_b16 a[170:171], v23 offset:15360
v_mfma_f32_16x16x32_bf16 v[128:131], a[152:155], a[216:219], v[128:131]
s_waitcnt lgkmcnt(6)
v_mfma_f32_16x16x32_bf16 v[140:143], a[156:159], a[216:219], v[140:143]
v_mfma_f32_16x16x32_bf16 v[144:147], a[156:159], a[220:223], v[144:147]
ds_read_b64_tr_b16 a[172:173], v24 offset:10272
ds_read_b64_tr_b16 a[174:175], v24 offset:15392
v_mfma_f32_16x16x32_bf16 v[148:151], a[156:159], a[224:227], v[148:151]
s_waitcnt lgkmcnt(6)
v_mul_i32_i24 v22, s48, v22
v_mfma_f32_16x16x32_bf16 v[160:163], a[160:163], a[224:227], v[160:163]
v_mfma_f32_16x16x32_bf16 v[156:159], a[160:163], a[220:223], v[156:159]
ds_read_b64_tr_b16 a[176:177], v23 offset:10304
ds_read_b64_tr_b16 a[178:179], v23 offset:15424
v_mfma_f32_16x16x32_bf16 v[152:155], a[160:163], a[216:219], v[152:155]
s_waitcnt lgkmcnt(6)
v_mfma_f32_16x16x32_bf16 v[164:167], a[164:167], a[216:219], v[164:167]
v_mfma_f32_16x16x32_bf16 v[168:171], a[164:167], a[220:223], v[168:171]
ds_read_b64_tr_b16 a[180:181], v24 offset:10336
ds_read_b64_tr_b16 a[182:183], v24 offset:15456
v_mfma_f32_16x16x32_bf16 v[172:175], a[164:167], a[224:227], v[172:175]
s_waitcnt vmcnt(12)
s_lshl_b64 exec, 1, s36
buffer_store_dwordx2 v[6:7], v250, s[20:23], 0 offen offset:192
buffer_store_dwordx2 v[6:7], v250, s[20:23], 0 offen offset:64 sc1
s_mov_b64 exec, -1
s_waitcnt lgkmcnt(6)
v_mfma_f32_16x16x32_bf16 v[64:67], a[168:171], a[236:239], v[64:67]
v_mfma_f32_16x16x32_bf16 v[60:63], a[168:171], a[232:235], v[60:63]
ds_read_b64_tr_b16 a[184:185], v23 offset:10368
ds_read_b64_tr_b16 a[186:187], v23 offset:15488
v_mfma_f32_16x16x32_bf16 v[56:59], a[168:171], a[228:231], v[56:59]
s_waitcnt lgkmcnt(6)
v_add_u32 v22, v22, v251
s_waitcnt vmcnt(7)
v_cmp_ne_u64 vcc, s[92:93], v[4:5]
v_mfma_f32_16x16x32_bf16 v[68:71], a[172:175], a[228:231], v[68:71]
v_mfma_f32_16x16x32_bf16 v[72:75], a[172:175], a[232:235], v[72:75]
ds_read_b64_tr_b16 a[188:189], v24 offset:10400
ds_read_b64_tr_b16 a[190:191], v24 offset:15520
v_mfma_f32_16x16x32_bf16 v[76:79], a[172:175], a[236:239], v[76:79]
s_waitcnt lgkmcnt(6)
v_mfma_f32_16x16x32_bf16 v[88:91], a[176:179], a[236:239], v[88:91]
s_cbranch_vccnz L_spin1
L_spinr1:
v_mfma_f32_16x16x32_bf16 v[84:87], a[176:179], a[232:235], v[84:87]
s_add_u32 s44, s77, 1
ds_read_b64_tr_b16 a[144:145], v23 offset:10432
ds_read_b64_tr_b16 a[146:147], v23 offset:15552
v_mfma_f32_16x16x32_bf16 v[80:83], a[176:179], a[228:231], v[80:83]
s_waitcnt lgkmcnt(6)
v_mfma_f32_16x16x32_bf16 v[92:95], a[180:183], a[228:231], v[92:95]
s_mul_i32 s44, s44, 24576
v_mfma_f32_16x16x32_bf16 v[96:99], a[180:183], a[232:235], v[96:99]
ds_read_b64_tr_b16 a[148:149], v24 offset:10464
ds_read_b64_tr_b16 a[150:151], v24 offset:15584
v_mfma_f32_16x16x32_bf16 v[100:103], a[180:183], a[236:239], v[100:103]
s_waitcnt lgkmcnt(6)
buffer_load_dwordx4 a[8:11], v30, s[20:23], s44 offen offset:0 sc1
v_mfma_f32_16x16x32_bf16 v[112:115], a[184:187], a[236:239], v[112:115]
v_mfma_f32_16x16x32_bf16 v[108:111], a[184:187], a[232:235], v[108:111]
ds_read_b64_tr_b16 a[152:153], v23 offset:10496
ds_read_b64_tr_b16 a[154:155], v23 offset:15616
v_mfma_f32_16x16x32_bf16 v[104:107], a[184:187], a[228:231], v[104:107]
s_waitcnt lgkmcnt(6)
buffer_load_dwordx4 a[12:15], v30, s[20:23], s44 offen offset:1024 sc1
v_mfma_f32_16x16x32_bf16 v[116:119], a[188:191], a[228:231], v[116:119]
v_mfma_f32_16x16x32_bf16 v[120:123], a[188:191], a[232:235], v[120:123]
ds_read_b64_tr_b16 a[156:157], v24 offset:10528
ds_read_b64_tr_b16 a[158:159], v24 offset:15648
v_mfma_f32_16x16x32_bf16 v[124:127], a[188:191], a[236:239], v[124:127]
s_waitcnt lgkmcnt(6)
buffer_load_dwordx4 a[16:19], v30, s[20:23], s44 offen offset:2048 sc1
v_mfma_f32_16x16x32_bf16 v[136:139], a[144:147], a[236:239], v[136:139]
v_mfma_f32_16x16x32_bf16 v[132:135], a[144:147], a[232:235], v[132:135]
s_barrier
s_add_u32 s44, s44, 12288
v_mfma_f32_16x16x32_bf16 v[128:131], a[144:147], a[228:231], v[128:131]
s_waitcnt lgkmcnt(4)
ds_read_b64_tr_b16 a[160:161], v20 offset:0
ds_read_b64_tr_b16 a[162:163], v20 offset:5120
v_mfma_f32_16x16x32_bf16 v[140:143], a[148:151], a[228:231], v[140:143]
buffer_load_dwordx4 a[20:23], v30, s[20:23], s44 offen offset:0 sc1
v_mfma_f32_16x16x32_bf16 v[144:147], a[148:151], a[232:235], v[144:147]
ds_read_b64_tr_b16 a[164:165], v21 offset:32
ds_read_b64_tr_b16 a[166:167], v21 offset:5152
v_mfma_f32_16x16x32_bf16 v[148:151], a[148:151], a[236:239], v[148:151]
s_waitcnt lgkmcnt(6)
buffer_load_dwordx4 a[24:27], v30, s[20:23], s44 offen offset:1024 sc1
v_mfma_f32_16x16x32_bf16 v[160:163], a[152:155], a[236:239], v[160:163]
v_mfma_f32_16x16x32_bf16 v[156:159], a[152:155], a[232:235], v[156:159]
ds_read_b64_tr_b16 a[168:169], v20 offset:64
ds_read_b64_tr_b16 a[170:171], v20 offset:5184
v_mfma_f32_16x16x32_bf16 v[152:155], a[152:155], a[228:231], v[152:155]
s_waitcnt lgkmcnt(6)
buffer_load_dwordx4 a[28:31], v30, s[20:23], s44 offen offset:2048 sc1
v_mfma_f32_16x16x32_bf16 v[164:167], a[156:159], a[228:231], v[164:167]
s_add_u32 s44, s78, 1
v_mfma_f32_16x16x32_bf16 v[168:171], a[156:159], a[232:235], v[168:171]
s_mul_i32 s44, s44, 24576
ds_read_b64_tr_b16 a[172:173], v21 offset:96
ds_read_b64_tr_b16 a[174:175], v21 offset:5216
v_mfma_f32_16x16x32_bf16 v[172:175], a[156:159], a[236:239], v[172:175]
s_waitcnt lgkmcnt(6)
v_mfma_f32_16x16x32_bf16 v[64:67], a[160:163], a[248:251], v[64:67]
buffer_load_dwordx4 a[32:35], v30, s[20:23], s44 offen offset:0 sc1
v_mfma_f32_16x16x32_bf16 v[60:63], a[160:163], a[244:247], v[60:63]
ds_read_b64_tr_b16 a[176:177], v20 offset:128
ds_read_b64_tr_b16 a[178:179], v20 offset:5248
v_mfma_f32_16x16x32_bf16 v[56:59], a[160:163], a[240:243], v[56:59]
s_waitcnt lgkmcnt(6)
buffer_load_dwordx4 a[36:39], v30, s[20:23], s44 offen offset:1024 sc1
v_mfma_f32_16x16x32_bf16 v[68:71], a[164:167], a[240:243], v[68:71]
v_mfma_f32_16x16x32_bf16 v[72:75], a[164:167], a[244:247], v[72:75]
ds_read_b64_tr_b16 a[180:181], v21 offset:160
ds_read_b64_tr_b16 a[182:183], v21 offset:5280
v_mfma_f32_16x16x32_bf16 v[76:79], a[164:167], a[248:251], v[76:79]
s_waitcnt lgkmcnt(6)
buffer_load_dwordx4 a[40:43], v30, s[20:23], s44 offen offset:2048 sc1
v_mfma_f32_16x16x32_bf16 v[88:91], a[168:171], a[248:251], v[88:91]
s_add_u32 s44, s44, 12288
v_mfma_f32_16x16x32_bf16 v[84:87], a[168:171], a[244:247], v[84:87]
ds_read_b64_tr_b16 a[184:185], v20 offset:10240
ds_read_b64_tr_b16 a[186:187], v20 offset:15360
v_mfma_f32_16x16x32_bf16 v[80:83], a[168:171], a[240:243], v[80:83]
s_waitcnt lgkmcnt(6)
buffer_load_dwordx4 a[44:47], v30, s[20:23], s44 offen offset:0 sc1
v_mfma_f32_16x16x32_bf16 v[92:95], a[172:175], a[240:243], v[92:95]
v_mfma_f32_16x16x32_bf16 v[96:99], a[172:175], a[244:247], v[96:99]
ds_read_b64_tr_b16 a[188:189], v21 offset:10272
ds_read_b64_tr_b16 a[190:191], v21 offset:15392
v_mfma_f32_16x16x32_bf16 v[100:103], a[172:175], a[248:251], v[100:103]
s_waitcnt lgkmcnt(6)
buffer_load_dwordx4 a[48:51], v30, s[20:23], s44 offen offset:1024 sc1
v_mfma_f32_16x16x32_bf16 v[112:115], a[176:179], a[248:251], v[112:115]
v_mfma_f32_16x16x32_bf16 v[108:111], a[176:179], a[244:247], v[108:111]
ds_read_b64_tr_b16 a[144:145], v20 offset:10304
ds_read_b64_tr_b16 a[146:147], v20 offset:15424
v_mfma_f32_16x16x32_bf16 v[104:107], a[176:179], a[240:243], v[104:107]
s_waitcnt lgkmcnt(6)
buffer_load_dwordx4 a[52:55], v30, s[20:23], s44 offen offset:2048 sc1
v_mfma_f32_16x16x32_bf16 v[116:119], a[180:183], a[240:243], v[116:119]
v_mfma_f32_16x16x32_bf16 v[120:123], a[180:183], a[244:247], v[120:123]
ds_read_b64_tr_b16 a[148:149], v21 offset:10336
ds_read_b64_tr_b16 a[150:151], v21 offset:15456
v_mfma_f32_16x16x32_bf16 v[124:127], a[180:183], a[248:251], v[124:127]
s_waitcnt lgkmcnt(6)
buffer_load_dwordx2 v[8:9], v250, s[20:23], 0 offen offset:192 sc1
v_mfma_f32_16x16x32_bf16 v[64:67], a[184:187], a[4:7], v[64:67]
s_add_u32 s43, s77, 2
v_mfma_f32_16x16x32_bf16 v[60:63], a[184:187], a[0:3], v[60:63]
s_mul_i32 s43, s43, 81920
ds_read_b64_tr_b16 a[152:153], v20 offset:10368
ds_read_b64_tr_b16 a[154:155], v20 offset:15488
v_mfma_f32_16x16x32_bf16 v[56:59], a[184:187], a[252:255], v[56:59]
s_waitcnt lgkmcnt(6)
v_mfma_f32_16x16x32_bf16 v[68:71], a[188:191], a[252:255], v[68:71]
s_add_u32 m0, s45, 102400
v_mfma_f32_16x16x32_bf16 v[72:75], a[188:191], a[0:3], v[72:75]
ds_read_b64_tr_b16 a[156:157], v21 offset:10400
ds_read_b64_tr_b16 a[158:159], v21 offset:15520
v_mfma_f32_16x16x32_bf16 v[76:79], a[188:191], a[4:7], v[76:79]
s_waitcnt lgkmcnt(6)
buffer_load_dwordx4 v11, s[24:27], s43 offen offset:0 lds
v_mfma_f32_16x16x32_bf16 v[88:91], a[144:147], a[4:7], v[88:91]
v_mfma_f32_16x16x32_bf16 v[84:87], a[144:147], a[0:3], v[84:87]
s_barrier
v_mfma_f32_16x16x32_bf16 v[80:83], a[144:147], a[252:255], v[80:83]
s_waitcnt lgkmcnt(4)
ds_read_b64_tr_b16 a[160:161], v25 offset:0
ds_read_b64_tr_b16 a[162:163], v25 offset:5120
v_mfma_f32_16x16x32_bf16 v[92:95], a[148:151], a[252:255], v[92:95]
buffer_load_dwordx4 v12, s[24:27], s43 offen offset:1024 lds
v_mfma_f32_16x16x32_bf16 v[96:99], a[148:151], a[0:3], v[96:99]
ds_read_b64_tr_b16 a[164:165], v26 offset:32
ds_read_b64_tr_b16 a[166:167], v26 offset:5152
v_mfma_f32_16x16x32_bf16 v[100:103], a[148:151], a[4:7], v[100:103]
s_waitcnt lgkmcnt(6)
buffer_load_dwordx4 v13, s[24:27], s43 offen offset:2048 lds
v_mfma_f32_16x16x32_bf16 v[112:115], a[152:155], a[4:7], v[112:115]
v_mfma_f32_16x16x32_bf16 v[108:111], a[152:155], a[0:3], v[108:111]
ds_read_b64_tr_b16 a[168:169], v25 offset:64
ds_read_b64_tr_b16 a[170:171], v25 offset:5184
v_mfma_f32_16x16x32_bf16 v[104:107], a[152:155], a[252:255], v[104:107]
s_waitcnt lgkmcnt(6)
buffer_load_dwordx4 v14, s[24:27], s43 offen offset:3072 lds
v_mfma_f32_16x16x32_bf16 v[116:119], a[156:159], a[252:255], v[116:119]
s_add_u32 m0, s45, 106496
v_mfma_f32_16x16x32_bf16 v[120:123], a[156:159], a[0:3], v[120:123]
ds_read_b64_tr_b16 a[172:173], v26 offset:96
ds_read_b64_tr_b16 a[174:175], v26 offset:5216
v_mfma_f32_16x16x32_bf16 v[124:127], a[156:159], a[4:7], v[124:127]
s_waitcnt vmcnt(14) lgkmcnt(6)
buffer_load_dwordx4 v15, s[24:27], s43 offen offset:0 lds
v_mfma_f32_16x16x32_bf16 v[64:67], a[160:163], a[16:19], v[64:67]
s_add_u32 s44, s79, 1
v_mfma_f32_16x16x32_bf16 v[60:63], a[160:163], a[12:15], v[60:63]
ds_read_b64_tr_b16 a[176:177], v25 offset:128
ds_read_b64_tr_b16 a[178:179], v25 offset:5248
v_mfma_f32_16x16x32_bf16 v[56:59], a[160:163], a[8:11], v[56:59]
s_waitcnt lgkmcnt(6)
v_mfma_f32_16x16x32_bf16 v[68:71], a[164:167], a[8:11], v[68:71]
s_mul_i32 s44, s44, 24576
v_mfma_f32_16x16x32_bf16 v[72:75], a[164:167], a[12:15], v[72:75]
ds_read_b64_tr_b16 a[180:181], v26 offset:160
ds_read_b64_tr_b16 a[182:183], v26 offset:5280
v_mfma_f32_16x16x32_bf16 v[76:79], a[164:167], a[16:19], v[76:79]
s_waitcnt lgkmcnt(6)
buffer_load_dwordx4 a[56:59], v30, s[20:23], s44 offen offset:0 sc1
v_mfma_f32_16x16x32_bf16 v[88:91], a[168:171], a[16:19], v[88:91]
v_mfma_f32_16x16x32_bf16 v[84:87], a[168:171], a[12:15], v[84:87]
ds_read_b64_tr_b16 a[184:185], v25 offset:10240
ds_read_b64_tr_b16 a[186:187], v25 offset:15360
v_mfma_f32_16x16x32_bf16 v[80:83], a[168:171], a[8:11], v[80:83]
s_waitcnt lgkmcnt(6)
buffer_load_dwordx4 a[60:63], v30, s[20:23], s44 offen offset:1024 sc1
v_mfma_f32_16x16x32_bf16 v[92:95], a[172:175], a[8:11], v[92:95]
v_mfma_f32_16x16x32_bf16 v[96:99], a[172:175], a[12:15], v[96:99]
ds_read_b64_tr_b16 a[188:189], v26 offset:10272
ds_read_b64_tr_b16 a[190:191], v26 offset:15392
v_mfma_f32_16x16x32_bf16 v[100:103], a[172:175], a[16:19], v[100:103]
s_waitcnt lgkmcnt(6)
buffer_load_dwordx4 a[64:67], v30, s[20:23], s44 offen offset:2048 sc1
v_mfma_f32_16x16x32_bf16 v[112:115], a[176:179], a[16:19], v[112:115]
s_add_u32 s44, s44, 12288
v_mfma_f32_16x16x32_bf16 v[108:111], a[176:179], a[12:15], v[108:111]
ds_read_b64_tr_b16 a[144:145], v25 offset:10304
ds_read_b64_tr_b16 a[146:147], v25 offset:15424
v_mfma_f32_16x16x32_bf16 v[104:107], a[176:179], a[8:11], v[104:107]
s_waitcnt lgkmcnt(6)
buffer_load_dwordx4 a[68:71], v30, s[20:23], s44 offen offset:0 sc1
v_mfma_f32_16x16x32_bf16 v[116:119], a[180:183], a[8:11], v[116:119]
v_mfma_f32_16x16x32_bf16 v[120:123], a[180:183], a[12:15], v[120:123]
ds_read_b64_tr_b16 a[148:149], v26 offset:10336
ds_read_b64_tr_b16 a[150:151], v26 offset:15456
v_mfma_f32_16x16x32_bf16 v[124:127], a[180:183], a[16:19], v[124:127]
s_waitcnt vmcnt(16) lgkmcnt(6)
buffer_load_dwordx4 a[72:75], v30, s[20:23], s44 offen offset:1024 sc1
v_mfma_f32_16x16x32_bf16 v[64:67], a[184:187], a[28:31], v[64:67]
v_mfma_f32_16x16x32_bf16 v[60:63], a[184:187], a[24:27], v[60:63]
ds_read_b64_tr_b16 a[152:153], v25 offset:10368
ds_read_b64_tr_b16 a[154:155], v25 offset:15488
v_mfma_f32_16x16x32_bf16 v[56:59], a[184:187], a[20:23], v[56:59]
s_waitcnt lgkmcnt(6)
buffer_load_dwordx4 a[76:79], v30, s[20:23], s44 offen offset:2048 sc1
v_mfma_f32_16x16x32_bf16 v[68:71], a[188:191], a[20:23], v[68:71]
s_waitcnt vmcnt(11)
v_cmp_ne_u64 vcc, s[92:93], v[8:9]
v_mfma_f32_16x16x32_bf16 v[72:75], a[188:191], a[24:27], v[72:75]
ds_read_b64_tr_b16 a[156:157], v26 offset:10400
ds_read_b64_tr_b16 a[158:159], v26 offset:15520
v_mfma_f32_16x16x32_bf16 v[76:79], a[188:191], a[28:31], v[76:79]
s_waitcnt lgkmcnt(6)
v_mfma_f32_16x16x32_bf16 v[88:91], a[144:147], a[28:31], v[88:91]
v_mfma_f32_16x16x32_bf16 v[84:87], a[144:147], a[24:27], v[84:87]
s_barrier
s_cbranch_vccnz L_spin2
L_spinr2:
v_mfma_f32_16x16x32_bf16 v[80:83], a[144:147], a[20:23], v[80:83]
s_waitcnt lgkmcnt(4)
ds_read_b64_tr_b16 a[160:161], v25 offset:20480
ds_read_b64_tr_b16 a[162:163], v25 offset:25600
v_mfma_f32_16x16x32_bf16 v[92:95], a[148:151], a[20:23], v[92:95]
s_add_u32 s44, s77, 2
v_mfma_f32_16x16x32_bf16 v[96:99], a[148:151], a[24:27], v[96:99]
s_mul_i32 s44, s44, 24576
ds_read_b64_tr_b16 a[164:165], v26 offset:20512
ds_read_b64_tr_b16 a[166:167], v26 offset:25632
v_mfma_f32_16x16x32_bf16 v[100:103], a[148:151], a[28:31], v[100:103]
s_waitcnt lgkmcnt(6)
buffer_load_dwordx4 a[80:83], v30, s[20:23], s44 offen offset:0 sc1
v_mfma_f32_16x16x32_bf16 v[112:115], a[152:155], a[28:31], v[112:115]
v_mfma_f32_16x16x32_bf16 v[108:111], a[152:155], a[24:27], v[108:111]
ds_read_b64_tr_b16 a[168:169], v25 offset:20544
ds_read_b64_tr_b16 a[170:171], v25 offset:25664
v_mfma_f32_16x16x32_bf16 v[104:107], a[152:155], a[20:23], v[104:107]
s_waitcnt lgkmcnt(6)
buffer_load_dwordx4 a[84:87], v30, s[20:23], s44 offen offset:1024 sc1
v_mfma_f32_16x16x32_bf16 v[116:119], a[156:159], a[20:23], v[116:119]
v_mfma_f32_16x16x32_bf16 v[120:123], a[156:159], a[24:27], v[120:123]
ds_read_b64_tr_b16 a[172:173], v26 offset:20576
ds_read_b64_tr_b16 a[174:175], v26 offset:25696
v_mfma_f32_16x16x32_bf16 v[124:127], a[156:159], a[28:31], v[124:127]
s_waitcnt lgkmcnt(6)
buffer_load_dwordx4 a[88:91], v30, s[20:23], s44 offen offset:2048 sc1
v_mfma_f32_16x16x32_bf16 v[64:67], a[160:163], a[40:43], v[64:67]
s_add_u32 s44, s44, 12288
v_mfma_f32_16x16x32_bf16 v[60:63], a[160:163], a[36:39], v[60:63]
ds_read_b64_tr_b16 a[176:177], v25 offset:20608
ds_read_b64_tr_b16 a[178:179], v25 offset:25728
v_mfma_f32_16x16x32_bf16 v[56:59], a[160:163], a[32:35], v[56:59]
s_waitcnt lgkmcnt(6)
buffer_load_dwordx4 a[92:95], v30, s[20:23], s44 offen offset:0 sc1
v_mfma_f32_16x16x32_bf16 v[68:71], a[164:167], a[32:35], v[68:71]
v_mfma_f32_16x16x32_bf16 v[72:75], a[164:167], a[36:39], v[72:75]
ds_read_b64_tr_b16 a[180:181], v26 offset:20640
ds_read_b64_tr_b16 a[182:183], v26 offset:25760
v_mfma_f32_16x16x32_bf16 v[76:79], a[164:167], a[40:43], v[76:79]
s_waitcnt lgkmcnt(6)
buffer_load_dwordx4 a[96:99], v30, s[20:23], s44 offen offset:1024 sc1
v_mfma_f32_16x16x32_bf16 v[88:91], a[168:171], a[40:43], v[88:91]
v_mfma_f32_16x16x32_bf16 v[84:87], a[168:171], a[36:39], v[84:87]
ds_read_b64_tr_b16 a[184:185], v25 offset:30720
ds_read_b64_tr_b16 a[186:187], v25 offset:35840
v_mfma_f32_16x16x32_bf16 v[80:83], a[168:171], a[32:35], v[80:83]
s_waitcnt lgkmcnt(6)
buffer_load_dwordx4 a[100:103], v30, s[20:23], s44 offen offset:2048 sc1
v_mfma_f32_16x16x32_bf16 v[92:95], a[172:175], a[32:35], v[92:95]
s_add_u32 s43, s78, 2
v_mfma_f32_16x16x32_bf16 v[96:99], a[172:175], a[36:39], v[96:99]
s_mul_i32 s43, s43, 81920
ds_read_b64_tr_b16 a[188:189], v26 offset:30752
ds_read_b64_tr_b16 a[190:191], v26 offset:35872
v_mfma_f32_16x16x32_bf16 v[100:103], a[172:175], a[40:43], v[100:103]
s_waitcnt lgkmcnt(6)
v_mfma_f32_16x16x32_bf16 v[112:115], a[176:179], a[40:43], v[112:115]
s_add_u32 m0, s45, 122880
v_mfma_f32_16x16x32_bf16 v[108:111], a[176:179], a[36:39], v[108:111]
ds_read_b64_tr_b16 a[144:145], v25 offset:30784
ds_read_b64_tr_b16 a[146:147], v25 offset:35904
v_mfma_f32_16x16x32_bf16 v[104:107], a[176:179], a[32:35], v[104:107]
s_waitcnt lgkmcnt(6)
buffer_load_dwordx4 v11, s[24:27], s43 offen offset:0 lds
v_mfma_f32_16x16x32_bf16 v[116:119], a[180:183], a[32:35], v[116:119]
v_mfma_f32_16x16x32_bf16 v[120:123], a[180:183], a[36:39], v[120:123]
ds_read_b64_tr_b16 a[148:149], v26 offset:30816
ds_read_b64_tr_b16 a[150:151], v26 offset:35936
v_mfma_f32_16x16x32_bf16 v[124:127], a[180:183], a[40:43], v[124:127]
s_waitcnt lgkmcnt(6)
buffer_load_dwordx4 v12, s[24:27], s43 offen offset:1024 lds
v_mfma_f32_16x16x32_bf16 v[64:67], a[184:187], a[52:55], v[64:67]
v_mfma_f32_16x16x32_bf16 v[60:63], a[184:187], a[48:51], v[60:63]
ds_read_b64_tr_b16 a[152:153], v25 offset:30848
ds_read_b64_tr_b16 a[154:155], v25 offset:35968
v_mfma_f32_16x16x32_bf16 v[56:59], a[184:187], a[44:47], v[56:59]
s_waitcnt lgkmcnt(6)
buffer_load_dwordx4 v13, s[24:27], s43 offen offset:2048 lds
v_mfma_f32_16x16x32_bf16 v[68:71], a[188:191], a[44:47], v[68:71]
v_mfma_f32_16x16x32_bf16 v[72:75], a[188:191], a[48:51], v[72:75]
ds_read_b64_tr_b16 a[156:157], v26 offset:30880
ds_read_b64_tr_b16 a[158:159], v26 offset:36000
v_mfma_f32_16x16x32_bf16 v[76:79], a[188:191], a[52:55], v[76:79]
s_waitcnt lgkmcnt(6)
buffer_load_dwordx4 v14, s[24:27], s43 offen offset:3072 lds
v_mfma_f32_16x16x32_bf16 v[88:91], a[144:147], a[52:55], v[88:91]
v_mfma_f32_16x16x32_bf16 v[84:87], a[144:147], a[48:51], v[84:87]
s_barrier
s_add_u32 m0, s45, 126976
v_mfma_f32_16x16x32_bf16 v[80:83], a[144:147], a[44:47], v[80:83]
s_waitcnt lgkmcnt(4)
ds_read_b64_tr_b16 a[160:161], v25 offset:40960
ds_read_b64_tr_b16 a[162:163], v25 offset:46080
v_mfma_f32_16x16x32_bf16 v[92:95], a[148:151], a[44:47], v[92:95]
buffer_load_dwordx4 v15, s[24:27], s43 offen offset:0 lds
v_mfma_f32_16x16x32_bf16 v[96:99], a[148:151], a[48:51], v[96:99]
s_add_u32 s44, s78, 2
ds_read_b64_tr_b16 a[164:165], v26 offset:40992
ds_read_b64_tr_b16 a[166:167], v26 offset:46112
v_mfma_f32_16x16x32_bf16 v[100:103], a[148:151], a[52:55], v[100:103]
s_waitcnt lgkmcnt(6)
v_mfma_f32_16x16x32_bf16 v[112:115], a[152:155], a[52:55], v[112:115]
s_mul_i32 s44, s44, 24576
v_mfma_f32_16x16x32_bf16 v[108:111], a[152:155], a[48:51], v[108:111]
ds_read_b64_tr_b16 a[168:169], v25 offset:41024
ds_read_b64_tr_b16 a[170:171], v25 offset:46144
v_mfma_f32_16x16x32_bf16 v[104:107], a[152:155], a[44:47], v[104:107]
s_waitcnt lgkmcnt(6)
buffer_load_dwordx4 a[104:107], v30, s[20:23], s44 offen offset:0 sc1
v_mfma_f32_16x16x32_bf16 v[116:119], a[156:159], a[44:47], v[116:119]
v_mfma_f32_16x16x32_bf16 v[120:123], a[156:159], a[48:51], v[120:123]
ds_read_b64_tr_b16 a[172:173], v26 offset:41056
ds_read_b64_tr_b16 a[174:175], v26 offset:46176
v_mfma_f32_16x16x32_bf16 v[124:127], a[156:159], a[52:55], v[124:127]
s_waitcnt vmcnt(15) lgkmcnt(6)
buffer_load_dwordx4 a[108:111], v30, s[20:23], s44 offen offset:1024 sc1
v_mfma_f32_16x16x32_bf16 v[64:67], a[160:163], a[64:67], v[64:67]
v_mfma_f32_16x16x32_bf16 v[60:63], a[160:163], a[60:63], v[60:63]
ds_read_b64_tr_b16 a[176:177], v25 offset:41088
ds_read_b64_tr_b16 a[178:179], v25 offset:46208
v_mfma_f32_16x16x32_bf16 v[56:59], a[160:163], a[56:59], v[56:59]
s_waitcnt lgkmcnt(6)
buffer_load_dwordx4 a[112:115], v30, s[20:23], s44 offen offset:2048 sc1
v_mfma_f32_16x16x32_bf16 v[68:71], a[164:167], a[56:59], v[68:71]
s_add_u32 s44, s44, 12288
v_mfma_f32_16x16x32_bf16 v[72:75], a[164:167], a[60:63], v[72:75]
ds_read_b64_tr_b16 a[180:181], v26 offset:41120
ds_read_b64_tr_b16 a[182:183], v26 offset:46240
v_mfma_f32_16x16x32_bf16 v[76:79], a[164:167], a[64:67], v[76:79]
s_waitcnt lgkmcnt(6)
buffer_load_dwordx4 a[116:119], v30, s[20:23], s44 offen offset:0 sc1
v_mfma_f32_16x16x32_bf16 v[88:91], a[168:171], a[64:67], v[88:91]
v_mfma_f32_16x16x32_bf16 v[84:87], a[168:171], a[60:63], v[84:87]
ds_read_b64_tr_b16 a[184:185], v25 offset:51200
ds_read_b64_tr_b16 a[186:187], v25 offset:56320
v_mfma_f32_16x16x32_bf16 v[80:83], a[168:171], a[56:59], v[80:83]
s_waitcnt lgkmcnt(6)
buffer_load_dwordx4 a[120:123], v30, s[20:23], s44 offen offset:1024 sc1
v_mfma_f32_16x16x32_bf16 v[92:95], a[172:175], a[56:59], v[92:95]
v_mfma_f32_16x16x32_bf16 v[96:99], a[172:175], a[60:63], v[96:99]
ds_read_b64_tr_b16 a[188:189], v26 offset:51232
ds_read_b64_tr_b16 a[190:191], v26 offset:56352
v_mfma_f32_16x16x32_bf16 v[100:103], a[172:175], a[64:67], v[100:103]
s_waitcnt lgkmcnt(6)
buffer_load_dwordx4 a[124:127], v30, s[20:23], s44 offen offset:2048 sc1
v_mfma_f32_16x16x32_bf16 v[112:115], a[176:179], a[64:67], v[112:115]
s_add_u32 s43, s79, 2
v_mfma_f32_16x16x32_bf16 v[108:111], a[176:179], a[60:63], v[108:111]
s_mul_i32 s43, s43, 81920
ds_read_b64_tr_b16 a[144:145], v25 offset:51264
ds_read_b64_tr_b16 a[146:147], v25 offset:56384
v_mfma_f32_16x16x32_bf16 v[104:107], a[176:179], a[56:59], v[104:107]
s_waitcnt lgkmcnt(6)
v_mfma_f32_16x16x32_bf16 v[116:119], a[180:183], a[56:59], v[116:119]
s_add_u32 m0, s45, 143360
v_mfma_f32_16x16x32_bf16 v[120:123], a[180:183], a[60:63], v[120:123]
ds_read_b64_tr_b16 a[148:149], v26 offset:51296
ds_read_b64_tr_b16 a[150:151], v26 offset:56416
v_mfma_f32_16x16x32_bf16 v[124:127], a[180:183], a[64:67], v[124:127]
s_waitcnt vmcnt(17) lgkmcnt(6)
buffer_load_dwordx4 v11, s[24:27], s43 offen offset:0 lds
v_mfma_f32_16x16x32_bf16 v[64:67], a[184:187], a[76:79], v[64:67]
v_mfma_f32_16x16x32_bf16 v[60:63], a[184:187], a[72:75], v[60:63]
ds_read_b64_tr_b16 a[152:153], v25 offset:51328
ds_read_b64_tr_b16 a[154:155], v25 offset:56448
v_mfma_f32_16x16x32_bf16 v[56:59], a[184:187], a[68:71], v[56:59]
s_waitcnt lgkmcnt(6)
buffer_load_dwordx4 v12, s[24:27], s43 offen offset:1024 lds
v_mfma_f32_16x16x32_bf16 v[68:71], a[188:191], a[68:71], v[68:71]
v_mfma_f32_16x16x32_bf16 v[72:75], a[188:191], a[72:75], v[72:75]
ds_read_b64_tr_b16 a[156:157], v26 offset:51360
ds_read_b64_tr_b16 a[158:159], v26 offset:56480
v_mfma_f32_16x16x32_bf16 v[76:79], a[188:191], a[76:79], v[76:79]
s_waitcnt lgkmcnt(6)
buffer_load_dwordx4 v13, s[24:27], s43 offen offset:2048 lds
v_mfma_f32_16x16x32_bf16 v[88:91], a[144:147], a[76:79], v[88:91]
v_mfma_f32_16x16x32_bf16 v[84:87], a[144:147], a[72:75], v[84:87]
s_barrier
v_mfma_f32_16x16x32_bf16 v[80:83], a[144:147], a[68:71], v[80:83]
s_waitcnt lgkmcnt(4)
ds_read_b64_tr_b16 a[160:161], v16 offset:0
ds_read_b64_tr_b16 a[162:163], v16 offset:5120
v_mfma_f32_16x16x32_bf16 v[92:95], a[148:151], a[68:71], v[92:95]
buffer_load_dwordx4 v14, s[24:27], s43 offen offset:3072 lds
v_mfma_f32_16x16x32_bf16 v[96:99], a[148:151], a[72:75], v[96:99]
s_add_u32 m0, s45, 147456
ds_read_b64_tr_b16 a[164:165], v17 offset:32
ds_read_b64_tr_b16 a[166:167], v17 offset:5152
v_mfma_f32_16x16x32_bf16 v[100:103], a[148:151], a[76:79], v[100:103]
s_waitcnt lgkmcnt(6)
buffer_load_dwordx4 v15, s[24:27], s43 offen offset:0 lds
v_mfma_f32_16x16x32_bf16 v[112:115], a[152:155], a[76:79], v[112:115]
s_add_u32 s44, s79, 2
v_mfma_f32_16x16x32_bf16 v[108:111], a[152:155], a[72:75], v[108:111]
s_mul_i32 s44, s44, 24576
ds_read_b64_tr_b16 a[168:169], v16 offset:64
ds_read_b64_tr_b16 a[170:171], v16 offset:5184
v_mfma_f32_16x16x32_bf16 v[104:107], a[152:155], a[68:71], v[104:107]
s_waitcnt lgkmcnt(6)
buffer_load_dwordx4 a[128:131], v30, s[20:23], s44 offen offset:0 sc1
v_mfma_f32_16x16x32_bf16 v[116:119], a[156:159], a[68:71], v[116:119]
v_mfma_f32_16x16x32_bf16 v[120:123], a[156:159], a[72:75], v[120:123]
ds_read_b64_tr_b16 a[172:173], v17 offset:96
ds_read_b64_tr_b16 a[174:175], v17 offset:5216
v_mfma_f32_16x16x32_bf16 v[124:127], a[156:159], a[76:79], v[124:127]
s_waitcnt vmcnt(20) lgkmcnt(6)
buffer_load_dwordx4 a[132:135], v30, s[20:23], s44 offen offset:1024 sc1
v_mfma_f32_16x16x32_bf16 v[64:67], a[160:163], a[88:91], v[64:67]
v_mfma_f32_16x16x32_bf16 v[60:63], a[160:163], a[84:87], v[60:63]
ds_read_b64_tr_b16 a[176:177], v16 offset:128
ds_read_b64_tr_b16 a[178:179], v16 offset:5248
v_mfma_f32_16x16x32_bf16 v[56:59], a[160:163], a[80:83], v[56:59]
s_waitcnt lgkmcnt(6)
buffer_load_dwordx4 a[136:139], v30, s[20:23], s44 offen offset:2048 sc1
v_mfma_f32_16x16x32_bf16 v[68:71], a[164:167], a[80:83], v[68:71]
s_add_u32 s44, s44, 12288
v_mfma_f32_16x16x32_bf16 v[72:75], a[164:167], a[84:87], v[72:75]
ds_read_b64_tr_b16 a[180:181], v17 offset:160
ds_read_b64_tr_b16 a[182:183], v17 offset:5280
v_mfma_f32_16x16x32_bf16 v[76:79], a[164:167], a[88:91], v[76:79]
s_waitcnt lgkmcnt(6)
buffer_load_dwordx4 a[140:143], v30, s[20:23], s44 offen offset:0 sc1
v_mfma_f32_16x16x32_bf16 v[88:91], a[168:171], a[88:91], v[88:91]
v_mfma_f32_16x16x32_bf16 v[84:87], a[168:171], a[84:87], v[84:87]
ds_read_b64_tr_b16 a[184:185], v16 offset:10240
ds_read_b64_tr_b16 a[186:187], v16 offset:15360
v_mfma_f32_16x16x32_bf16 v[80:83], a[168:171], a[80:83], v[80:83]
s_waitcnt lgkmcnt(6)
buffer_load_dwordx4 v[32:35], v30, s[20:23], s44 offen offset:1024 sc1
v_mfma_f32_16x16x32_bf16 v[92:95], a[172:175], a[80:83], v[92:95]
v_mfma_f32_16x16x32_bf16 v[96:99], a[172:175], a[84:87], v[96:99]
ds_read_b64_tr_b16 a[188:189], v17 offset:10272
ds_read_b64_tr_b16 a[190:191], v17 offset:15392
v_mfma_f32_16x16x32_bf16 v[100:103], a[172:175], a[88:91], v[100:103]
s_waitcnt lgkmcnt(6)
buffer_load_dwordx4 v[36:39], v30, s[20:23], s44 offen offset:2048 sc1
v_mfma_f32_16x16x32_bf16 v[112:115], a[176:179], a[88:91], v[112:115]
v_mfma_f32_16x16x32_bf16 v[108:111], a[176:179], a[84:87], v[108:111]
ds_read_b64_tr_b16 a[144:145], v16 offset:10304
ds_read_b64_tr_b16 a[146:147], v16 offset:15424
v_mfma_f32_16x16x32_bf16 v[104:107], a[176:179], a[80:83], v[104:107]
s_waitcnt lgkmcnt(6)
v_mfma_f32_16x16x32_bf16 v[116:119], a[180:183], a[80:83], v[116:119]
v_mfma_f32_16x16x32_bf16 v[120:123], a[180:183], a[84:87], v[120:123]
ds_read_b64_tr_b16 a[148:149], v17 offset:10336
ds_read_b64_tr_b16 a[150:151], v17 offset:15456
v_mfma_f32_16x16x32_bf16 v[124:127], a[180:183], a[88:91], v[124:127]
s_waitcnt vmcnt(22) lgkmcnt(6)
v_mfma_f32_16x16x32_bf16 v[64:67], a[184:187], a[100:103], v[64:67]
v_mfma_f32_16x16x32_bf16 v[60:63], a[184:187], a[96:99], v[60:63]
ds_read_b64_tr_b16 a[152:153], v16 offset:10368
ds_read_b64_tr_b16 a[154:155], v16 offset:15488
v_mfma_f32_16x16x32_bf16 v[56:59], a[184:187], a[92:95], v[56:59]
s_waitcnt lgkmcnt(6)
v_mfma_f32_16x16x32_bf16 v[68:71], a[188:191], a[92:95], v[68:71]
v_mfma_f32_16x16x32_bf16 v[72:75], a[188:191], a[96:99], v[72:75]
ds_read_b64_tr_b16 a[156:157], v17 offset:10400
ds_read_b64_tr_b16 a[158:159], v17 offset:15520
v_mfma_f32_16x16x32_bf16 v[76:79], a[188:191], a[100:103], v[76:79]
s_waitcnt lgkmcnt(6)
v_mfma_f32_16x16x32_bf16 v[88:91], a[144:147], a[100:103], v[88:91]
s_waitcnt vmcnt(6)
v_mfma_f32_16x16x32_bf16 v[84:87], a[144:147], a[96:99], v[84:87]
s_barrier
v_mfma_f32_16x16x32_bf16 v[80:83], a[144:147], a[92:95], v[80:83]
s_waitcnt lgkmcnt(4)
ds_read_b64_tr_b16 a[160:161], v16 offset:20480
ds_read_b64_tr_b16 a[162:163], v16 offset:25600
v_mfma_f32_16x16x32_bf16 v[92:95], a[148:151], a[92:95], v[92:95]
ds_read_b64_tr_b16 a[164:165], v16 offset:30720
ds_read_b64_tr_b16 a[166:167], v16 offset:35840
v_mfma_f32_16x16x32_bf16 v[96:99], a[148:151], a[96:99], v[96:99]
v_mfma_f32_16x16x32_bf16 v[100:103], a[148:151], a[100:103], v[100:103]
s_waitcnt lgkmcnt(6)
v_mfma_f32_16x16x32_bf16 v[112:115], a[152:155], a[100:103], v[112:115]
ds_read_b64_tr_b16 a[168:169], v16 offset:40960
ds_read_b64_tr_b16 a[170:171], v16 offset:46080
v_mfma_f32_16x16x32_bf16 v[108:111], a[152:155], a[96:99], v[108:111]
v_mfma_f32_16x16x32_bf16 v[104:107], a[152:155], a[92:95], v[104:107]
s_waitcnt lgkmcnt(6)
v_mfma_f32_16x16x32_bf16 v[116:119], a[156:159], a[92:95], v[116:119]
ds_read_b64_tr_b16 a[172:173], v16 offset:51200
ds_read_b64_tr_b16 a[174:175], v16 offset:56320
v_mfma_f32_16x16x32_bf16 v[120:123], a[156:159], a[96:99], v[120:123]
v_mfma_f32_16x16x32_bf16 v[124:127], a[156:159], a[100:103], v[124:127]
s_waitcnt lgkmcnt(6)
v_mfma_f32_16x16x32_bf16 v[64:67], a[160:163], a[112:115], v[64:67]
ds_read_b64_tr_b16 a[176:177], v17 offset:20512
ds_read_b64_tr_b16 a[178:179], v17 offset:25632
v_mfma_f32_16x16x32_bf16 v[60:63], a[160:163], a[108:111], v[60:63]
v_mfma_f32_16x16x32_bf16 v[56:59], a[160:163], a[104:107], v[56:59]
s_waitcnt lgkmcnt(6)
v_mfma_f32_16x16x32_bf16 v[56:59], a[164:167], a[116:119], v[56:59]
ds_read_b64_tr_b16 a[180:181], v17 offset:30752
ds_read_b64_tr_b16 a[182:183], v17 offset:35872
v_mfma_f32_16x16x32_bf16 v[60:63], a[164:167], a[120:123], v[60:63]
v_mfma_f32_16x16x32_bf16 v[64:67], a[164:167], a[124:127], v[64:67]
s_waitcnt vmcnt(3) lgkmcnt(6)
v_mfma_f32_16x16x32_bf16 v[64:67], a[168:171], a[136:139], v[64:67]
ds_read_b64_tr_b16 a[184:185], v17 offset:40992
ds_read_b64_tr_b16 a[186:187], v17 offset:46112
v_mfma_f32_16x16x32_bf16 v[60:63], a[168:171], a[132:135], v[60:63]
v_mfma_f32_16x16x32_bf16 v[56:59], a[168:171], a[128:131], v[56:59]
s_waitcnt vmcnt(2) lgkmcnt(6)
v_mfma_f32_16x16x32_bf16 v[56:59], a[172:175], a[140:143], v[56:59]
s_waitcnt vmcnt(1)
ds_read_b64_tr_b16 a[188:189], v17 offset:51232
ds_read_b64_tr_b16 a[190:191], v17 offset:56352
v_mfma_f32_16x16x32_bf16 v[60:63], a[172:175], v[32:35], v[60:63]
s_waitcnt vmcnt(0)
v_mfma_f32_16x16x32_bf16 v[64:67], a[172:175], v[36:39], v[64:67]
s_waitcnt lgkmcnt(6)
v_mfma_f32_16x16x32_bf16 v[76:79], a[176:179], a[112:115], v[76:79]
ds_read_b64_tr_b16 a[144:145], v16 offset:20544
ds_read_b64_tr_b16 a[146:147], v16 offset:25664
v_mfma_f32_16x16x32_bf16 v[72:75], a[176:179], a[108:111], v[72:75]
v_mfma_f32_16x16x32_bf16 v[68:71], a[176:179], a[104:107], v[68:71]
s_waitcnt lgkmcnt(6)
v_mfma_f32_16x16x32_bf16 v[68:71], a[180:183], a[116:119], v[68:71]
ds_read_b64_tr_b16 a[148:149], v16 offset:30784
ds_read_b64_tr_b16 a[150:151], v16 offset:35904
v_mfma_f32_16x16x32_bf16 v[72:75], a[180:183], a[120:123], v[72:75]
v_mfma_f32_16x16x32_bf16 v[76:79], a[180:183], a[124:127], v[76:79]
s_waitcnt lgkmcnt(6)
v_mfma_f32_16x16x32_bf16 v[76:79], a[184:187], a[136:139], v[76:79]
ds_read_b64_tr_b16 a[152:153], v16 offset:41024
ds_read_b64_tr_b16 a[154:155], v16 offset:46144
v_mfma_f32_16x16x32_bf16 v[72:75], a[184:187], a[132:135], v[72:75]
v_mfma_f32_16x16x32_bf16 v[68:71], a[184:187], a[128:131], v[68:71]
s_waitcnt lgkmcnt(6)
v_mfma_f32_16x16x32_bf16 v[68:71], a[188:191], a[140:143], v[68:71]
ds_read_b64_tr_b16 a[156:157], v16 offset:51264
ds_read_b64_tr_b16 a[158:159], v16 offset:56384
v_mfma_f32_16x16x32_bf16 v[72:75], a[188:191], v[32:35], v[72:75]
v_mfma_f32_16x16x32_bf16 v[76:79], a[188:191], v[36:39], v[76:79]
s_waitcnt lgkmcnt(6)
v_mfma_f32_16x16x32_bf16 v[88:91], a[144:147], a[112:115], v[88:91]
ds_read_b64_tr_b16 a[160:161], v17 offset:20576
ds_read_b64_tr_b16 a[162:163], v17 offset:25696
v_mfma_f32_16x16x32_bf16 v[84:87], a[144:147], a[108:111], v[84:87]
v_mfma_f32_16x16x32_bf16 v[80:83], a[144:147], a[104:107], v[80:83]
s_waitcnt lgkmcnt(6)
v_mfma_f32_16x16x32_bf16 v[80:83], a[148:151], a[116:119], v[80:83]
ds_read_b64_tr_b16 a[164:165], v17 offset:30816
ds_read_b64_tr_b16 a[166:167], v17 offset:35936
v_mfma_f32_16x16x32_bf16 v[84:87], a[148:151], a[120:123], v[84:87]
v_cvt_pk_bf16_f32 v184, v56, v57
v_cvt_pk_bf16_f32 v185, v58, v59
v_mfma_f32_16x16x32_bf16 v[88:91], a[148:151], a[124:127], v[88:91]
s_waitcnt lgkmcnt(6)
v_cvt_pk_bf16_f32 v186, v68, v69
v_mfma_f32_16x16x32_bf16 v[88:91], a[152:155], a[136:139], v[88:91]
ds_read_b64_tr_b16 a[168:169], v17 offset:41056
ds_read_b64_tr_b16 a[170:171], v17 offset:46176
v_mfma_f32_16x16x32_bf16 v[84:87], a[152:155], a[132:135], v[84:87]
v_cvt_pk_bf16_f32 v187, v70, v71
v_mfma_f32_16x16x32_bf16 v[80:83], a[152:155], a[128:131], v[80:83]
s_waitcnt lgkmcnt(6)
v_mfma_f32_16x16x32_bf16 v[80:83], a[156:159], a[140:143], v[80:83]
s_add_u32 s47, s41, 0
ds_read_b64_tr_b16 a[172:173], v17 offset:51296
ds_read_b64_tr_b16 a[174:175], v17 offset:56416
v_mfma_f32_16x16x32_bf16 v[84:87], a[156:159], v[32:35], v[84:87]
s_cmp_eq_u32 s33, 0
s_cselect_b32 s49, 2130706432, s47
s_cbranch_scc1 L_own0
L_ownr0:
v_mfma_f32_16x16x32_bf16 v[88:91], a[156:159], v[36:39], v[88:91]
s_waitcnt lgkmcnt(6)
buffer_store_dwordx4 v[184:187], v31, s[20:23], s49 offen offset:0 sc1
v_mfma_f32_16x16x32_bf16 v[100:103], a[160:163], a[112:115], v[100:103]
ds_read_b64_tr_b16 a[176:177], v16 offset:20608
ds_read_b64_tr_b16 a[178:179], v16 offset:25728
v_mfma_f32_16x16x32_bf16 v[96:99], a[160:163], a[108:111], v[96:99]
v_cvt_pk_bf16_f32 v196, v60, v61
v_cvt_pk_bf16_f32 v197, v62, v63
v_mfma_f32_16x16x32_bf16 v[92:95], a[160:163], a[104:107], v[92:95]
s_waitcnt lgkmcnt(6)
v_cvt_pk_bf16_f32 v198, v72, v73
v_cvt_pk_bf16_f32 v199, v74, v75
v_mfma_f32_16x16x32_bf16 v[92:95], a[164:167], a[116:119], v[92:95]
ds_read_b64_tr_b16 a[180:181], v16 offset:30848
ds_read_b64_tr_b16 a[182:183], v16 offset:35968
v_mfma_f32_16x16x32_bf16 v[96:99], a[164:167], a[120:123], v[96:99]
s_cmp_eq_u32 s33, 1
s_cselect_b32 s49, 2130706432, s47
s_cbranch_scc1 L_own1
L_ownr1:
v_mfma_f32_16x16x32_bf16 v[100:103], a[164:167], a[124:127], v[100:103]
s_waitcnt lgkmcnt(6)
buffer_store_dwordx4 v[196:199], v31, s[20:23], s49 offen offset:1024 sc1
v_mfma_f32_16x16x32_bf16 v[100:103], a[168:171], a[136:139], v[100:103]
ds_read_b64_tr_b16 a[184:185], v16 offset:41088
ds_read_b64_tr_b16 a[186:187], v16 offset:46208
v_mfma_f32_16x16x32_bf16 v[96:99], a[168:171], a[132:135], v[96:99]
v_cvt_pk_bf16_f32 v208, v64, v65
v_cvt_pk_bf16_f32 v209, v66, v67
v_mfma_f32_16x16x32_bf16 v[92:95], a[168:171], a[128:131], v[92:95]
s_waitcnt lgkmcnt(6)
v_cvt_pk_bf16_f32 v210, v76, v77
v_cvt_pk_bf16_f32 v211, v78, v79
v_mfma_f32_16x16x32_bf16 v[92:95], a[172:175], a[140:143], v[92:95]
ds_read_b64_tr_b16 a[188:189], v16 offset:51328
ds_read_b64_tr_b16 a[190:191], v16 offset:56448
v_mfma_f32_16x16x32_bf16 v[96:99], a[172:175], v[32:35], v[96:99]
s_cmp_eq_u32 s33, 2
s_cselect_b32 s49, 2130706432, s47
s_cbranch_scc1 L_own2
L_ownr2:
v_mfma_f32_16x16x32_bf16 v[100:103], a[172:175], v[36:39], v[100:103]
s_waitcnt lgkmcnt(6)
buffer_store_dwordx4 v[208:211], v31, s[20:23], s49 offen offset:2048 sc1
v_mfma_f32_16x16x32_bf16 v[112:115], a[176:179], a[112:115], v[112:115]
ds_read_b64_tr_b16 a[144:145], v17 offset:20640
ds_read_b64_tr_b16 a[146:147], v17 offset:25760
v_mfma_f32_16x16x32_bf16 v[108:111], a[176:179], a[108:111], v[108:111]
v_mfma_f32_16x16x32_bf16 v[104:107], a[176:179], a[104:107], v[104:107]
s_waitcnt lgkmcnt(6)
v_mfma_f32_16x16x32_bf16 v[104:107], a[180:183], a[116:119], v[104:107]
ds_read_b64_tr_b16 a[148:149], v17 offset:30880
ds_read_b64_tr_b16 a[150:151], v17 offset:36000
v_mfma_f32_16x16x32_bf16 v[108:111], a[180:183], a[120:123], v[108:111]
v_cvt_pk_bf16_f32 v220, v80, v81
v_cvt_pk_bf16_f32 v221, v82, v83
v_mfma_f32_16x16x32_bf16 v[112:115], a[180:183], a[124:127], v[112:115]
s_waitcnt lgkmcnt(6)
v_cvt_pk_bf16_f32 v222, v92, v93
v_mfma_f32_16x16x32_bf16 v[112:115], a[184:187], a[136:139], v[112:115]
ds_read_b64_tr_b16 a[152:153], v17 offset:41120
ds_read_b64_tr_b16 a[154:155], v17 offset:46240
v_mfma_f32_16x16x32_bf16 v[108:111], a[184:187], a[132:135], v[108:111]
v_cvt_pk_bf16_f32 v223, v94, v95
v_mfma_f32_16x16x32_bf16 v[104:107], a[184:187], a[128:131], v[104:107]
s_waitcnt lgkmcnt(6)
v_mfma_f32_16x16x32_bf16 v[104:107], a[188:191], a[140:143], v[104:107]
ds_read_b64_tr_b16 a[156:157], v17 offset:51360
ds_read_b64_tr_b16 a[158:159], v17 offset:56480
v_mfma_f32_16x16x32_bf16 v[108:111], a[188:191], v[32:35], v[108:111]
s_cmp_eq_u32 s33, 3
s_cselect_b32 s49, 2130706432, s47
s_cbranch_scc1 L_own3
L_ownr3:
v_mfma_f32_16x16x32_bf16 v[112:115], a[188:191], v[36:39], v[112:115]
s_waitcnt lgkmcnt(6)
buffer_store_dwordx4 v[220:223], v31, s[20:23], s49 offen offset:3072 sc1
v_mfma_f32_16x16x32_bf16 v[124:127], a[144:147], a[112:115], v[124:127]
ds_read_b64_tr_b16 a[160:161], v20 offset:192
ds_read_b64_tr_b16 a[162:163], v20 offset:5312
v_mfma_f32_16x16x32_bf16 v[120:123], a[144:147], a[108:111], v[120:123]
v_cvt_pk_bf16_f32 v184, v84, v85
v_cvt_pk_bf16_f32 v185, v86, v87
v_mfma_f32_16x16x32_bf16 v[116:119], a[144:147], a[104:107], v[116:119]
s_waitcnt lgkmcnt(6)
v_cvt_pk_bf16_f32 v186, v96, v97
v_cvt_pk_bf16_f32 v187, v98, v99
v_mfma_f32_16x16x32_bf16 v[116:119], a[148:151], a[116:119], v[116:119]
s_add_u32 s47, s41, 4096
ds_read_b64_tr_b16 a[164:165], v20 offset:10432
ds_read_b64_tr_b16 a[166:167], v20 offset:15552
v_mfma_f32_16x16x32_bf16 v[120:123], a[148:151], a[120:123], v[120:123]
s_cmp_eq_u32 s33, 4
s_cselect_b32 s49, 2130706432, s47
s_cbranch_scc1 L_own4
L_ownr4:
v_mfma_f32_16x16x32_bf16 v[124:127], a[148:151], a[124:127], v[124:127]
s_waitcnt lgkmcnt(6)
buffer_store_dwordx4 v[184:187], v31, s[20:23], s49 offen offset:0 sc1
v_mfma_f32_16x16x32_bf16 v[124:127], a[152:155], a[136:139], v[124:127]
ds_read_b64_tr_b16 a[168:169], v25 offset:192
ds_read_b64_tr_b16 a[170:171], v25 offset:5312
v_mfma_f32_16x16x32_bf16 v[120:123], a[152:155], a[132:135], v[120:123]
v_cvt_pk_bf16_f32 v196, v88, v89
v_cvt_pk_bf16_f32 v197, v90, v91
v_mfma_f32_16x16x32_bf16 v[116:119], a[152:155], a[128:131], v[116:119]
s_waitcnt lgkmcnt(6)
v_cvt_pk_bf16_f32 v198, v100, v101
v_cvt_pk_bf16_f32 v199, v102, v103
v_mfma_f32_16x16x32_bf16 v[116:119], a[156:159], a[140:143], v[116:119]
ds_read_b64_tr_b16 a[172:173], v25 offset:10432
ds_read_b64_tr_b16 a[174:175], v25 offset:15552
v_mfma_f32_16x16x32_bf16 v[120:123], a[156:159], v[32:35], v[120:123]
s_cmp_eq_u32 s33, 5
s_cselect_b32 s49, 2130706432, s47
s_cbranch_scc1 L_own5
L_ownr5:
v_mfma_f32_16x16x32_bf16 v[124:127], a[156:159], v[36:39], v[124:127]
s_waitcnt lgkmcnt(6)
buffer_store_dwordx4 v[196:199], v31, s[20:23], s49 offen offset:1024 sc1
v_mfma_f32_16x16x32_bf16 v[136:139], a[160:163], a[248:251], v[136:139]
ds_read_b64_tr_b16 a[176:177], v25 offset:20672
ds_read_b64_tr_b16 a[178:179], v25 offset:25792
v_mfma_f32_16x16x32_bf16 v[132:135], a[160:163], a[244:247], v[132:135]
v_mfma_f32_16x16x32_bf16 v[128:131], a[160:163], a[240:243], v[128:131]
s_waitcnt lgkmcnt(6)
v_mfma_f32_16x16x32_bf16 v[128:131], a[164:167], a[252:255], v[128:131]
ds_read_b64_tr_b16 a[180:181], v25 offset:30912
ds_read_b64_tr_b16 a[182:183], v25 offset:36032
v_mfma_f32_16x16x32_bf16 v[132:135], a[164:167], a[0:3], v[132:135]
v_cvt_pk_bf16_f32 v208, v104, v105
v_cvt_pk_bf16_f32 v209, v106, v107
v_mfma_f32_16x16x32_bf16 v[136:139], a[164:167], a[4:7], v[136:139]
s_waitcnt lgkmcnt(6)
v_cvt_pk_bf16_f32 v210, v116, v117
v_mfma_f32_16x16x32_bf16 v[136:139], a[168:171], a[16:19], v[136:139]
ds_read_b64_tr_b16 a[184:185], v25 offset:41152
ds_read_b64_tr_b16 a[186:187], v25 offset:46272
v_mfma_f32_16x16x32_bf16 v[132:135], a[168:171], a[12:15], v[132:135]
v_cvt_pk_bf16_f32 v211, v118, v119
v_mfma_f32_16x16x32_bf16 v[128:131], a[168:171], a[8:11], v[128:131]
s_waitcnt lgkmcnt(6)
v_mfma_f32_16x16x32_bf16 v[128:131], a[172:175], a[20:23], v[128:131]
ds_read_b64_tr_b16 a[188:189], v25 offset:51392
ds_read_b64_tr_b16 a[190:191], v25 offset:56512
v_mfma_f32_16x16x32_bf16 v[132:135], a[172:175], a[24:27], v[132:135]
s_cmp_eq_u32 s33, 6
s_cselect_b32 s49, 2130706432, s47
s_cbranch_scc1 L_own6
L_ownr6:
v_mfma_f32_16x16x32_bf16 v[136:139], a[172:175], a[28:31], v[136:139]
s_waitcnt lgkmcnt(6)
buffer_store_dwordx4 v[208:211], v31, s[20:23], s49 offen offset:2048 sc1
v_mfma_f32_16x16x32_bf16 v[136:139], a[176:179], a[40:43], v[136:139]
ds_read_b64_tr_b16 a[144:145], v16 offset:192
ds_read_b64_tr_b16 a[146:147], v16 offset:5312
v_mfma_f32_16x16x32_bf16 v[132:135], a[176:179], a[36:39], v[132:135]
v_cvt_pk_bf16_f32 v220, v108, v109
v_cvt_pk_bf16_f32 v221, v110, v111
v_mfma_f32_16x16x32_bf16 v[128:131], a[176:179], a[32:35], v[128:131]
s_waitcnt lgkmcnt(6)
v_cvt_pk_bf16_f32 v222, v120, v121
v_cvt_pk_bf16_f32 v223, v122, v123
v_mfma_f32_16x16x32_bf16 v[128:131], a[180:183], a[44:47], v[128:131]
ds_read_b64_tr_b16 a[148:149], v16 offset:10432
ds_read_b64_tr_b16 a[150:151], v16 offset:15552
v_mfma_f32_16x16x32_bf16 v[132:135], a[180:183], a[48:51], v[132:135]
s_cmp_eq_u32 s33, 7
s_cselect_b32 s49, 2130706432, s47
s_cbranch_scc1 L_own7
L_ownr7:
v_mfma_f32_16x16x32_bf16 v[136:139], a[180:183], a[52:55], v[136:139]
s_waitcnt lgkmcnt(6)
buffer_store_dwordx4 v[220:223], v31, s[20:23], s49 offen offset:3072 sc1
v_mfma_f32_16x16x32_bf16 v[136:139], a[184:187], a[64:67], v[136:139]
ds_read_b64_tr_b16 a[152:153], v16 offset:20672
ds_read_b64_tr_b16 a[154:155], v16 offset:25792
v_mfma_f32_16x16x32_bf16 v[132:135], a[184:187], a[60:63], v[132:135]
v_cvt_pk_bf16_f32 v184, v112, v113
v_cvt_pk_bf16_f32 v185, v114, v115
v_mfma_f32_16x16x32_bf16 v[128:131], a[184:187], a[56:59], v[128:131]
s_waitcnt lgkmcnt(6)
v_cvt_pk_bf16_f32 v186, v124, v125
v_cvt_pk_bf16_f32 v187, v126, v127
v_mfma_f32_16x16x32_bf16 v[128:131], a[188:191], a[68:71], v[128:131]
s_add_u32 s47, s41, 8192
ds_read_b64_tr_b16 a[156:157], v16 offset:30912
ds_read_b64_tr_b16 a[158:159], v16 offset:36032
v_mfma_f32_16x16x32_bf16 v[132:135], a[188:191], a[72:75], v[132:135]
s_cmp_eq_u32 s33, 0
s_cselect_b32 s49, 2130706432, s47
s_cbranch_scc1 L_own8
L_ownr8:
v_mfma_f32_16x16x32_bf16 v[136:139], a[188:191], a[76:79], v[136:139]
s_waitcnt lgkmcnt(6)
buffer_store_dwordx4 v[184:187], v31, s[20:23], s49 offen offset:0 sc1
v_mfma_f32_16x16x32_bf16 v[136:139], a[144:147], a[88:91], v[136:139]
ds_read_b64_tr_b16 a[160:161], v16 offset:41152
ds_read_b64_tr_b16 a[162:163], v16 offset:46272
v_mfma_f32_16x16x32_bf16 v[132:135], a[144:147], a[84:87], v[132:135]
v_mfma_f32_16x16x32_bf16 v[128:131], a[144:147], a[80:83], v[128:131]
s_waitcnt lgkmcnt(6)
v_mfma_f32_16x16x32_bf16 v[128:131], a[148:151], a[92:95], v[128:131]
ds_read_b64_tr_b16 a[164:165], v16 offset:51392
ds_read_b64_tr_b16 a[166:167], v16 offset:56512
v_mfma_f32_16x16x32_bf16 v[132:135], a[148:151], a[96:99], v[132:135]
v_mfma_f32_16x16x32_bf16 v[136:139], a[148:151], a[100:103], v[136:139]
s_waitcnt lgkmcnt(6)
v_mfma_f32_16x16x32_bf16 v[136:139], a[152:155], a[112:115], v[136:139]
ds_read_b64_tr_b16 a[168:169], v21 offset:224
ds_read_b64_tr_b16 a[170:171], v21 offset:5344
v_mfma_f32_16x16x32_bf16 v[132:135], a[152:155], a[108:111], v[132:135]
v_mfma_f32_16x16x32_bf16 v[128:131], a[152:155], a[104:107], v[128:131]
s_waitcnt lgkmcnt(6)
v_mfma_f32_16x16x32_bf16 v[128:131], a[156:159], a[116:119], v[128:131]
ds_read_b64_tr_b16 a[172:173], v21 offset:10464
ds_read_b64_tr_b16 a[174:175], v21 offset:15584
v_mfma_f32_16x16x32_bf16 v[132:135], a[156:159], a[120:123], v[132:135]
v_mfma_f32_16x16x32_bf16 v[136:139], a[156:159], a[124:127], v[136:139]
s_waitcnt lgkmcnt(6)
v_mfma_f32_16x16x32_bf16 v[136:139], a[160:163], a[136:139], v[136:139]
ds_read_b64_tr_b16 a[176:177], v26 offset:224
ds_read_b64_tr_b16 a[178:179], v26 offset:5344
v_mfma_f32_16x16x32_bf16 v[132:135], a[160:163], a[132:135], v[132:135]
v_mfma_f32_16x16x32_bf16 v[128:131], a[160:163], a[128:131], v[128:131]
s_waitcnt lgkmcnt(6)
ds_read_b64_tr_b16 a[180:181], v26 offset:10464
ds_read_b64_tr_b16 a[182:183], v26 offset:15584
v_mfma_f32_16x16x32_bf16 v[128:131], a[164:167], a[140:143], v[128:131]
v_mfma_f32_16x16x32_bf16 v[132:135], a[164:167], v[32:35], v[132:135]
v_mfma_f32_16x16x32_bf16 v[136:139], a[164:167], v[36:39], v[136:139]
s_waitcnt lgkmcnt(6)
ds_read_b64_tr_b16 a[184:185], v26 offset:20704
ds_read_b64_tr_b16 a[186:187], v26 offset:25824
v_mfma_f32_16x16x32_bf16 v[148:151], a[168:171], a[248:251], v[148:151]
v_mfma_f32_16x16x32_bf16 v[144:147], a[168:171], a[244:247], v[144:147]
v_mfma_f32_16x16x32_bf16 v[140:143], a[168:171], a[240:243], v[140:143]
s_waitcnt lgkmcnt(6)
ds_read_b64_tr_b16 a[188:189], v26 offset:30944
ds_read_b64_tr_b16 a[190:191], v26 offset:36064
v_mfma_f32_16x16x32_bf16 v[140:143], a[172:175], a[252:255], v[140:143]
v_mfma_f32_16x16x32_bf16 v[144:147], a[172:175], a[0:3], v[144:147]
v_mfma_f32_16x16x32_bf16 v[148:151], a[172:175], a[4:7], v[148:151]
s_waitcnt lgkmcnt(6)
ds_read_b64_tr_b16 a[144:145], v26 offset:41184
ds_read_b64_tr_b16 a[146:147], v26 offset:46304
v_mfma_f32_16x16x32_bf16 v[148:151], a[176:179], a[16:19], v[148:151]
v_mfma_f32_16x16x32_bf16 v[144:147], a[176:179], a[12:15], v[144:147]
v_mfma_f32_16x16x32_bf16 v[140:143], a[176:179], a[8:11], v[140:143]
s_waitcnt lgkmcnt(6)
ds_read_b64_tr_b16 a[148:149], v26 offset:51424
ds_read_b64_tr_b16 a[150:151], v26 offset:56544
v_mfma_f32_16x16x32_bf16 v[140:143], a[180:183], a[20:23], v[140:143]
v_mfma_f32_16x16x32_bf16 v[144:147], a[180:183], a[24:27], v[144:147]
v_mfma_f32_16x16x32_bf16 v[148:151], a[180:183], a[28:31], v[148:151]
s_waitcnt lgkmcnt(6)
ds_read_b64_tr_b16 a[152:153], v17 offset:224
ds_read_b64_tr_b16 a[154:155], v17 offset:5344
v_mfma_f32_16x16x32_bf16 v[148:151], a[184:187], a[40:43], v[148:151]
v_mfma_f32_16x16x32_bf16 v[144:147], a[184:187], a[36:39], v[144:147]
v_mfma_f32_16x16x32_bf16 v[140:143], a[184:187], a[32:35], v[140:143]
s_waitcnt lgkmcnt(6)
ds_read_b64_tr_b16 a[156:157], v17 offset:10464
ds_read_b64_tr_b16 a[158:159], v17 offset:15584
v_mfma_f32_16x16x32_bf16 v[140:143], a[188:191], a[44:47], v[140:143]
v_mfma_f32_16x16x32_bf16 v[144:147], a[188:191], a[48:51], v[144:147]
v_mfma_f32_16x16x32_bf16 v[148:151], a[188:191], a[52:55], v[148:151]
s_waitcnt lgkmcnt(6)
ds_read_b64_tr_b16 a[160:161], v17 offset:20704
ds_read_b64_tr_b16 a[162:163], v17 offset:25824
v_mfma_f32_16x16x32_bf16 v[148:151], a[144:147], a[64:67], v[148:151]
v_mfma_f32_16x16x32_bf16 v[144:147], a[144:147], a[60:63], v[144:147]
v_mfma_f32_16x16x32_bf16 v[140:143], a[144:147], a[56:59], v[140:143]
s_waitcnt lgkmcnt(6)
ds_read_b64_tr_b16 a[164:165], v17 offset:30944
ds_read_b64_tr_b16 a[166:167], v17 offset:36064
v_mfma_f32_16x16x32_bf16 v[140:143], a[148:151], a[68:71], v[140:143]
v_mfma_f32_16x16x32_bf16 v[144:147], a[148:151], a[72:75], v[144:147]
v_mfma_f32_16x16x32_bf16 v[148:151], a[148:151], a[76:79], v[148:151]
s_waitcnt lgkmcnt(6)
ds_read_b64_tr_b16 a[168:169], v17 offset:41184
ds_read_b64_tr_b16 a[170:171], v17 offset:46304
v_mfma_f32_16x16x32_bf16 v[148:151], a[152:155], a[88:91], v[148:151]
v_mfma_f32_16x16x32_bf16 v[144:147], a[152:155], a[84:87], v[144:147]
v_mfma_f32_16x16x32_bf16 v[140:143], a[152:155], a[80:83], v[140:143]
s_waitcnt lgkmcnt(6)
ds_read_b64_tr_b16 a[172:173], v17 offset:51424
ds_read_b64_tr_b16 a[174:175], v17 offset:56544
v_mfma_f32_16x16x32_bf16 v[140:143], a[156:159], a[92:95], v[140:143]
v_mfma_f32_16x16x32_bf16 v[144:147], a[156:159], a[96:99], v[144:147]
v_mfma_f32_16x16x32_bf16 v[148:151], a[156:159], a[100:103], v[148:151]
s_waitcnt lgkmcnt(6)
ds_read_b64_tr_b16 a[176:177], v20 offset:256
ds_read_b64_tr_b16 a[178:179], v20 offset:5376
v_mfma_f32_16x16x32_bf16 v[148:151], a[160:163], a[112:115], v[148:151]
v_mfma_f32_16x16x32_bf16 v[144:147], a[160:163], a[108:111], v[144:147]
v_mfma_f32_16x16x32_bf16 v[140:143], a[160:163], a[104:107], v[140:143]
s_waitcnt lgkmcnt(6)
ds_read_b64_tr_b16 a[180:181], v20 offset:10496
ds_read_b64_tr_b16 a[182:183], v20 offset:15616
v_mfma_f32_16x16x32_bf16 v[140:143], a[164:167], a[116:119], v[140:143]
v_mfma_f32_16x16x32_bf16 v[144:147], a[164:167], a[120:123], v[144:147]
v_mfma_f32_16x16x32_bf16 v[148:151], a[164:167], a[124:127], v[148:151]
s_waitcnt lgkmcnt(6)
ds_read_b64_tr_b16 a[184:185], v25 offset:256
ds_read_b64_tr_b16 a[186:187], v25 offset:5376
v_mfma_f32_16x16x32_bf16 v[148:151], a[168:171], a[136:139], v[148:151]
v_mfma_f32_16x16x32_bf16 v[144:147], a[168:171], a[132:135], v[144:147]
v_mfma_f32_16x16x32_bf16 v[140:143], a[168:171], a[128:131], v[140:143]
s_waitcnt lgkmcnt(6)
ds_read_b64_tr_b16 a[188:189], v25 offset:10496
ds_read_b64_tr_b16 a[190:191], v25 offset:15616
v_mfma_f32_16x16x32_bf16 v[140:143], a[172:175], a[140:143], v[140:143]
s_waitcnt vmcnt(0)
s_lshl_b64 exec, 1, s35
buffer_store_dwordx2 v[18:19], v251, s[20:23], 0 offen offset:0 sc1
s_mov_b64 exec, -1
v_mfma_f32_16x16x32_bf16 v[144:147], a[172:175], v[32:35], v[144:147]
v_mfma_f32_16x16x32_bf16 v[148:151], a[172:175], v[36:39], v[148:151]
s_waitcnt lgkmcnt(6)
ds_read_b64_tr_b16 a[144:145], v25 offset:20736
ds_read_b64_tr_b16 a[146:147], v25 offset:25856
v_mfma_f32_16x16x32_bf16 v[160:163], a[176:179], a[248:251], v[160:163]
v_mfma_f32_16x16x32_bf16 v[156:159], a[176:179], a[244:247], v[156:159]
v_mfma_f32_16x16x32_bf16 v[152:155], a[176:179], a[240:243], v[152:155]
s_waitcnt lgkmcnt(6)
ds_read_b64_tr_b16 a[148:149], v25 offset:30976
ds_read_b64_tr_b16 a[150:151], v25 offset:36096
v_mfma_f32_16x16x32_bf16 v[152:155], a[180:183], a[252:255], v[152:155]
v_mfma_f32_16x16x32_bf16 v[156:159], a[180:183], a[0:3], v[156:159]
v_cvt_pk_bf16_f32 v196, v128, v129
v_cvt_pk_bf16_f32 v197, v130, v131
v_mfma_f32_16x16x32_bf16 v[160:163], a[180:183], a[4:7], v[160:163]
s_waitcnt lgkmcnt(6)
ds_read_b64_tr_b16 a[152:153], v25 offset:41216
ds_read_b64_tr_b16 a[154:155], v25 offset:46336
v_mfma_f32_16x16x32_bf16 v[160:163], a[184:187], a[16:19], v[160:163]
v_cvt_pk_bf16_f32 v198, v140, v141
v_cvt_pk_bf16_f32 v199, v142, v143
v_mfma_f32_16x16x32_bf16 v[156:159], a[184:187], a[12:15], v[156:159]
s_cmp_eq_u32 s33, 1
s_cselect_b32 s49, 2130706432, s47
s_cbranch_scc1 L_own9
L_ownr9:
v_mfma_f32_16x16x32_bf16 v[152:155], a[184:187], a[8:11], v[152:155]
s_waitcnt lgkmcnt(6)
ds_read_b64_tr_b16 a[156:157], v25 offset:51456
ds_read_b64_tr_b16 a[158:159], v25 offset:56576
v_mfma_f32_16x16x32_bf16 v[152:155], a[188:191], a[20:23], v[152:155]
buffer_store_dwordx4 v[196:199], v31, s[20:23], s49 offen offset:1024 sc1
v_mfma_f32_16x16x32_bf16 v[156:159], a[188:191], a[24:27], v[156:159]
v_cvt_pk_bf16_f32 v208, v132, v133
v_cvt_pk_bf16_f32 v209, v134, v135
v_mfma_f32_16x16x32_bf16 v[160:163], a[188:191], a[28:31], v[160:163]
s_waitcnt lgkmcnt(6)
ds_read_b64_tr_b16 a[160:161], v16 offset:256
ds_read_b64_tr_b16 a[162:163], v16 offset:5376
v_mfma_f32_16x16x32_bf16 v[160:163], a[144:147], a[40:43], v[160:163]
v_cvt_pk_bf16_f32 v210, v144, v145
v_cvt_pk_bf16_f32 v211, v146, v147
v_mfma_f32_16x16x32_bf16 v[156:159], a[144:147], a[36:39], v[156:159]
s_cmp_eq_u32 s33, 2
s_cselect_b32 s49, 2130706432, s47
s_cbranch_scc1 L_own10
L_ownr10:
v_mfma_f32_16x16x32_bf16 v[152:155], a[144:147], a[32:35], v[152:155]
s_waitcnt lgkmcnt(6)
ds_read_b64_tr_b16 a[164:165], v16 offset:10496
ds_read_b64_tr_b16 a[166:167], v16 offset:15616
v_mfma_f32_16x16x32_bf16 v[152:155], a[148:151], a[44:47], v[152:155]
buffer_store_dwordx4 v[208:211], v31, s[20:23], s49 offen offset:2048 sc1
v_mfma_f32_16x16x32_bf16 v[156:159], a[148:151], a[48:51], v[156:159]
v_cvt_pk_bf16_f32 v220, v136, v137
v_cvt_pk_bf16_f32 v221, v138, v139
v_mfma_f32_16x16x32_bf16 v[160:163], a[148:151], a[52:55], v[160:163]
s_waitcnt lgkmcnt(6)
ds_read_b64_tr_b16 a[168:169], v16 offset:20736
ds_read_b64_tr_b16 a[170:171], v16 offset:25856
v_mfma_f32_16x16x32_bf16 v[160:163], a[152:155], a[64:67], v[160:163]
v_cvt_pk_bf16_f32 v222, v148, v149
v_cvt_pk_bf16_f32 v223, v150, v151
v_mfma_f32_16x16x32_bf16 v[156:159], a[152:155], a[60:63], v[156:159]
s_cmp_eq_u32 s33, 3
s_cselect_b32 s49, 2130706432, s47
s_cbranch_scc1 L_own11
L_ownr11:
v_mfma_f32_16x16x32_bf16 v[152:155], a[152:155], a[56:59], v[152:155]
s_waitcnt lgkmcnt(6)
ds_read_b64_tr_b16 a[172:173], v16 offset:30976
ds_read_b64_tr_b16 a[174:175], v16 offset:36096
v_mfma_f32_16x16x32_bf16 v[152:155], a[156:159], a[68:71], v[152:155]
buffer_store_dwordx4 v[220:223], v31, s[20:23], s49 offen offset:3072 sc1
v_mfma_f32_16x16x32_bf16 v[156:159], a[156:159], a[72:75], v[156:159]
v_mfma_f32_16x16x32_bf16 v[160:163], a[156:159], a[76:79], v[160:163]
s_waitcnt lgkmcnt(6)
ds_read_b64_tr_b16 a[176:177], v16 offset:41216
ds_read_b64_tr_b16 a[178:179], v16 offset:46336
v_mfma_f32_16x16x32_bf16 v[160:163], a[160:163], a[88:91], v[160:163]
v_mfma_f32_16x16x32_bf16 v[156:159], a[160:163], a[84:87], v[156:159]
v_mfma_f32_16x16x32_bf16 v[152:155], a[160:163], a[80:83], v[152:155]
s_waitcnt lgkmcnt(6)
ds_read_b64_tr_b16 a[180:181], v16 offset:51456
ds_read_b64_tr_b16 a[182:183], v16 offset:56576
v_mfma_f32_16x16x32_bf16 v[152:155], a[164:167], a[92:95], v[152:155]
v_mfma_f32_16x16x32_bf16 v[156:159], a[164:167], a[96:99], v[156:159]
v_mfma_f32_16x16x32_bf16 v[160:163], a[164:167], a[100:103], v[160:163]
s_waitcnt lgkmcnt(6)
ds_read_b64_tr_b16 a[184:185], v21 offset:288
ds_read_b64_tr_b16 a[186:187], v21 offset:5408
v_mfma_f32_16x16x32_bf16 v[160:163], a[168:171], a[112:115], v[160:163]
v_mfma_f32_16x16x32_bf16 v[156:159], a[168:171], a[108:111], v[156:159]
v_mfma_f32_16x16x32_bf16 v[152:155], a[168:171], a[104:107], v[152:155]
s_waitcnt lgkmcnt(6)
ds_read_b64_tr_b16 a[188:189], v21 offset:10528
ds_read_b64_tr_b16 a[190:191], v21 offset:15648
v_mfma_f32_16x16x32_bf16 v[152:155], a[172:175], a[116:119], v[152:155]
v_mfma_f32_16x16x32_bf16 v[156:159], a[172:175], a[120:123], v[156:159]
v_mfma_f32_16x16x32_bf16 v[160:163], a[172:175], a[124:127], v[160:163]
s_waitcnt lgkmcnt(6)
ds_read_b64_tr_b16 a[144:145], v26 offset:288
ds_read_b64_tr_b16 a[146:147], v26 offset:5408
v_mfma_f32_16x16x32_bf16 v[160:163], a[176:179], a[136:139], v[160:163]
v_mfma_f32_16x16x32_bf16 v[156:159], a[176:179], a[132:135], v[156:159]
v_mfma_f32_16x16x32_bf16 v[152:155], a[176:179], a[128:131], v[152:155]
s_waitcnt lgkmcnt(6)
ds_read_b64_tr_b16 a[148:149], v26 offset:10528
ds_read_b64_tr_b16 a[150:151], v26 offset:15648
v_mfma_f32_16x16x32_bf16 v[152:155], a[180:183], a[140:143], v[152:155]
v_mfma_f32_16x16x32_bf16 v[156:159], a[180:183], v[32:35], v[156:159]
v_mfma_f32_16x16x32_bf16 v[160:163], a[180:183], v[36:39], v[160:163]
s_waitcnt lgkmcnt(6)
ds_read_b64_tr_b16 a[152:153], v26 offset:20768
ds_read_b64_tr_b16 a[154:155], v26 offset:25888
v_mfma_f32_16x16x32_bf16 v[172:175], a[184:187], a[248:251], v[172:175]
v_mfma_f32_16x16x32_bf16 v[168:171], a[184:187], a[244:247], v[168:171]
v_mfma_f32_16x16x32_bf16 v[164:167], a[184:187], a[240:243], v[164:167]
s_waitcnt lgkmcnt(6)
ds_read_b64_tr_b16 a[156:157], v26 offset:31008
ds_read_b64_tr_b16 a[158:159], v26 offset:36128
v_mfma_f32_16x16x32_bf16 v[164:167], a[188:191], a[252:255], v[164:167]
v_mfma_f32_16x16x32_bf16 v[168:171], a[188:191], a[0:3], v[168:171]
v_mfma_f32_16x16x32_bf16 v[172:175], a[188:191], a[4:7], v[172:175]
s_waitcnt lgkmcnt(6)
ds_read_b64_tr_b16 a[160:161], v26 offset:41248
ds_read_b64_tr_b16 a[162:163], v26 offset:46368
v_mfma_f32_16x16x32_bf16 v[172:175], a[144:147], a[16:19], v[172:175]
v_mfma_f32_16x16x32_bf16 v[168:171], a[144:147], a[12:15], v[168:171]
v_mfma_f32_16x16x32_bf16 v[164:167], a[144:147], a[8:11], v[164:167]
s_waitcnt lgkmcnt(6)
ds_read_b64_tr_b16 a[164:165], v26 offset:51488
ds_read_b64_tr_b16 a[166:167], v26 offset:56608
v_mfma_f32_16x16x32_bf16 v[164:167], a[148:151], a[20:23], v[164:167]
v_mfma_f32_16x16x32_bf16 v[168:171], a[148:151], a[24:27], v[168:171]
v_mfma_f32_16x16x32_bf16 v[172:175], a[148:151], a[28:31], v[172:175]
s_waitcnt lgkmcnt(6)
ds_read_b64_tr_b16 a[168:169], v17 offset:288
ds_read_b64_tr_b16 a[170:171], v17 offset:5408
v_mfma_f32_16x16x32_bf16 v[172:175], a[152:155], a[40:43], v[172:175]
v_mfma_f32_16x16x32_bf16 v[168:171], a[152:155], a[36:39], v[168:171]
v_mfma_f32_16x16x32_bf16 v[164:167], a[152:155], a[32:35], v[164:167]
s_waitcnt lgkmcnt(6)
ds_read_b64_tr_b16 a[172:173], v17 offset:10528
ds_read_b64_tr_b16 a[174:175], v17 offset:15648
v_mfma_f32_16x16x32_bf16 v[164:167], a[156:159], a[44:47], v[164:167]
v_mfma_f32_16x16x32_bf16 v[168:171], a[156:159], a[48:51], v[168:171]
v_mfma_f32_16x16x32_bf16 v[172:175], a[156:159], a[52:55], v[172:175]
s_waitcnt lgkmcnt(6)
ds_read_b64_tr_b16 a[176:177], v17 offset:20768
ds_read_b64_tr_b16 a[178:179], v17 offset:25888
v_mfma_f32_16x16x32_bf16 v[172:175], a[160:163], a[64:67], v[172:175]
v_mfma_f32_16x16x32_bf16 v[168:171], a[160:163], a[60:63], v[168:171]
v_mfma_f32_16x16x32_bf16 v[164:167], a[160:163], a[56:59], v[164:167]
s_waitcnt lgkmcnt(6)
ds_read_b64_tr_b16 a[180:181], v17 offset:31008
ds_read_b64_tr_b16 a[182:183], v17 offset:36128
v_mfma_f32_16x16x32_bf16 v[164:167], a[164:167], a[68:71], v[164:167]
v_mfma_f32_16x16x32_bf16 v[168:171], a[164:167], a[72:75], v[168:171]
v_mfma_f32_16x16x32_bf16 v[172:175], a[164:167], a[76:79], v[172:175]
s_waitcnt lgkmcnt(6)
ds_read_b64_tr_b16 a[184:185], v17 offset:41248
ds_read_b64_tr_b16 a[186:187], v17 offset:46368
v_mfma_f32_16x16x32_bf16 v[172:175], a[168:171], a[88:91], v[172:175]
v_mfma_f32_16x16x32_bf16 v[168:171], a[168:171], a[84:87], v[168:171]
v_mfma_f32_16x16x32_bf16 v[164:167], a[168:171], a[80:83], v[164:167]
s_waitcnt lgkmcnt(6)
ds_read_b64_tr_b16 a[188:189], v17 offset:51488
ds_read_b64_tr_b16 a[190:191], v17 offset:56608
v_mfma_f32_16x16x32_bf16 v[164:167], a[172:175], a[92:95], v[164:167]
v_mfma_f32_16x16x32_bf16 v[168:171], a[172:175], a[96:99], v[168:171]
v_mfma_f32_16x16x32_bf16 v[172:175], a[172:175], a[100:103], v[172:175]
s_waitcnt lgkmcnt(6)
v_mfma_f32_16x16x32_bf16 v[172:175], a[176:179], a[112:115], v[172:175]
v_mfma_f32_16x16x32_bf16 v[168:171], a[176:179], a[108:111], v[168:171]
v_mfma_f32_16x16x32_bf16 v[164:167], a[176:179], a[104:107], v[164:167]
s_waitcnt lgkmcnt(4)
v_mfma_f32_16x16x32_bf16 v[164:167], a[180:183], a[116:119], v[164:167]
v_mfma_f32_16x16x32_bf16 v[168:171], a[180:183], a[120:123], v[168:171]
v_mfma_f32_16x16x32_bf16 v[172:175], a[180:183], a[124:127], v[172:175]
s_waitcnt lgkmcnt(2)
v_mfma_f32_16x16x32_bf16 v[172:175], a[184:187], a[136:139], v[172:175]
v_mfma_f32_16x16x32_bf16 v[168:171], a[184:187], a[132:135], v[168:171]
v_mfma_f32_16x16x32_bf16 v[164:167], a[184:187], a[128:131], v[164:167]
s_waitcnt lgkmcnt(0)
v_mfma_f32_16x16x32_bf16 v[164:167], a[188:191], a[140:143], v[164:167]
v_mfma_f32_16x16x32_bf16 v[168:171], a[188:191], v[32:35], v[168:171]
v_mfma_f32_16x16x32_bf16 v[172:175], a[188:191], v[36:39], v[172:175]
v_cvt_pk_bf16_f32 v184, v152, v153
v_cvt_pk_bf16_f32 v185, v154, v155
s_nop 3
v_cvt_pk_bf16_f32 v186, v164, v165
v_cvt_pk_bf16_f32 v187, v166, v167
s_add_u32 s47, s41, 12288
s_cmp_eq_u32 s33, 4
s_cselect_b32 s49, 2130706432, s47
s_cbranch_scc1 L_own12
L_ownr12:
buffer_store_dwordx4 v[184:187], v31, s[20:23], s49 offen offset:0 sc1
v_cvt_pk_bf16_f32 v196, v156, v157
v_cvt_pk_bf16_f32 v197, v158, v159
v_cvt_pk_bf16_f32 v198, v168, v169
v_cvt_pk_bf16_f32 v199, v170, v171
s_cmp_eq_u32 s33, 5
s_cselect_b32 s49, 2130706432, s47
s_cbranch_scc1 L_own13
L_ownr13:
buffer_store_dwordx4 v[196:199], v31, s[20:23], s49 offen offset:1024 sc1
v_cvt_pk_bf16_f32 v208, v160, v161
v_cvt_pk_bf16_f32 v209, v162, v163
v_cvt_pk_bf16_f32 v210, v172, v173
v_cvt_pk_bf16_f32 v211, v174, v175
s_cmp_eq_u32 s33, 6
s_cselect_b32 s49, 2130706432, s47
s_cbranch_scc1 L_own14
L_ownr14:
buffer_store_dwordx4 v[208:211], v31, s[20:23], s49 offen offset:2048 sc1
buffer_load_dwordx2 v[28:29], v22, s[20:23], 0 offen sc1
s_lshl_b32 s46, s33, 10
v_add_u32 v2, s46, v31
s_cmp_eq_u32 s33, 7
s_cselect_b32 s40, 2130706432, 0
s_cselect_b32 s42, 0xff00, 0
s_mov_b32 s41, 0xffff0000
s_lshl_b32 s43, 0x101, s35
s_mov_b32 s44, 2130706432
s_mov_b32 s46, 0x20000
s_waitcnt vmcnt(1)
s_lshl_b64 exec, 1, s35
buffer_store_dwordx2 v[18:19], v251, s[20:23], 0 offen offset:128 sc1
s_mov_b64 exec, -1
s_waitcnt vmcnt(1)
s_branch L_fin2
L_fin:
buffer_load_dwordx2 v[28:29], v22, s[20:23], 0 offen sc1
s_waitcnt vmcnt(0)
L_fin2:
v_cmp_eq_u64 vcc, s[94:95], v[28:29]
s_nop 4
s_and_b32 s39, vcc_lo, 0xffff
s_or_b32 s39, s39, s43
s_andn2_b32 s39, s39, s42
s_cbranch_scc0 L_fnone
s_or_b32 s42, s42, s39
s_and_b32 s47, s39, 0xff
s_cbranch_scc0 L_fs7
s_bitcmp0_b32 s39, 0
s_cbranch_scc1 L_fs0
s_cmp_eq_u32 s35, 0
s_cselect_b32 s47, s44, 0
buffer_load_dwordx4 v[56:59], v2, s[20:23], s47 offen sc1
L_fs0:
s_bitcmp0_b32 s39, 1
s_cbranch_scc1 L_fs1
s_cmp_eq_u32 s35, 1
s_cselect_b32 s47, s44, 15360
buffer_load_dwordx4 v[60:63], v2, s[20:23], s47 offen sc1
L_fs1:
s_bitcmp0_b32 s39, 2
s_cbranch_scc1 L_fs2
s_cmp_eq_u32 s35, 2
s_cselect_b32 s47, s44, 30720
buffer_load_dwordx4 v[64:67], v2, s[20:23], s47 offen sc1
L_fs2:
s_bitcmp0_b32 s39, 3
s_cbranch_scc1 L_fs3
s_cmp_eq_u32 s35, 3
s_cselect_b32 s47, s44, 46080
buffer_load_dwordx4 v[68:71], v2, s[20:23], s47 offen sc1
L_fs3:
s_bitcmp0_b32 s39, 4
s_cbranch_scc1 L_fs4
s_cmp_eq_u32 s35, 4
s_cselect_b32 s47, s44, 61440
buffer_load_dwordx4 v[72:75], v2, s[20:23], s47 offen sc1
L_fs4:
s_bitcmp0_b32 s39, 5
s_cbranch_scc1 L_fs5
s_cmp_eq_u32 s35, 5
s_cselect_b32 s47, s44, 76800
buffer_load_dwordx4 v[76:79], v2, s[20:23], s47 offen sc1
L_fs5:
s_bitcmp0_b32 s39, 6
s_cbranch_scc1 L_fs6
s_cmp_eq_u32 s35, 6
s_cselect_b32 s47, s44, 92160
buffer_load_dwordx4 v[80:83], v2, s[20:23], s47 offen sc1
L_fs6:
s_bitcmp0_b32 s39, 7
s_cbranch_scc1 L_fs7
s_cmp_eq_u32 s35, 7
s_cselect_b32 s47, s44, 107520
buffer_load_dwordx4 v[84:87], v2, s[20:23], s47 offen sc1
L_fs7:
s_bitcmp0_b32 s39, 8
s_cbranch_scc1 L_fs8
s_cmp_eq_u32 s35, 0
s_cselect_b32 s47, s44, 8192
buffer_load_dwordx4 v[88:91], v2, s[20:23], s47 offen sc1
L_fs8:
s_bitcmp0_b32 s39, 9
s_cbranch_scc1 L_fs9
s_cmp_eq_u32 s35, 1
s_cselect_b32 s47, s44, 23552
buffer_load_dwordx4 v[92:95], v2, s[20:23], s47 offen sc1
L_fs9:
s_bitcmp0_b32 s39, 10
s_cbranch_scc1 L_fs10
s_cmp_eq_u32 s35, 2
s_cselect_b32 s47, s44, 38912
buffer_load_dwordx4 v[96:99], v2, s[20:23], s47 offen sc1
L_fs10:
s_bitcmp0_b32 s39, 11
s_cbranch_scc1 L_fs11
s_cmp_eq_u32 s35, 3
s_cselect_b32 s47, s44, 54272
buffer_load_dwordx4 v[100:103], v2, s[20:23], s47 offen sc1
L_fs11:
s_bitcmp0_b32 s39, 12
s_cbranch_scc1 L_fs12
s_cmp_eq_u32 s35, 4
s_cselect_b32 s47, s44, 69632
buffer_load_dwordx4 v[104:107], v2, s[20:23], s47 offen sc1
L_fs12:
s_bitcmp0_b32 s39, 13
s_cbranch_scc1 L_fs13
s_cmp_eq_u32 s35, 5
s_cselect_b32 s47, s44, 84992
buffer_load_dwordx4 v[108:111], v2, s[20:23], s47 offen sc1
L_fs13:
s_bitcmp0_b32 s39, 14
s_cbranch_scc1 L_fs14
s_cmp_eq_u32 s35, 6
s_cselect_b32 s47, s44, 100352
buffer_load_dwordx4 v[112:115], v2, s[20:23], s47 offen sc1
L_fs14:
s_bitcmp0_b32 s39, 15
s_cbranch_scc1 L_fs15
s_cmp_eq_u32 s35, 7
s_cselect_b32 s47, s44, 115712
buffer_load_dwordx4 v[116:119], v2, s[20:23], s47 offen sc1
L_fs15:
s_cmp_eq_u32 s42, 0xffff
s_cbranch_scc1 L_find
L_fnone:
s_sub_u32 s46, s46, 1
s_cmp_lg_u32 s46, 0
s_cbranch_scc1 L_fin
L_find:
s_add_u32 s46, s33, 0
s_mul_i32 s47, s46, 11
s_lshr_b32 s47, s47, 5
s_mul_i32 s49, s47, 3
s_sub_u32 s49, s46, s49
s_mul_i32 s49, s49, 20480
s_lshl_b32 s47, s47, 6
s_add_u32 s50, s47, s49
s_add_u32 s46, s33, 8
s_mul_i32 s47, s46, 11
s_lshr_b32 s47, s47, 5
s_mul_i32 s49, s47, 3
s_sub_u32 s49, s46, s49
s_mul_i32 s49, s49, 20480
s_lshl_b32 s47, s47, 6
s_add_u32 s51, s47, s49
s_add_u32 s51, s51, s40
s_and_b32 s39, s39, 0xff
s_cbranch_scc0 L_fa
s_waitcnt vmcnt(0)
L_fa:
v_lshlrev_b32 v120, 16, v56
v_and_b32 v121, s41, v56
v_lshlrev_b32 v122, 16, v57
v_and_b32 v123, s41, v57
v_lshlrev_b32 v124, 16, v58
v_and_b32 v125, s41, v58
v_lshlrev_b32 v126, 16, v59
v_and_b32 v127, s41, v59
v_add_f32 v40, v40, v120
v_add_f32 v41, v41, v121
v_add_f32 v42, v42, v122
v_add_f32 v43, v43, v123
v_add_f32 v44, v44, v124
v_add_f32 v45, v45, v125
v_add_f32 v46, v46, v126
v_add_f32 v47, v47, v127
v_lshlrev_b32 v120, 16, v60
v_and_b32 v121, s41, v60
v_lshlrev_b32 v122, 16, v61
v_and_b32 v123, s41, v61
v_lshlrev_b32 v124, 16, v62
v_and_b32 v125, s41, v62
v_lshlrev_b32 v126, 16, v63
v_and_b32 v127, s41, v63
v_add_f32 v40, v40, v120
v_add_f32 v41, v41, v121
v_add_f32 v42, v42, v122
v_add_f32 v43, v43, v123
v_add_f32 v44, v44, v124
v_add_f32 v45, v45, v125
v_add_f32 v46, v46, v126
v_add_f32 v47, v47, v127
v_lshlrev_b32 v120, 16, v64
v_and_b32 v121, s41, v64
v_lshlrev_b32 v122, 16, v65
v_and_b32 v123, s41, v65
v_lshlrev_b32 v124, 16, v66
v_and_b32 v125, s41, v66
v_lshlrev_b32 v126, 16, v67
v_and_b32 v127, s41, v67
v_add_f32 v40, v40, v120
v_add_f32 v41, v41, v121
v_add_f32 v42, v42, v122
v_add_f32 v43, v43, v123
v_add_f32 v44, v44, v124
v_add_f32 v45, v45, v125
v_add_f32 v46, v46, v126
v_add_f32 v47, v47, v127
v_lshlrev_b32 v120, 16, v68
v_and_b32 v121, s41, v68
v_lshlrev_b32 v122, 16, v69
v_and_b32 v123, s41, v69
v_lshlrev_b32 v124, 16, v70
v_and_b32 v125, s41, v70
v_lshlrev_b32 v126, 16, v71
v_and_b32 v127, s41, v71
v_add_f32 v40, v40, v120
v_add_f32 v41, v41, v121
v_add_f32 v42, v42, v122
v_add_f32 v43, v43, v123
v_add_f32 v44, v44, v124
v_add_f32 v45, v45, v125
v_add_f32 v46, v46, v126
v_add_f32 v47, v47, v127
v_lshlrev_b32 v120, 16, v72
v_and_b32 v121, s41, v72
v_lshlrev_b32 v122, 16, v73
v_and_b32 v123, s41, v73
v_lshlrev_b32 v124, 16, v74
v_and_b32 v125, s41, v74
v_lshlrev_b32 v126, 16, v75
v_and_b32 v127, s41, v75
v_add_f32 v40, v40, v120
v_add_f32 v41, v41, v121
v_add_f32 v42, v42, v122
v_add_f32 v43, v43, v123
v_add_f32 v44, v44, v124
v_add_f32 v45, v45, v125
v_add_f32 v46, v46, v126
v_add_f32 v47, v47, v127
v_lshlrev_b32 v120, 16, v76
v_and_b32 v121, s41, v76
v_lshlrev_b32 v122, 16, v77
v_and_b32 v123, s41, v77
v_lshlrev_b32 v124, 16, v78
v_and_b32 v125, s41, v78
v_lshlrev_b32 v126, 16, v79
v_and_b32 v127, s41, v79
v_add_f32 v40, v40, v120
v_add_f32 v41, v41, v121
v_add_f32 v42, v42, v122
v_add_f32 v43, v43, v123
v_add_f32 v44, v44, v124
v_add_f32 v45, v45, v125
v_add_f32 v46, v46, v126
v_add_f32 v47, v47, v127
v_lshlrev_b32 v120, 16, v80
v_and_b32 v121, s41, v80
v_lshlrev_b32 v122, 16, v81
v_and_b32 v123, s41, v81
v_lshlrev_b32 v124, 16, v82
v_and_b32 v125, s41, v82
v_lshlrev_b32 v126, 16, v83
v_and_b32 v127, s41, v83
v_add_f32 v40, v40, v120
v_add_f32 v41, v41, v121
v_add_f32 v42, v42, v122
v_add_f32 v43, v43, v123
v_add_f32 v44, v44, v124
v_add_f32 v45, v45, v125
v_add_f32 v46, v46, v126
v_add_f32 v47, v47, v127
v_lshlrev_b32 v120, 16, v84
v_and_b32 v121, s41, v84
v_lshlrev_b32 v122, 16, v85
v_and_b32 v123, s41, v85
v_lshlrev_b32 v124, 16, v86
v_and_b32 v125, s41, v86
v_lshlrev_b32 v126, 16, v87
v_and_b32 v127, s41, v87
v_add_f32 v40, v40, v120
v_add_f32 v41, v41, v121
v_add_f32 v42, v42, v122
v_add_f32 v43, v43, v123
v_add_f32 v44, v44, v124
v_add_f32 v45, v45, v125
v_add_f32 v46, v46, v126
v_add_f32 v47, v47, v127
v_cvt_pk_bf16_f32 v132, v40, v41
v_cvt_pk_bf16_f32 v133, v42, v43
v_cvt_pk_bf16_f32 v134, v44, v45
v_cvt_pk_bf16_f32 v135, v46, v47
s_nop 0
v_permlane16_swap_b32 v132, v134
v_permlane16_swap_b32 v133, v135
buffer_store_dwordx4 v[132:135], v254, s[28:31], s50 offen
s_waitcnt vmcnt(1)
v_lshlrev_b32 v120, 16, v88
v_and_b32 v121, s41, v88
v_lshlrev_b32 v122, 16, v89
v_and_b32 v123, s41, v89
v_lshlrev_b32 v124, 16, v90
v_and_b32 v125, s41, v90
v_lshlrev_b32 v126, 16, v91
v_and_b32 v127, s41, v91
v_add_f32 v48, v48, v120
v_add_f32 v49, v49, v121
v_add_f32 v50, v50, v122
v_add_f32 v51, v51, v123
v_add_f32 v52, v52, v124
v_add_f32 v53, v53, v125
v_add_f32 v54, v54, v126
v_add_f32 v55, v55, v127
v_lshlrev_b32 v120, 16, v92
v_and_b32 v121, s41, v92
v_lshlrev_b32 v122, 16, v93
v_and_b32 v123, s41, v93
v_lshlrev_b32 v124, 16, v94
v_and_b32 v125, s41, v94
v_lshlrev_b32 v126, 16, v95
v_and_b32 v127, s41, v95
v_add_f32 v48, v48, v120
v_add_f32 v49, v49, v121
v_add_f32 v50, v50, v122
v_add_f32 v51, v51, v123
v_add_f32 v52, v52, v124
v_add_f32 v53, v53, v125
v_add_f32 v54, v54, v126
v_add_f32 v55, v55, v127
v_lshlrev_b32 v120, 16, v96
v_and_b32 v121, s41, v96
v_lshlrev_b32 v122, 16, v97
v_and_b32 v123, s41, v97
v_lshlrev_b32 v124, 16, v98
v_and_b32 v125, s41, v98
v_lshlrev_b32 v126, 16, v99
v_and_b32 v127, s41, v99
v_add_f32 v48, v48, v120
v_add_f32 v49, v49, v121
v_add_f32 v50, v50, v122
v_add_f32 v51, v51, v123
v_add_f32 v52, v52, v124
v_add_f32 v53, v53, v125
v_add_f32 v54, v54, v126
v_add_f32 v55, v55, v127
v_lshlrev_b32 v120, 16, v100
v_and_b32 v121, s41, v100
v_lshlrev_b32 v122, 16, v101
v_and_b32 v123, s41, v101
v_lshlrev_b32 v124, 16, v102
v_and_b32 v125, s41, v102
v_lshlrev_b32 v126, 16, v103
v_and_b32 v127, s41, v103
v_add_f32 v48, v48, v120
v_add_f32 v49, v49, v121
v_add_f32 v50, v50, v122
v_add_f32 v51, v51, v123
v_add_f32 v52, v52, v124
v_add_f32 v53, v53, v125
v_add_f32 v54, v54, v126
v_add_f32 v55, v55, v127
v_lshlrev_b32 v120, 16, v104
v_and_b32 v121, s41, v104
v_lshlrev_b32 v122, 16, v105
v_and_b32 v123, s41, v105
v_lshlrev_b32 v124, 16, v106
v_and_b32 v125, s41, v106
v_lshlrev_b32 v126, 16, v107
v_and_b32 v127, s41, v107
v_add_f32 v48, v48, v120
v_add_f32 v49, v49, v121
v_add_f32 v50, v50, v122
v_add_f32 v51, v51, v123
v_add_f32 v52, v52, v124
v_add_f32 v53, v53, v125
v_add_f32 v54, v54, v126
v_add_f32 v55, v55, v127
v_lshlrev_b32 v120, 16, v108
v_and_b32 v121, s41, v108
v_lshlrev_b32 v122, 16, v109
v_and_b32 v123, s41, v109
v_lshlrev_b32 v124, 16, v110
v_and_b32 v125, s41, v110
v_lshlrev_b32 v126, 16, v111
v_and_b32 v127, s41, v111
v_add_f32 v48, v48, v120
v_add_f32 v49, v49, v121
v_add_f32 v50, v50, v122
v_add_f32 v51, v51, v123
v_add_f32 v52, v52, v124
v_add_f32 v53, v53, v125
v_add_f32 v54, v54, v126
v_add_f32 v55, v55, v127
v_lshlrev_b32 v120, 16, v112
v_and_b32 v121, s41, v112
v_lshlrev_b32 v122, 16, v113
v_and_b32 v123, s41, v113
v_lshlrev_b32 v124, 16, v114
v_and_b32 v125, s41, v114
v_lshlrev_b32 v126, 16, v115
v_and_b32 v127, s41, v115
v_add_f32 v48, v48, v120
v_add_f32 v49, v49, v121
v_add_f32 v50, v50, v122
v_add_f32 v51, v51, v123
v_add_f32 v52, v52, v124
v_add_f32 v53, v53, v125
v_add_f32 v54, v54, v126
v_add_f32 v55, v55, v127
v_lshlrev_b32 v120, 16, v116
v_and_b32 v121, s41, v116
v_lshlrev_b32 v122, 16, v117
v_and_b32 v123, s41, v117
v_lshlrev_b32 v124, 16, v118
v_and_b32 v125, s41, v118
v_lshlrev_b32 v126, 16, v119
v_and_b32 v127, s41, v119
v_add_f32 v48, v48, v120
v_add_f32 v49, v49, v121
v_add_f32 v50, v50, v122
v_add_f32 v51, v51, v123
v_add_f32 v52, v52, v124
v_add_f32 v53, v53, v125
v_add_f32 v54, v54, v126
v_add_f32 v55, v55, v127
v_cvt_pk_bf16_f32 v136, v48, v49
v_cvt_pk_bf16_f32 v137, v50, v51
v_cvt_pk_bf16_f32 v138, v52, v53
v_cvt_pk_bf16_f32 v139, v54, v55
s_nop 0
v_permlane16_swap_b32 v136, v138
v_permlane16_swap_b32 v137, v139
buffer_store_dwordx4 v[136:139], v254, s[28:31], s51 offen
s_cmp_lg_u32 s36, 0
s_cbranch_scc1 L_ne_19
v_mov_b32 v28, s92
v_mov_b32 v29, s93
s_mov_b64 exec, 1
buffer_store_dwordx2 v[28:29], v250, s[20:23], 0 offen offset:96 sc1
s_mov_b64 exec, -1
s_nop 1
L_ne_19:
s_cmp_lg_u32 s35, 0
s_cbranch_scc1 L_ne_20
v_mov_b32 v28, s94
v_mov_b32 v29, s95
s_mov_b64 exec, 1
buffer_store_dwordx2 v[28:29], v251, s[20:23], 0 offen offset:192 sc1
s_mov_b64 exec, -1
s_nop 1
L_ne_20:
L_end:
s_endpgm
L_spin0:
s_mov_b32 s46, 0x10000
L_poll0:
buffer_load_dwordx2 v[28:29], v250, s[20:23], 0 offen offset:128 sc1
s_waitcnt vmcnt(0)
v_cmp_ne_u64 vcc, s[92:93], v[28:29]
s_cbranch_vccz L_spinr0
buffer_load_dwordx2 v[28:29], v250, s[20:23], 0 offen offset:128 sc1
s_waitcnt vmcnt(0)
v_cmp_ne_u64 vcc, s[92:93], v[28:29]
s_cbranch_vccz L_spinr0
buffer_load_dwordx2 v[28:29], v250, s[20:23], 0 offen offset:128 sc1
s_waitcnt vmcnt(0)
v_cmp_ne_u64 vcc, s[92:93], v[28:29]
s_cbranch_vccz L_spinr0
buffer_load_dwordx2 v[28:29], v250, s[20:23], 0 offen offset:128 sc1
s_waitcnt vmcnt(0)
v_cmp_ne_u64 vcc, s[92:93], v[28:29]
s_cbranch_vccz L_spinr0
buffer_load_dwordx2 v[28:29], v250, s[20:23], 0 offen offset:0 sc1
s_waitcnt vmcnt(0)
v_cmp_ne_u64 vcc, s[92:93], v[28:29]
s_cbranch_vccz L_spinr0
s_sub_u32 s46, s46, 1
s_cmp_lg_u32 s46, 0
s_cbranch_scc1 L_poll0
s_branch L_spinr0

L_spin1:
s_mov_b32 s46, 0x10000
L_poll1:
buffer_load_dwordx2 v[28:29], v250, s[20:23], 0 offen offset:160 sc1
s_waitcnt vmcnt(0)
v_cmp_ne_u64 vcc, s[92:93], v[28:29]
s_cbranch_vccz L_spinr1
buffer_load_dwordx2 v[28:29], v250, s[20:23], 0 offen offset:160 sc1
s_waitcnt vmcnt(0)
v_cmp_ne_u64 vcc, s[92:93], v[28:29]
s_cbranch_vccz L_spinr1
buffer_load_dwordx2 v[28:29], v250, s[20:23], 0 offen offset:160 sc1
s_waitcnt vmcnt(0)
v_cmp_ne_u64 vcc, s[92:93], v[28:29]
s_cbranch_vccz L_spinr1
buffer_load_dwordx2 v[28:29], v250, s[20:23], 0 offen offset:160 sc1
s_waitcnt vmcnt(0)
v_cmp_ne_u64 vcc, s[92:93], v[28:29]
s_cbranch_vccz L_spinr1
buffer_load_dwordx2 v[28:29], v250, s[20:23], 0 offen offset:32 sc1
s_waitcnt vmcnt(0)
v_cmp_ne_u64 vcc, s[92:93], v[28:29]
s_cbranch_vccz L_spinr1
s_sub_u32 s46, s46, 1
s_cmp_lg_u32 s46, 0
s_cbranch_scc1 L_poll1
s_branch L_spinr1

L_spin2:
s_mov_b32 s46, 0x10000
L_poll2:
buffer_load_dwordx2 v[28:29], v250, s[20:23], 0 offen offset:192 sc1
s_waitcnt vmcnt(0)
v_cmp_ne_u64 vcc, s[92:93], v[28:29]
s_cbranch_vccz L_spinr2
buffer_load_dwordx2 v[28:29], v250, s[20:23], 0 offen offset:192 sc1
s_waitcnt vmcnt(0)
v_cmp_ne_u64 vcc, s[92:93], v[28:29]
s_cbranch_vccz L_spinr2
buffer_load_dwordx2 v[28:29], v250, s[20:23], 0 offen offset:192 sc1
s_waitcnt vmcnt(0)
v_cmp_ne_u64 vcc, s[92:93], v[28:29]
s_cbranch_vccz L_spinr2
buffer_load_dwordx2 v[28:29], v250, s[20:23], 0 offen offset:192 sc1
s_waitcnt vmcnt(0)
v_cmp_ne_u64 vcc, s[92:93], v[28:29]
s_cbranch_vccz L_spinr2
buffer_load_dwordx2 v[28:29], v250, s[20:23], 0 offen offset:64 sc1
s_waitcnt vmcnt(0)
v_cmp_ne_u64 vcc, s[92:93], v[28:29]
s_cbranch_vccz L_spinr2
s_sub_u32 s46, s46, 1
s_cmp_lg_u32 s46, 0
s_cbranch_scc1 L_poll2
s_branch L_spinr2

L_own0:
v_mov_b32 v40, v56
v_mov_b32 v41, v57
v_mov_b32 v42, v58
v_mov_b32 v43, v59
v_mov_b32 v44, v68
v_mov_b32 v45, v69
v_mov_b32 v46, v70
v_mov_b32 v47, v71
s_branch L_ownr0

L_own1:
v_mov_b32 v40, v60
v_mov_b32 v41, v61
v_mov_b32 v42, v62
v_mov_b32 v43, v63
v_mov_b32 v44, v72
v_mov_b32 v45, v73
v_mov_b32 v46, v74
v_mov_b32 v47, v75
s_branch L_ownr1

L_own2:
v_mov_b32 v40, v64
v_mov_b32 v41, v65
v_mov_b32 v42, v66
v_mov_b32 v43, v67
v_mov_b32 v44, v76
v_mov_b32 v45, v77
v_mov_b32 v46, v78
v_mov_b32 v47, v79
s_branch L_ownr2

L_own3:
v_mov_b32 v40, v80
v_mov_b32 v41, v81
v_mov_b32 v42, v82
v_mov_b32 v43, v83
v_mov_b32 v44, v92
v_mov_b32 v45, v93
v_mov_b32 v46, v94
v_mov_b32 v47, v95
s_branch L_ownr3

L_own4:
v_mov_b32 v40, v84
v_mov_b32 v41, v85
v_mov_b32 v42, v86
v_mov_b32 v43, v87
v_mov_b32 v44, v96
v_mov_b32 v45, v97
v_mov_b32 v46, v98
v_mov_b32 v47, v99
s_branch L_ownr4

L_own5:
v_mov_b32 v40, v88
v_mov_b32 v41, v89
v_mov_b32 v42, v90
v_mov_b32 v43, v91
v_mov_b32 v44, v100
v_mov_b32 v45, v101
v_mov_b32 v46, v102
v_mov_b32 v47, v103
s_branch L_ownr5

L_own6:
v_mov_b32 v40, v104
v_mov_b32 v41, v105
v_mov_b32 v42, v106
v_mov_b32 v43, v107
v_mov_b32 v44, v116
v_mov_b32 v45, v117
v_mov_b32 v46, v118
v_mov_b32 v47, v119
s_branch L_ownr6

L_own7:
v_mov_b32 v40, v108
v_mov_b32 v41, v109
v_mov_b32 v42, v110
v_mov_b32 v43, v111
v_mov_b32 v44, v120
v_mov_b32 v45, v121
v_mov_b32 v46, v122
v_mov_b32 v47, v123
s_branch L_ownr7

L_own8:
v_mov_b32 v48, v112
v_mov_b32 v49, v113
v_mov_b32 v50, v114
v_mov_b32 v51, v115
v_mov_b32 v52, v124
v_mov_b32 v53, v125
v_mov_b32 v54, v126
v_mov_b32 v55, v127
s_branch L_ownr8

L_own9:
v_mov_b32 v48, v128
v_mov_b32 v49, v129
v_mov_b32 v50, v130
v_mov_b32 v51, v131
v_mov_b32 v52, v140
v_mov_b32 v53, v141
v_mov_b32 v54, v142
v_mov_b32 v55, v143
s_branch L_ownr9

L_own10:
v_mov_b32 v48, v132
v_mov_b32 v49, v133
v_mov_b32 v50, v134
v_mov_b32 v51, v135
v_mov_b32 v52, v144
v_mov_b32 v53, v145
v_mov_b32 v54, v146
v_mov_b32 v55, v147
s_branch L_ownr10

L_own11:
v_mov_b32 v48, v136
v_mov_b32 v49, v137
v_mov_b32 v50, v138
v_mov_b32 v51, v139
v_mov_b32 v52, v148
v_mov_b32 v53, v149
v_mov_b32 v54, v150
v_mov_b32 v55, v151
s_branch L_ownr11

L_own12:
v_mov_b32 v48, v152
v_mov_b32 v49, v153
v_mov_b32 v50, v154
v_mov_b32 v51, v155
v_mov_b32 v52, v164
v_mov_b32 v53, v165
v_mov_b32 v54, v166
v_mov_b32 v55, v167
s_branch L_ownr12

L_own13:
v_mov_b32 v48, v156
v_mov_b32 v49, v157
v_mov_b32 v50, v158
v_mov_b32 v51, v159
v_mov_b32 v52, v168
v_mov_b32 v53, v169
v_mov_b32 v54, v170
v_mov_b32 v55, v171
s_branch L_ownr13

L_own14:
v_mov_b32 v48, v160
v_mov_b32 v49, v161
v_mov_b32 v50, v162
v_mov_b32 v51, v163
v_mov_b32 v52, v172
v_mov_b32 v53, v173
v_mov_b32 v54, v174
v_mov_b32 v55, v175
s_branch L_ownr14

L_tramp_2:
s_call_b64 s[98:99], L_rare1
s_branch L_ret_1
L_tramp_4:
s_call_b64 s[98:99], L_rare0
s_branch L_ret_3
L_tramp_6:
s_call_b64 s[98:99], L_rare1
s_branch L_ret_5
L_tramp_8:
s_call_b64 s[98:99], L_rare0
s_branch L_ret_7
L_tramp_10:
s_call_b64 s[98:99], L_rare1
s_branch L_ret_9
L_tramp_12:
s_call_b64 s[98:99], L_rare0
s_branch L_ret_11
L_tramp_14:
s_call_b64 s[98:99], L_rare1
s_branch L_ret_13
L_tramp_16:
s_call_b64 s[98:99], L_rare0
s_branch L_ret_15
L_tramp_18:
s_call_b64 s[98:99], L_rare1
s_branch L_ret_17
L_rare0:
s_nop 15
v_max3_f32 v132, v32, v33, v34
v_max3_f32 v140, v36, v37, v38
v_max3_f32 v132, v132, v35, v39
v_max_f32 v132, v132, v140
v_mov_b32 v140, v132
s_nop 1
v_permlane32_swap_b32 v132, v140
v_max_f32 v132, v132, v140
v_mov_b32 v140, v132
s_nop 1
v_permlane16_swap_b32 v132, v140
v_max_f32 v132, v132, v140
v_max_f32 v132, 0, v132
v_sub_f32 v104, v104, v132
v_sub_f32 v105, v105, v132
v_sub_f32 v106, v106, v132
v_sub_f32 v107, v107, v132
v_sub_f32 v32, v32, v132
v_sub_f32 v33, v33, v132
v_sub_f32 v34, v34, v132
v_sub_f32 v35, v35, v132
v_sub_f32 v36, v36, v132
v_sub_f32 v37, v37, v132
v_sub_f32 v38, v38, v132
v_sub_f32 v39, v39, v132
v_sub_f32 v56, v56, v132
v_sub_f32 v57, v57, v132
v_sub_f32 v58, v58, v132
v_sub_f32 v59, v59, v132
v_sub_f32 v60, v60, v132
v_sub_f32 v61, v61, v132
v_sub_f32 v62, v62, v132
v_sub_f32 v63, v63, v132
v_exp_f32_e64 v136, -v132
v_max3_f32 v133, v40, v41, v42
v_max3_f32 v140, v44, v45, v46
v_max3_f32 v133, v133, v43, v47
v_max_f32 v133, v133, v140
v_mov_b32 v140, v133
s_nop 1
v_permlane32_swap_b32 v133, v140
v_max_f32 v133, v133, v140
v_mov_b32 v140, v133
s_nop 1
v_permlane16_swap_b32 v133, v140
v_max_f32 v133, v133, v140
v_max_f32 v133, 0, v133
v_sub_f32 v108, v108, v133
v_sub_f32 v109, v109, v133
v_sub_f32 v110, v110, v133
v_sub_f32 v111, v111, v133
v_sub_f32 v40, v40, v133
v_sub_f32 v41, v41, v133
v_sub_f32 v42, v42, v133
v_sub_f32 v43, v43, v133
v_sub_f32 v44, v44, v133
v_sub_f32 v45, v45, v133
v_sub_f32 v46, v46, v133
v_sub_f32 v47, v47, v133
v_sub_f32 v64, v64, v133
v_sub_f32 v65, v65, v133
v_sub_f32 v66, v66, v133
v_sub_f32 v67, v67, v133
v_sub_f32 v68, v68, v133
v_sub_f32 v69, v69, v133
v_sub_f32 v70, v70, v133
v_sub_f32 v71, v71, v133
v_exp_f32_e64 v137, -v133
v_max3_f32 v134, v48, v49, v50
v_max3_f32 v140, v52, v53, v54
v_max3_f32 v134, v134, v51, v55
v_max_f32 v134, v134, v140
v_mov_b32 v140, v134
s_nop 1
v_permlane32_swap_b32 v134, v140
v_max_f32 v134, v134, v140
v_mov_b32 v140, v134
s_nop 1
v_permlane16_swap_b32 v134, v140
v_max_f32 v134, v134, v140
v_max_f32 v134, 0, v134
v_sub_f32 v112, v112, v134
v_sub_f32 v113, v113, v134
v_sub_f32 v114, v114, v134
v_sub_f32 v115, v115, v134
v_sub_f32 v48, v48, v134
v_sub_f32 v49, v49, v134
v_sub_f32 v50, v50, v134
v_sub_f32 v51, v51, v134
v_sub_f32 v52, v52, v134
v_sub_f32 v53, v53, v134
v_sub_f32 v54, v54, v134
v_sub_f32 v55, v55, v134
v_sub_f32 v72, v72, v134
v_sub_f32 v73, v73, v134
v_sub_f32 v74, v74, v134
v_sub_f32 v75, v75, v134
v_sub_f32 v76, v76, v134
v_sub_f32 v77, v77, v134
v_sub_f32 v78, v78, v134
v_sub_f32 v79, v79, v134
v_exp_f32_e64 v138, -v134
v_mul_f32 v156, v156, v136
v_mul_f32 v157, v157, v136
v_mul_f32 v158, v158, v136
v_mul_f32 v159, v159, v136
v_accvgpr_read_b32 v141, a0
v_mul_f32 v141, v141, v136
v_accvgpr_write_b32 a0, v141
v_accvgpr_read_b32 v141, a1
v_mul_f32 v141, v141, v136
v_accvgpr_write_b32 a1, v141
v_accvgpr_read_b32 v141, a2
v_mul_f32 v141, v141, v136
v_accvgpr_write_b32 a2, v141
v_accvgpr_read_b32 v141, a3
v_mul_f32 v141, v141, v136
v_accvgpr_write_b32 a3, v141
v_accvgpr_read_b32 v141, a12
v_mul_f32 v141, v141, v136
v_accvgpr_write_b32 a12, v141
v_accvgpr_read_b32 v141, a13
v_mul_f32 v141, v141, v136
v_accvgpr_write_b32 a13, v141
v_accvgpr_read_b32 v141, a14
v_mul_f32 v141, v141, v136
v_accvgpr_write_b32 a14, v141
v_accvgpr_read_b32 v141, a15
v_mul_f32 v141, v141, v136
v_accvgpr_write_b32 a15, v141
v_accvgpr_read_b32 v141, a24
v_mul_f32 v141, v141, v136
v_accvgpr_write_b32 a24, v141
v_accvgpr_read_b32 v141, a25
v_mul_f32 v141, v141, v136
v_accvgpr_write_b32 a25, v141
v_accvgpr_read_b32 v141, a26
v_mul_f32 v141, v141, v136
v_accvgpr_write_b32 a26, v141
v_accvgpr_read_b32 v141, a27
v_mul_f32 v141, v141, v136
v_accvgpr_write_b32 a27, v141
v_accvgpr_read_b32 v141, a36
v_mul_f32 v141, v141, v136
v_accvgpr_write_b32 a36, v141
v_accvgpr_read_b32 v141, a37
v_mul_f32 v141, v141, v136
v_accvgpr_write_b32 a37, v141
v_accvgpr_read_b32 v141, a38
v_mul_f32 v141, v141, v136
v_accvgpr_write_b32 a38, v141
v_accvgpr_read_b32 v141, a39
v_mul_f32 v141, v141, v136
v_accvgpr_write_b32 a39, v141
v_accvgpr_read_b32 v141, a48
v_mul_f32 v141, v141, v136
v_accvgpr_write_b32 a48, v141
v_accvgpr_read_b32 v141, a49
v_mul_f32 v141, v141, v136
v_accvgpr_write_b32 a49, v141
v_accvgpr_read_b32 v141, a50
v_mul_f32 v141, v141, v136
v_accvgpr_write_b32 a50, v141
v_accvgpr_read_b32 v141, a51
v_mul_f32 v141, v141, v136
v_accvgpr_write_b32 a51, v141
v_accvgpr_read_b32 v141, a60
v_mul_f32 v141, v141, v136
v_accvgpr_write_b32 a60, v141
v_accvgpr_read_b32 v141, a61
v_mul_f32 v141, v141, v136
v_accvgpr_write_b32 a61, v141
v_accvgpr_read_b32 v141, a62
v_mul_f32 v141, v141, v136
v_accvgpr_write_b32 a62, v141
v_accvgpr_read_b32 v141, a63
v_mul_f32 v141, v141, v136
v_accvgpr_write_b32 a63, v141
v_accvgpr_read_b32 v141, a72
v_mul_f32 v141, v141, v136
v_accvgpr_write_b32 a72, v141
v_accvgpr_read_b32 v141, a73
v_mul_f32 v141, v141, v136
v_accvgpr_write_b32 a73, v141
v_accvgpr_read_b32 v141, a74
v_mul_f32 v141, v141, v136
v_accvgpr_write_b32 a74, v141
v_accvgpr_read_b32 v141, a75
v_mul_f32 v141, v141, v136
v_accvgpr_write_b32 a75, v141
v_accvgpr_read_b32 v141, a84
v_mul_f32 v141, v141, v136
v_accvgpr_write_b32 a84, v141
v_accvgpr_read_b32 v141, a85
v_mul_f32 v141, v141, v136
v_accvgpr_write_b32 a85, v141
v_accvgpr_read_b32 v141, a86
v_mul_f32 v141, v141, v136
v_accvgpr_write_b32 a86, v141
v_accvgpr_read_b32 v141, a87
v_mul_f32 v141, v141, v136
v_accvgpr_write_b32 a87, v141
v_accvgpr_read_b32 v141, a96
v_mul_f32 v141, v141, v136
v_accvgpr_write_b32 a96, v141
v_accvgpr_read_b32 v141, a97
v_mul_f32 v141, v141, v136
v_accvgpr_write_b32 a97, v141
v_accvgpr_read_b32 v141, a98
v_mul_f32 v141, v141, v136
v_accvgpr_write_b32 a98, v141
v_accvgpr_read_b32 v141, a99
v_mul_f32 v141, v141, v136
v_accvgpr_write_b32 a99, v141
v_accvgpr_read_b32 v141, a108
v_mul_f32 v141, v141, v136
v_accvgpr_write_b32 a108, v141
v_accvgpr_read_b32 v141, a109
v_mul_f32 v141, v141, v136
v_accvgpr_write_b32 a109, v141
v_accvgpr_read_b32 v141, a110
v_mul_f32 v141, v141, v136
v_accvgpr_write_b32 a110, v141
v_accvgpr_read_b32 v141, a111
v_mul_f32 v141, v141, v136
v_accvgpr_write_b32 a111, v141
v_accvgpr_read_b32 v141, a120
v_mul_f32 v141, v141, v136
v_accvgpr_write_b32 a120, v141
v_accvgpr_read_b32 v141, a121
v_mul_f32 v141, v141, v136
v_accvgpr_write_b32 a121, v141
v_accvgpr_read_b32 v141, a122
v_mul_f32 v141, v141, v136
v_accvgpr_write_b32 a122, v141
v_accvgpr_read_b32 v141, a123
v_mul_f32 v141, v141, v136
v_accvgpr_write_b32 a123, v141
v_accvgpr_read_b32 v141, a132
v_mul_f32 v141, v141, v136
v_accvgpr_write_b32 a132, v141
v_accvgpr_read_b32 v141, a133
v_mul_f32 v141, v141, v136
v_accvgpr_write_b32 a133, v141
v_accvgpr_read_b32 v141, a134
v_mul_f32 v141, v141, v136
v_accvgpr_write_b32 a134, v141
v_accvgpr_read_b32 v141, a135
v_mul_f32 v141, v141, v136
v_accvgpr_write_b32 a135, v141
v_mul_f32 v160, v160, v137
v_mul_f32 v161, v161, v137
v_mul_f32 v162, v162, v137
v_mul_f32 v163, v163, v137
v_accvgpr_read_b32 v141, a4
v_mul_f32 v141, v141, v137
v_accvgpr_write_b32 a4, v141
v_accvgpr_read_b32 v141, a5
v_mul_f32 v141, v141, v137
v_accvgpr_write_b32 a5, v141
v_accvgpr_read_b32 v141, a6
v_mul_f32 v141, v141, v137
v_accvgpr_write_b32 a6, v141
v_accvgpr_read_b32 v141, a7
v_mul_f32 v141, v141, v137
v_accvgpr_write_b32 a7, v141
v_accvgpr_read_b32 v141, a16
v_mul_f32 v141, v141, v137
v_accvgpr_write_b32 a16, v141
v_accvgpr_read_b32 v141, a17
v_mul_f32 v141, v141, v137
v_accvgpr_write_b32 a17, v141
v_accvgpr_read_b32 v141, a18
v_mul_f32 v141, v141, v137
v_accvgpr_write_b32 a18, v141
v_accvgpr_read_b32 v141, a19
v_mul_f32 v141, v141, v137
v_accvgpr_write_b32 a19, v141
v_accvgpr_read_b32 v141, a28
v_mul_f32 v141, v141, v137
v_accvgpr_write_b32 a28, v141
v_accvgpr_read_b32 v141, a29
v_mul_f32 v141, v141, v137
v_accvgpr_write_b32 a29, v141
v_accvgpr_read_b32 v141, a30
v_mul_f32 v141, v141, v137
v_accvgpr_write_b32 a30, v141
v_accvgpr_read_b32 v141, a31
v_mul_f32 v141, v141, v137
v_accvgpr_write_b32 a31, v141
v_accvgpr_read_b32 v141, a40
v_mul_f32 v141, v141, v137
v_accvgpr_write_b32 a40, v141
v_accvgpr_read_b32 v141, a41
v_mul_f32 v141, v141, v137
v_accvgpr_write_b32 a41, v141
v_accvgpr_read_b32 v141, a42
v_mul_f32 v141, v141, v137
v_accvgpr_write_b32 a42, v141
v_accvgpr_read_b32 v141, a43
v_mul_f32 v141, v141, v137
v_accvgpr_write_b32 a43, v141
v_accvgpr_read_b32 v141, a52
v_mul_f32 v141, v141, v137
v_accvgpr_write_b32 a52, v141
v_accvgpr_read_b32 v141, a53
v_mul_f32 v141, v141, v137
v_accvgpr_write_b32 a53, v141
v_accvgpr_read_b32 v141, a54
v_mul_f32 v141, v141, v137
v_accvgpr_write_b32 a54, v141
v_accvgpr_read_b32 v141, a55
v_mul_f32 v141, v141, v137
v_accvgpr_write_b32 a55, v141
v_accvgpr_read_b32 v141, a64
v_mul_f32 v141, v141, v137
v_accvgpr_write_b32 a64, v141
v_accvgpr_read_b32 v141, a65
v_mul_f32 v141, v141, v137
v_accvgpr_write_b32 a65, v141
v_accvgpr_read_b32 v141, a66
v_mul_f32 v141, v141, v137
v_accvgpr_write_b32 a66, v141
v_accvgpr_read_b32 v141, a67
v_mul_f32 v141, v141, v137
v_accvgpr_write_b32 a67, v141
v_accvgpr_read_b32 v141, a76
v_mul_f32 v141, v141, v137
v_accvgpr_write_b32 a76, v141
v_accvgpr_read_b32 v141, a77
v_mul_f32 v141, v141, v137
v_accvgpr_write_b32 a77, v141
v_accvgpr_read_b32 v141, a78
v_mul_f32 v141, v141, v137
v_accvgpr_write_b32 a78, v141
v_accvgpr_read_b32 v141, a79
v_mul_f32 v141, v141, v137
v_accvgpr_write_b32 a79, v141
v_accvgpr_read_b32 v141, a88
v_mul_f32 v141, v141, v137
v_accvgpr_write_b32 a88, v141
v_accvgpr_read_b32 v141, a89
v_mul_f32 v141, v141, v137
v_accvgpr_write_b32 a89, v141
v_accvgpr_read_b32 v141, a90
v_mul_f32 v141, v141, v137
v_accvgpr_write_b32 a90, v141
v_accvgpr_read_b32 v141, a91
v_mul_f32 v141, v141, v137
v_accvgpr_write_b32 a91, v141
v_accvgpr_read_b32 v141, a100
v_mul_f32 v141, v141, v137
v_accvgpr_write_b32 a100, v141
v_accvgpr_read_b32 v141, a101
v_mul_f32 v141, v141, v137
v_accvgpr_write_b32 a101, v141
v_accvgpr_read_b32 v141, a102
v_mul_f32 v141, v141, v137
v_accvgpr_write_b32 a102, v141
v_accvgpr_read_b32 v141, a103
v_mul_f32 v141, v141, v137
v_accvgpr_write_b32 a103, v141
v_accvgpr_read_b32 v141, a112
v_mul_f32 v141, v141, v137
v_accvgpr_write_b32 a112, v141
v_accvgpr_read_b32 v141, a113
v_mul_f32 v141, v141, v137
v_accvgpr_write_b32 a113, v141
v_accvgpr_read_b32 v141, a114
v_mul_f32 v141, v141, v137
v_accvgpr_write_b32 a114, v141
v_accvgpr_read_b32 v141, a115
v_mul_f32 v141, v141, v137
v_accvgpr_write_b32 a115, v141
v_accvgpr_read_b32 v141, a124
v_mul_f32 v141, v141, v137
v_accvgpr_write_b32 a124, v141
v_accvgpr_read_b32 v141, a125
v_mul_f32 v141, v141, v137
v_accvgpr_write_b32 a125, v141
v_accvgpr_read_b32 v141, a126
v_mul_f32 v141, v141, v137
v_accvgpr_write_b32 a126, v141
v_accvgpr_read_b32 v141, a127
v_mul_f32 v141, v141, v137
v_accvgpr_write_b32 a127, v141
v_accvgpr_read_b32 v141, a136
v_mul_f32 v141, v141, v137
v_accvgpr_write_b32 a136, v141
v_accvgpr_read_b32 v141, a137
v_mul_f32 v141, v141, v137
v_accvgpr_write_b32 a137, v141
v_accvgpr_read_b32 v141, a138
v_mul_f32 v141, v141, v137
v_accvgpr_write_b32 a138, v141
v_accvgpr_read_b32 v141, a139
v_mul_f32 v141, v141, v137
v_accvgpr_write_b32 a139, v141
v_mul_f32 v164, v164, v138
v_mul_f32 v165, v165, v138
v_mul_f32 v166, v166, v138
v_mul_f32 v167, v167, v138
v_accvgpr_read_b32 v141, a8
v_mul_f32 v141, v141, v138
v_accvgpr_write_b32 a8, v141
v_accvgpr_read_b32 v141, a9
v_mul_f32 v141, v141, v138
v_accvgpr_write_b32 a9, v141
v_accvgpr_read_b32 v141, a10
v_mul_f32 v141, v141, v138
v_accvgpr_write_b32 a10, v141
v_accvgpr_read_b32 v141, a11
v_mul_f32 v141, v141, v138
v_accvgpr_write_b32 a11, v141
v_accvgpr_read_b32 v141, a20
v_mul_f32 v141, v141, v138
v_accvgpr_write_b32 a20, v141
v_accvgpr_read_b32 v141, a21
v_mul_f32 v141, v141, v138
v_accvgpr_write_b32 a21, v141
v_accvgpr_read_b32 v141, a22
v_mul_f32 v141, v141, v138
v_accvgpr_write_b32 a22, v141
v_accvgpr_read_b32 v141, a23
v_mul_f32 v141, v141, v138
v_accvgpr_write_b32 a23, v141
v_accvgpr_read_b32 v141, a32
v_mul_f32 v141, v141, v138
v_accvgpr_write_b32 a32, v141
v_accvgpr_read_b32 v141, a33
v_mul_f32 v141, v141, v138
v_accvgpr_write_b32 a33, v141
v_accvgpr_read_b32 v141, a34
v_mul_f32 v141, v141, v138
v_accvgpr_write_b32 a34, v141
v_accvgpr_read_b32 v141, a35
v_mul_f32 v141, v141, v138
v_accvgpr_write_b32 a35, v141
v_accvgpr_read_b32 v141, a44
v_mul_f32 v141, v141, v138
v_accvgpr_write_b32 a44, v141
v_accvgpr_read_b32 v141, a45
v_mul_f32 v141, v141, v138
v_accvgpr_write_b32 a45, v141
v_accvgpr_read_b32 v141, a46
v_mul_f32 v141, v141, v138
v_accvgpr_write_b32 a46, v141
v_accvgpr_read_b32 v141, a47
v_mul_f32 v141, v141, v138
v_accvgpr_write_b32 a47, v141
v_accvgpr_read_b32 v141, a56
v_mul_f32 v141, v141, v138
v_accvgpr_write_b32 a56, v141
v_accvgpr_read_b32 v141, a57
v_mul_f32 v141, v141, v138
v_accvgpr_write_b32 a57, v141
v_accvgpr_read_b32 v141, a58
v_mul_f32 v141, v141, v138
v_accvgpr_write_b32 a58, v141
v_accvgpr_read_b32 v141, a59
v_mul_f32 v141, v141, v138
v_accvgpr_write_b32 a59, v141
v_accvgpr_read_b32 v141, a68
v_mul_f32 v141, v141, v138
v_accvgpr_write_b32 a68, v141
v_accvgpr_read_b32 v141, a69
v_mul_f32 v141, v141, v138
v_accvgpr_write_b32 a69, v141
v_accvgpr_read_b32 v141, a70
v_mul_f32 v141, v141, v138
v_accvgpr_write_b32 a70, v141
v_accvgpr_read_b32 v141, a71
v_mul_f32 v141, v141, v138
v_accvgpr_write_b32 a71, v141
v_accvgpr_read_b32 v141, a80
v_mul_f32 v141, v141, v138
v_accvgpr_write_b32 a80, v141
v_accvgpr_read_b32 v141, a81
v_mul_f32 v141, v141, v138
v_accvgpr_write_b32 a81, v141
v_accvgpr_read_b32 v141, a82
v_mul_f32 v141, v141, v138
v_accvgpr_write_b32 a82, v141
v_accvgpr_read_b32 v141, a83
v_mul_f32 v141, v141, v138
v_accvgpr_write_b32 a83, v141
v_accvgpr_read_b32 v141, a92
v_mul_f32 v141, v141, v138
v_accvgpr_write_b32 a92, v141
v_accvgpr_read_b32 v141, a93
v_mul_f32 v141, v141, v138
v_accvgpr_write_b32 a93, v141
v_accvgpr_read_b32 v141, a94
v_mul_f32 v141, v141, v138
v_accvgpr_write_b32 a94, v141
v_accvgpr_read_b32 v141, a95
v_mul_f32 v141, v141, v138
v_accvgpr_write_b32 a95, v141
v_accvgpr_read_b32 v141, a104
v_mul_f32 v141, v141, v138
v_accvgpr_write_b32 a104, v141
v_accvgpr_read_b32 v141, a105
v_mul_f32 v141, v141, v138
v_accvgpr_write_b32 a105, v141
v_accvgpr_read_b32 v141, a106
v_mul_f32 v141, v141, v138
v_accvgpr_write_b32 a106, v141
v_accvgpr_read_b32 v141, a107
v_mul_f32 v141, v141, v138
v_accvgpr_write_b32 a107, v141
v_accvgpr_read_b32 v141, a116
v_mul_f32 v141, v141, v138
v_accvgpr_write_b32 a116, v141
v_accvgpr_read_b32 v141, a117
v_mul_f32 v141, v141, v138
v_accvgpr_write_b32 a117, v141
v_accvgpr_read_b32 v141, a118
v_mul_f32 v141, v141, v138
v_accvgpr_write_b32 a118, v141
v_accvgpr_read_b32 v141, a119
v_mul_f32 v141, v141, v138
v_accvgpr_write_b32 a119, v141
v_accvgpr_read_b32 v141, a128
v_mul_f32 v141, v141, v138
v_accvgpr_write_b32 a128, v141
v_accvgpr_read_b32 v141, a129
v_mul_f32 v141, v141, v138
v_accvgpr_write_b32 a129, v141
v_accvgpr_read_b32 v141, a130
v_mul_f32 v141, v141, v138
v_accvgpr_write_b32 a130, v141
v_accvgpr_read_b32 v141, a131
v_mul_f32 v141, v141, v138
v_accvgpr_write_b32 a131, v141
v_accvgpr_read_b32 v141, a140
v_mul_f32 v141, v141, v138
v_accvgpr_write_b32 a140, v141
v_accvgpr_read_b32 v141, a141
v_mul_f32 v141, v141, v138
v_accvgpr_write_b32 a141, v141
v_accvgpr_read_b32 v141, a142
v_mul_f32 v141, v141, v138
v_accvgpr_write_b32 a142, v141
v_accvgpr_read_b32 v141, a143
v_mul_f32 v141, v141, v138
v_accvgpr_write_b32 a143, v141
v_exp_f32 v120, v32
v_exp_f32 v121, v33
s_nop 0
v_cvt_pk_bf16_f32 v80, v120, v121
v_exp_f32 v120, v34
v_exp_f32 v121, v35
s_nop 0
v_cvt_pk_bf16_f32 v81, v120, v121
v_exp_f32 v120, v40
v_exp_f32 v121, v41
s_nop 0
v_cvt_pk_bf16_f32 v84, v120, v121
v_exp_f32 v120, v42
v_exp_f32 v121, v43
s_nop 0
v_cvt_pk_bf16_f32 v85, v120, v121
v_exp_f32 v120, v48
v_exp_f32 v121, v49
s_nop 0
v_cvt_pk_bf16_f32 v88, v120, v121
v_exp_f32 v120, v50
v_exp_f32 v121, v51
s_nop 0
v_cvt_pk_bf16_f32 v89, v120, v121
v_exp_f32 v120, v36
v_exp_f32 v121, v37
s_nop 0
v_cvt_pk_bf16_f32 v82, v120, v121
v_exp_f32 v120, v38
v_exp_f32 v121, v39
s_nop 0
v_cvt_pk_bf16_f32 v83, v120, v121
v_exp_f32 v120, v44
v_exp_f32 v121, v45
s_nop 0
v_cvt_pk_bf16_f32 v86, v120, v121
v_exp_f32 v120, v46
v_exp_f32 v121, v47
s_nop 0
v_cvt_pk_bf16_f32 v87, v120, v121
v_exp_f32 v120, v52
v_exp_f32 v121, v53
s_nop 0
v_cvt_pk_bf16_f32 v90, v120, v121
v_exp_f32 v120, v54
v_exp_f32 v121, v55
s_nop 0
v_cvt_pk_bf16_f32 v91, v120, v121
v_mfma_f32_16x16x32_bf16 v[144:147], a[240:243], v[80:83], v[156:159]
v_mfma_f32_16x16x32_bf16 v[148:151], a[240:243], v[84:87], v[160:163]
v_mfma_f32_16x16x32_bf16 v[152:155], a[240:243], v[88:91], v[164:167]
s_nop 15
s_setpc_b64 s[98:99]
L_rare1:
s_nop 15
v_max3_f32 v132, v56, v57, v58
v_max3_f32 v140, v60, v61, v62
v_max3_f32 v132, v132, v59, v63
v_max_f32 v132, v132, v140
v_mov_b32 v140, v132
s_nop 1
v_permlane32_swap_b32 v132, v140
v_max_f32 v132, v132, v140
v_mov_b32 v140, v132
s_nop 1
v_permlane16_swap_b32 v132, v140
v_max_f32 v132, v132, v140
v_max_f32 v132, 0, v132
v_sub_f32 v104, v104, v132
v_sub_f32 v105, v105, v132
v_sub_f32 v106, v106, v132
v_sub_f32 v107, v107, v132
v_sub_f32 v56, v56, v132
v_sub_f32 v57, v57, v132
v_sub_f32 v58, v58, v132
v_sub_f32 v59, v59, v132
v_sub_f32 v60, v60, v132
v_sub_f32 v61, v61, v132
v_sub_f32 v62, v62, v132
v_sub_f32 v63, v63, v132
v_sub_f32 v32, v32, v132
v_sub_f32 v33, v33, v132
v_sub_f32 v34, v34, v132
v_sub_f32 v35, v35, v132
v_sub_f32 v36, v36, v132
v_sub_f32 v37, v37, v132
v_sub_f32 v38, v38, v132
v_sub_f32 v39, v39, v132
v_exp_f32_e64 v136, -v132
v_max3_f32 v133, v64, v65, v66
v_max3_f32 v140, v68, v69, v70
v_max3_f32 v133, v133, v67, v71
v_max_f32 v133, v133, v140
v_mov_b32 v140, v133
s_nop 1
v_permlane32_swap_b32 v133, v140
v_max_f32 v133, v133, v140
v_mov_b32 v140, v133
s_nop 1
v_permlane16_swap_b32 v133, v140
v_max_f32 v133, v133, v140
v_max_f32 v133, 0, v133
v_sub_f32 v108, v108, v133
v_sub_f32 v109, v109, v133
v_sub_f32 v110, v110, v133
v_sub_f32 v111, v111, v133
v_sub_f32 v64, v64, v133
v_sub_f32 v65, v65, v133
v_sub_f32 v66, v66, v133
v_sub_f32 v67, v67, v133
v_sub_f32 v68, v68, v133
v_sub_f32 v69, v69, v133
v_sub_f32 v70, v70, v133
v_sub_f32 v71, v71, v133
v_sub_f32 v40, v40, v133
v_sub_f32 v41, v41, v133
v_sub_f32 v42, v42, v133
v_sub_f32 v43, v43, v133
v_sub_f32 v44, v44, v133
v_sub_f32 v45, v45, v133
v_sub_f32 v46, v46, v133
v_sub_f32 v47, v47, v133
v_exp_f32_e64 v137, -v133
v_max3_f32 v134, v72, v73, v74
v_max3_f32 v140, v76, v77, v78
v_max3_f32 v134, v134, v75, v79
v_max_f32 v134, v134, v140
v_mov_b32 v140, v134
s_nop 1
v_permlane32_swap_b32 v134, v140
v_max_f32 v134, v134, v140
v_mov_b32 v140, v134
s_nop 1
v_permlane16_swap_b32 v134, v140
v_max_f32 v134, v134, v140
v_max_f32 v134, 0, v134
v_sub_f32 v112, v112, v134
v_sub_f32 v113, v113, v134
v_sub_f32 v114, v114, v134
v_sub_f32 v115, v115, v134
v_sub_f32 v72, v72, v134
v_sub_f32 v73, v73, v134
v_sub_f32 v74, v74, v134
v_sub_f32 v75, v75, v134
v_sub_f32 v76, v76, v134
v_sub_f32 v77, v77, v134
v_sub_f32 v78, v78, v134
v_sub_f32 v79, v79, v134
v_sub_f32 v48, v48, v134
v_sub_f32 v49, v49, v134
v_sub_f32 v50, v50, v134
v_sub_f32 v51, v51, v134
v_sub_f32 v52, v52, v134
v_sub_f32 v53, v53, v134
v_sub_f32 v54, v54, v134
v_sub_f32 v55, v55, v134
v_exp_f32_e64 v138, -v134
v_mul_f32 v144, v144, v136
v_mul_f32 v145, v145, v136
v_mul_f32 v146, v146, v136
v_mul_f32 v147, v147, v136
v_accvgpr_read_b32 v141, a0
v_mul_f32 v141, v141, v136
v_accvgpr_write_b32 a0, v141
v_accvgpr_read_b32 v141, a1
v_mul_f32 v141, v141, v136
v_accvgpr_write_b32 a1, v141
v_accvgpr_read_b32 v141, a2
v_mul_f32 v141, v141, v136
v_accvgpr_write_b32 a2, v141
v_accvgpr_read_b32 v141, a3
v_mul_f32 v141, v141, v136
v_accvgpr_write_b32 a3, v141
v_accvgpr_read_b32 v141, a12
v_mul_f32 v141, v141, v136
v_accvgpr_write_b32 a12, v141
v_accvgpr_read_b32 v141, a13
v_mul_f32 v141, v141, v136
v_accvgpr_write_b32 a13, v141
v_accvgpr_read_b32 v141, a14
v_mul_f32 v141, v141, v136
v_accvgpr_write_b32 a14, v141
v_accvgpr_read_b32 v141, a15
v_mul_f32 v141, v141, v136
v_accvgpr_write_b32 a15, v141
v_accvgpr_read_b32 v141, a24
v_mul_f32 v141, v141, v136
v_accvgpr_write_b32 a24, v141
v_accvgpr_read_b32 v141, a25
v_mul_f32 v141, v141, v136
v_accvgpr_write_b32 a25, v141
v_accvgpr_read_b32 v141, a26
v_mul_f32 v141, v141, v136
v_accvgpr_write_b32 a26, v141
v_accvgpr_read_b32 v141, a27
v_mul_f32 v141, v141, v136
v_accvgpr_write_b32 a27, v141
v_accvgpr_read_b32 v141, a36
v_mul_f32 v141, v141, v136
v_accvgpr_write_b32 a36, v141
v_accvgpr_read_b32 v141, a37
v_mul_f32 v141, v141, v136
v_accvgpr_write_b32 a37, v141
v_accvgpr_read_b32 v141, a38
v_mul_f32 v141, v141, v136
v_accvgpr_write_b32 a38, v141
v_accvgpr_read_b32 v141, a39
v_mul_f32 v141, v141, v136
v_accvgpr_write_b32 a39, v141
v_accvgpr_read_b32 v141, a48
v_mul_f32 v141, v141, v136
v_accvgpr_write_b32 a48, v141
v_accvgpr_read_b32 v141, a49
v_mul_f32 v141, v141, v136
v_accvgpr_write_b32 a49, v141
v_accvgpr_read_b32 v141, a50
v_mul_f32 v141, v141, v136
v_accvgpr_write_b32 a50, v141
v_accvgpr_read_b32 v141, a51
v_mul_f32 v141, v141, v136
v_accvgpr_write_b32 a51, v141
v_accvgpr_read_b32 v141, a60
v_mul_f32 v141, v141, v136
v_accvgpr_write_b32 a60, v141
v_accvgpr_read_b32 v141, a61
v_mul_f32 v141, v141, v136
v_accvgpr_write_b32 a61, v141
v_accvgpr_read_b32 v141, a62
v_mul_f32 v141, v141, v136
v_accvgpr_write_b32 a62, v141
v_accvgpr_read_b32 v141, a63
v_mul_f32 v141, v141, v136
v_accvgpr_write_b32 a63, v141
v_accvgpr_read_b32 v141, a72
v_mul_f32 v141, v141, v136
v_accvgpr_write_b32 a72, v141
v_accvgpr_read_b32 v141, a73
v_mul_f32 v141, v141, v136
v_accvgpr_write_b32 a73, v141
v_accvgpr_read_b32 v141, a74
v_mul_f32 v141, v141, v136
v_accvgpr_write_b32 a74, v141
v_accvgpr_read_b32 v141, a75
v_mul_f32 v141, v141, v136
v_accvgpr_write_b32 a75, v141
v_accvgpr_read_b32 v141, a84
v_mul_f32 v141, v141, v136
v_accvgpr_write_b32 a84, v141
v_accvgpr_read_b32 v141, a85
v_mul_f32 v141, v141, v136
v_accvgpr_write_b32 a85, v141
v_accvgpr_read_b32 v141, a86
v_mul_f32 v141, v141, v136
v_accvgpr_write_b32 a86, v141
v_accvgpr_read_b32 v141, a87
v_mul_f32 v141, v141, v136
v_accvgpr_write_b32 a87, v141
v_accvgpr_read_b32 v141, a96
v_mul_f32 v141, v141, v136
v_accvgpr_write_b32 a96, v141
v_accvgpr_read_b32 v141, a97
v_mul_f32 v141, v141, v136
v_accvgpr_write_b32 a97, v141
v_accvgpr_read_b32 v141, a98
v_mul_f32 v141, v141, v136
v_accvgpr_write_b32 a98, v141
v_accvgpr_read_b32 v141, a99
v_mul_f32 v141, v141, v136
v_accvgpr_write_b32 a99, v141
v_accvgpr_read_b32 v141, a108
v_mul_f32 v141, v141, v136
v_accvgpr_write_b32 a108, v141
v_accvgpr_read_b32 v141, a109
v_mul_f32 v141, v141, v136
v_accvgpr_write_b32 a109, v141
v_accvgpr_read_b32 v141, a110
v_mul_f32 v141, v141, v136
v_accvgpr_write_b32 a110, v141
v_accvgpr_read_b32 v141, a111
v_mul_f32 v141, v141, v136
v_accvgpr_write_b32 a111, v141
v_accvgpr_read_b32 v141, a120
v_mul_f32 v141, v141, v136
v_accvgpr_write_b32 a120, v141
v_accvgpr_read_b32 v141, a121
v_mul_f32 v141, v141, v136
v_accvgpr_write_b32 a121, v141
v_accvgpr_read_b32 v141, a122
v_mul_f32 v141, v141, v136
v_accvgpr_write_b32 a122, v141
v_accvgpr_read_b32 v141, a123
v_mul_f32 v141, v141, v136
v_accvgpr_write_b32 a123, v141
v_accvgpr_read_b32 v141, a132
v_mul_f32 v141, v141, v136
v_accvgpr_write_b32 a132, v141
v_accvgpr_read_b32 v141, a133
v_mul_f32 v141, v141, v136
v_accvgpr_write_b32 a133, v141
v_accvgpr_read_b32 v141, a134
v_mul_f32 v141, v141, v136
v_accvgpr_write_b32 a134, v141
v_accvgpr_read_b32 v141, a135
v_mul_f32 v141, v141, v136
v_accvgpr_write_b32 a135, v141
v_mul_f32 v148, v148, v137
v_mul_f32 v149, v149, v137
v_mul_f32 v150, v150, v137
v_mul_f32 v151, v151, v137
v_accvgpr_read_b32 v141, a4
v_mul_f32 v141, v141, v137
v_accvgpr_write_b32 a4, v141
v_accvgpr_read_b32 v141, a5
v_mul_f32 v141, v141, v137
v_accvgpr_write_b32 a5, v141
v_accvgpr_read_b32 v141, a6
v_mul_f32 v141, v141, v137
v_accvgpr_write_b32 a6, v141
v_accvgpr_read_b32 v141, a7
v_mul_f32 v141, v141, v137
v_accvgpr_write_b32 a7, v141
v_accvgpr_read_b32 v141, a16
v_mul_f32 v141, v141, v137
v_accvgpr_write_b32 a16, v141
v_accvgpr_read_b32 v141, a17
v_mul_f32 v141, v141, v137
v_accvgpr_write_b32 a17, v141
v_accvgpr_read_b32 v141, a18
v_mul_f32 v141, v141, v137
v_accvgpr_write_b32 a18, v141
v_accvgpr_read_b32 v141, a19
v_mul_f32 v141, v141, v137
v_accvgpr_write_b32 a19, v141
v_accvgpr_read_b32 v141, a28
v_mul_f32 v141, v141, v137
v_accvgpr_write_b32 a28, v141
v_accvgpr_read_b32 v141, a29
v_mul_f32 v141, v141, v137
v_accvgpr_write_b32 a29, v141
v_accvgpr_read_b32 v141, a30
v_mul_f32 v141, v141, v137
v_accvgpr_write_b32 a30, v141
v_accvgpr_read_b32 v141, a31
v_mul_f32 v141, v141, v137
v_accvgpr_write_b32 a31, v141
v_accvgpr_read_b32 v141, a40
v_mul_f32 v141, v141, v137
v_accvgpr_write_b32 a40, v141
v_accvgpr_read_b32 v141, a41
v_mul_f32 v141, v141, v137
v_accvgpr_write_b32 a41, v141
v_accvgpr_read_b32 v141, a42
v_mul_f32 v141, v141, v137
v_accvgpr_write_b32 a42, v141
v_accvgpr_read_b32 v141, a43
v_mul_f32 v141, v141, v137
v_accvgpr_write_b32 a43, v141
v_accvgpr_read_b32 v141, a52
v_mul_f32 v141, v141, v137
v_accvgpr_write_b32 a52, v141
v_accvgpr_read_b32 v141, a53
v_mul_f32 v141, v141, v137
v_accvgpr_write_b32 a53, v141
v_accvgpr_read_b32 v141, a54
v_mul_f32 v141, v141, v137
v_accvgpr_write_b32 a54, v141
v_accvgpr_read_b32 v141, a55
v_mul_f32 v141, v141, v137
v_accvgpr_write_b32 a55, v141
v_accvgpr_read_b32 v141, a64
v_mul_f32 v141, v141, v137
v_accvgpr_write_b32 a64, v141
v_accvgpr_read_b32 v141, a65
v_mul_f32 v141, v141, v137
v_accvgpr_write_b32 a65, v141
v_accvgpr_read_b32 v141, a66
v_mul_f32 v141, v141, v137
v_accvgpr_write_b32 a66, v141
v_accvgpr_read_b32 v141, a67
v_mul_f32 v141, v141, v137
v_accvgpr_write_b32 a67, v141
v_accvgpr_read_b32 v141, a76
v_mul_f32 v141, v141, v137
v_accvgpr_write_b32 a76, v141
v_accvgpr_read_b32 v141, a77
v_mul_f32 v141, v141, v137
v_accvgpr_write_b32 a77, v141
v_accvgpr_read_b32 v141, a78
v_mul_f32 v141, v141, v137
v_accvgpr_write_b32 a78, v141
v_accvgpr_read_b32 v141, a79
v_mul_f32 v141, v141, v137
v_accvgpr_write_b32 a79, v141
v_accvgpr_read_b32 v141, a88
v_mul_f32 v141, v141, v137
v_accvgpr_write_b32 a88, v141
v_accvgpr_read_b32 v141, a89
v_mul_f32 v141, v141, v137
v_accvgpr_write_b32 a89, v141
v_accvgpr_read_b32 v141, a90
v_mul_f32 v141, v141, v137
v_accvgpr_write_b32 a90, v141
v_accvgpr_read_b32 v141, a91
v_mul_f32 v141, v141, v137
v_accvgpr_write_b32 a91, v141
v_accvgpr_read_b32 v141, a100
v_mul_f32 v141, v141, v137
v_accvgpr_write_b32 a100, v141
v_accvgpr_read_b32 v141, a101
v_mul_f32 v141, v141, v137
v_accvgpr_write_b32 a101, v141
v_accvgpr_read_b32 v141, a102
v_mul_f32 v141, v141, v137
v_accvgpr_write_b32 a102, v141
v_accvgpr_read_b32 v141, a103
v_mul_f32 v141, v141, v137
v_accvgpr_write_b32 a103, v141
v_accvgpr_read_b32 v141, a112
v_mul_f32 v141, v141, v137
v_accvgpr_write_b32 a112, v141
v_accvgpr_read_b32 v141, a113
v_mul_f32 v141, v141, v137
v_accvgpr_write_b32 a113, v141
v_accvgpr_read_b32 v141, a114
v_mul_f32 v141, v141, v137
v_accvgpr_write_b32 a114, v141
v_accvgpr_read_b32 v141, a115
v_mul_f32 v141, v141, v137
v_accvgpr_write_b32 a115, v141
v_accvgpr_read_b32 v141, a124
v_mul_f32 v141, v141, v137
v_accvgpr_write_b32 a124, v141
v_accvgpr_read_b32 v141, a125
v_mul_f32 v141, v141, v137
v_accvgpr_write_b32 a125, v141
v_accvgpr_read_b32 v141, a126
v_mul_f32 v141, v141, v137
v_accvgpr_write_b32 a126, v141
v_accvgpr_read_b32 v141, a127
v_mul_f32 v141, v141, v137
v_accvgpr_write_b32 a127, v141
v_accvgpr_read_b32 v141, a136
v_mul_f32 v141, v141, v137
v_accvgpr_write_b32 a136, v141
v_accvgpr_read_b32 v141, a137
v_mul_f32 v141, v141, v137
v_accvgpr_write_b32 a137, v141
v_accvgpr_read_b32 v141, a138
v_mul_f32 v141, v141, v137
v_accvgpr_write_b32 a138, v141
v_accvgpr_read_b32 v141, a139
v_mul_f32 v141, v141, v137
v_accvgpr_write_b32 a139, v141
v_mul_f32 v152, v152, v138
v_mul_f32 v153, v153, v138
v_mul_f32 v154, v154, v138
v_mul_f32 v155, v155, v138
v_accvgpr_read_b32 v141, a8
v_mul_f32 v141, v141, v138
v_accvgpr_write_b32 a8, v141
v_accvgpr_read_b32 v141, a9
v_mul_f32 v141, v141, v138
v_accvgpr_write_b32 a9, v141
v_accvgpr_read_b32 v141, a10
v_mul_f32 v141, v141, v138
v_accvgpr_write_b32 a10, v141
v_accvgpr_read_b32 v141, a11
v_mul_f32 v141, v141, v138
v_accvgpr_write_b32 a11, v141
v_accvgpr_read_b32 v141, a20
v_mul_f32 v141, v141, v138
v_accvgpr_write_b32 a20, v141
v_accvgpr_read_b32 v141, a21
v_mul_f32 v141, v141, v138
v_accvgpr_write_b32 a21, v141
v_accvgpr_read_b32 v141, a22
v_mul_f32 v141, v141, v138
v_accvgpr_write_b32 a22, v141
v_accvgpr_read_b32 v141, a23
v_mul_f32 v141, v141, v138
v_accvgpr_write_b32 a23, v141
v_accvgpr_read_b32 v141, a32
v_mul_f32 v141, v141, v138
v_accvgpr_write_b32 a32, v141
v_accvgpr_read_b32 v141, a33
v_mul_f32 v141, v141, v138
v_accvgpr_write_b32 a33, v141
v_accvgpr_read_b32 v141, a34
v_mul_f32 v141, v141, v138
v_accvgpr_write_b32 a34, v141
v_accvgpr_read_b32 v141, a35
v_mul_f32 v141, v141, v138
v_accvgpr_write_b32 a35, v141
v_accvgpr_read_b32 v141, a44
v_mul_f32 v141, v141, v138
v_accvgpr_write_b32 a44, v141
v_accvgpr_read_b32 v141, a45
v_mul_f32 v141, v141, v138
v_accvgpr_write_b32 a45, v141
v_accvgpr_read_b32 v141, a46
v_mul_f32 v141, v141, v138
v_accvgpr_write_b32 a46, v141
v_accvgpr_read_b32 v141, a47
v_mul_f32 v141, v141, v138
v_accvgpr_write_b32 a47, v141
v_accvgpr_read_b32 v141, a56
v_mul_f32 v141, v141, v138
v_accvgpr_write_b32 a56, v141
v_accvgpr_read_b32 v141, a57
v_mul_f32 v141, v141, v138
v_accvgpr_write_b32 a57, v141
v_accvgpr_read_b32 v141, a58
v_mul_f32 v141, v141, v138
v_accvgpr_write_b32 a58, v141
v_accvgpr_read_b32 v141, a59
v_mul_f32 v141, v141, v138
v_accvgpr_write_b32 a59, v141
v_accvgpr_read_b32 v141, a68
v_mul_f32 v141, v141, v138
v_accvgpr_write_b32 a68, v141
v_accvgpr_read_b32 v141, a69
v_mul_f32 v141, v141, v138
v_accvgpr_write_b32 a69, v141
v_accvgpr_read_b32 v141, a70
v_mul_f32 v141, v141, v138
v_accvgpr_write_b32 a70, v141
v_accvgpr_read_b32 v141, a71
v_mul_f32 v141, v141, v138
v_accvgpr_write_b32 a71, v141
v_accvgpr_read_b32 v141, a80
v_mul_f32 v141, v141, v138
v_accvgpr_write_b32 a80, v141
v_accvgpr_read_b32 v141, a81
v_mul_f32 v141, v141, v138
v_accvgpr_write_b32 a81, v141
v_accvgpr_read_b32 v141, a82
v_mul_f32 v141, v141, v138
v_accvgpr_write_b32 a82, v141
v_accvgpr_read_b32 v141, a83
v_mul_f32 v141, v141, v138
v_accvgpr_write_b32 a83, v141
v_accvgpr_read_b32 v141, a92
v_mul_f32 v141, v141, v138
v_accvgpr_write_b32 a92, v141
v_accvgpr_read_b32 v141, a93
v_mul_f32 v141, v141, v138
v_accvgpr_write_b32 a93, v141
v_accvgpr_read_b32 v141, a94
v_mul_f32 v141, v141, v138
v_accvgpr_write_b32 a94, v141
v_accvgpr_read_b32 v141, a95
v_mul_f32 v141, v141, v138
v_accvgpr_write_b32 a95, v141
v_accvgpr_read_b32 v141, a104
v_mul_f32 v141, v141, v138
v_accvgpr_write_b32 a104, v141
v_accvgpr_read_b32 v141, a105
v_mul_f32 v141, v141, v138
v_accvgpr_write_b32 a105, v141
v_accvgpr_read_b32 v141, a106
v_mul_f32 v141, v141, v138
v_accvgpr_write_b32 a106, v141
v_accvgpr_read_b32 v141, a107
v_mul_f32 v141, v141, v138
v_accvgpr_write_b32 a107, v141
v_accvgpr_read_b32 v141, a116
v_mul_f32 v141, v141, v138
v_accvgpr_write_b32 a116, v141
v_accvgpr_read_b32 v141, a117
v_mul_f32 v141, v141, v138
v_accvgpr_write_b32 a117, v141
v_accvgpr_read_b32 v141, a118
v_mul_f32 v141, v141, v138
v_accvgpr_write_b32 a118, v141
v_accvgpr_read_b32 v141, a119
v_mul_f32 v141, v141, v138
v_accvgpr_write_b32 a119, v141
v_accvgpr_read_b32 v141, a128
v_mul_f32 v141, v141, v138
v_accvgpr_write_b32 a128, v141
v_accvgpr_read_b32 v141, a129
v_mul_f32 v141, v141, v138
v_accvgpr_write_b32 a129, v141
v_accvgpr_read_b32 v141, a130
v_mul_f32 v141, v141, v138
v_accvgpr_write_b32 a130, v141
v_accvgpr_read_b32 v141, a131
v_mul_f32 v141, v141, v138
v_accvgpr_write_b32 a131, v141
v_accvgpr_read_b32 v141, a140
v_mul_f32 v141, v141, v138
v_accvgpr_write_b32 a140, v141
v_accvgpr_read_b32 v141, a141
v_mul_f32 v141, v141, v138
v_accvgpr_write_b32 a141, v141
v_accvgpr_read_b32 v141, a142
v_mul_f32 v141, v141, v138
v_accvgpr_write_b32 a142, v141
v_accvgpr_read_b32 v141, a143
v_mul_f32 v141, v141, v138
v_accvgpr_write_b32 a143, v141
v_exp_f32 v120, v56
v_exp_f32 v121, v57
s_nop 0
v_cvt_pk_bf16_f32 v92, v120, v121
v_exp_f32 v120, v58
v_exp_f32 v121, v59
s_nop 0
v_cvt_pk_bf16_f32 v93, v120, v121
v_exp_f32 v120, v64
v_exp_f32 v121, v65
s_nop 0
v_cvt_pk_bf16_f32 v96, v120, v121
v_exp_f32 v120, v66
v_exp_f32 v121, v67
s_nop 0
v_cvt_pk_bf16_f32 v97, v120, v121
v_exp_f32 v120, v72
v_exp_f32 v121, v73
s_nop 0
v_cvt_pk_bf16_f32 v100, v120, v121
v_exp_f32 v120, v74
v_exp_f32 v121, v75
s_nop 0
v_cvt_pk_bf16_f32 v101, v120, v121
v_exp_f32 v120, v60
v_exp_f32 v121, v61
s_nop 0
v_cvt_pk_bf16_f32 v94, v120, v121
v_exp_f32 v120, v62
v_exp_f32 v121, v63
s_nop 0
v_cvt_pk_bf16_f32 v95, v120, v121
v_exp_f32 v120, v68
v_exp_f32 v121, v69
s_nop 0
v_cvt_pk_bf16_f32 v98, v120, v121
v_exp_f32 v120, v70
v_exp_f32 v121, v71
s_nop 0
v_cvt_pk_bf16_f32 v99, v120, v121
v_exp_f32 v120, v76
v_exp_f32 v121, v77
s_nop 0
v_cvt_pk_bf16_f32 v102, v120, v121
v_exp_f32 v120, v78
v_exp_f32 v121, v79
s_nop 0
v_cvt_pk_bf16_f32 v103, v120, v121
v_mfma_f32_16x16x32_bf16 v[156:159], a[240:243], v[92:95], v[144:147]
v_mfma_f32_16x16x32_bf16 v[160:163], a[240:243], v[96:99], v[148:151]
v_mfma_f32_16x16x32_bf16 v[164:167], a[240:243], v[100:103], v[152:155]
s_nop 15
s_setpc_b64 s[98:99]
.fill 64, 4, 0xbf800000
.section .rodata,"a"
.p2align 6
.amdhsa_kernel standalone__gqa_block_cached__near_ridge_kernel
  .amdhsa_next_free_vgpr 512
  .amdhsa_next_free_sgpr 102
  .amdhsa_accum_offset 256
  .amdhsa_group_segment_fixed_size 0
  .amdhsa_kernarg_size 64
  .amdhsa_user_sgpr_count 2
  .amdhsa_user_sgpr_kernarg_segment_ptr 1
  .amdhsa_system_sgpr_workgroup_id_x 1
.end_amdhsa_kernel
```
